```python
import torch

def _softmax(x, axis=-1):
    return torch.softmax(x, dim=axis)
def _gelu(x):
    return torch.nn.functional.gelu(x, approximate="tanh")
def _silu(x):
    return torch.nn.functional.silu(x)
def _sigmoid(x):
    return torch.sigmoid(x)
def _layernorm(x, axis=-1, eps=1e-5):
    m = x.mean(dim=axis, keepdim=True)
    v = x.var(dim=axis, keepdim=True, unbiased=False)
    return (x - m) / torch.sqrt(v + eps)
def _scatter_add(tgt, idx, src, axis=0):
    return tgt.clone().index_add_(axis, idx, src)
def _segment_sum(src, seg, n):
    out = torch.zeros((n,) + src.shape[1:], dtype=src.dtype)
    return out.index_add_(0, seg, src)
def _pad(x, pw):
    flat = tuple(v for pair in reversed(pw) for v in pair)
    return torch.nn.functional.pad(x, flat)

kernel_name = 'standalone__dense_activation_gelu__prompt'

def setup_inputs():

    _w = (lambda a: (lambda t: t.to(torch.bfloat16) if t.is_floating_point() else t)(torch.as_tensor(a)))
    B, S, D, F = 1, 2048, 576, 4608
    return {
        "x": _w((lambda *s: torch.randn(*s, dtype=torch.bfloat16) * 0.05)(B, S, D)),
        "w1": _w((lambda *s: torch.randn(*s, dtype=torch.bfloat16) * 3.2)(D, F) * (D ** -0.5)),
        "b1": _w((lambda *s: torch.randn(*s, dtype=torch.bfloat16) * 3.2)(F) * 0.01),
        "w2": _w((lambda *s: torch.randn(*s, dtype=torch.bfloat16) * 0.05)(F, D) * (F ** -0.5)),
        "b2": _w((lambda *s: torch.randn(*s, dtype=torch.bfloat16) * 0.1)(D) * 0.01),
    }

def reference(x, w1, b1, w2, b2):
    h = torch.einsum("bsd,df->bsf", x, w1) + b1
    h = _gelu(h)
    return torch.einsum("bsf,fd->bsd", h, w2) + b2
```

```asm
; @launch grid=(256,1,1) block=(256,1,1) lds=163840
.amdgcn_target "amdgcn-amd-amdhsa--gfx950"
.text
.globl standalone__dense_activation_gelu__prompt_kernel
.p2align 8
.type standalone__dense_activation_gelu__prompt_kernel,@function
standalone__dense_activation_gelu__prompt_kernel:
    s_cmp_ge_u32 s2, 256
    s_cbranch_scc1 L_end
    s_load_dwordx16 s[40:55], s[0:1], 0
    s_getpc_b64 s[6:7]
L_pc:
    s_lshr_b32 s4, s2, 3
    s_mul_i32 s4, s4, 2304
    v_lshl_add_u32 v3, v0, 7, s4
    v_min_u32 v3, L_end - L_pc, v3
    v_cmp_gt_u32 vcc, 18, v0
    s_and_saveexec_b64 s[4:5], vcc
    s_cbranch_execz L_nopf
    global_load_dword v254, v3, s[6:7]
L_nopf:
    s_mov_b64 exec, s[4:5]
    v_lshrrev_b32 v2, 6, v0
    v_and_b32 v1, 63, v0
    v_readfirstlane_b32 s56, v2
    s_and_b32 s3, s2, 7
    s_lshr_b32 s4, s2, 3
    s_lshr_b32 s58, s3, 1
    s_and_b32 s3, s3, 1
    s_lshl_b32 s3, s3, 3
    s_lshr_b32 s5, s4, 2
    s_add_u32 s57, s3, s5
    s_and_b32 s59, s4, 3
    v_lshrrev_b32 v30, 3, v1
    v_and_b32 v31, 7, v1
    v_lshrrev_b32 v32, 4, v1
    s_mul_i32 s7, s56, 36864
    v_mul_u32_u24 v33, 1152, v30
    v_add_u32 v33, s7, v33
    v_xor_b32 v34, v32, v31
    v_lshl_add_u32 v2, v34, 4, v33
    v_xor_b32 v34, 4, v34
    v_lshl_add_u32 v34, v34, 4, v33
    v_add_u32 v3, 0x2000, v34
    v_add_u32 v4, 0x4000, v2
    v_add_u32 v5, 0x6000, v34
    s_and_b32 s3, s59, 1
    s_mul_i32 s95, s59, 9
    s_add_u32 s95, s95, s3
    s_mul_i32 s94, s58, 2304
    s_lshl_b32 s3, s95, 6
    s_add_u32 s94, s94, s3
    s_mul_i32 s7, s56, 147456
    s_add_u32 s3, s7, s94
    v_mul_u32_u24 v33, 9216, v30
    v_add_u32 v33, s3, v33
    v_bfe_u32 v34, v30, 1, 1
    v_lshlrev_b32 v34, 2, v34
    v_xor_b32 v34, v34, v31
    v_lshl_add_u32 v6, v34, 4, v33
    v_add_u32 v7, 72704, v6
    s_mul_i32 s96, s57, 147456
    s_lshl_b32 s97, s59, 1
    s_and_b32 s7, s57, 7
    s_add_u32 s97, s97, s7
    s_cmp_ge_u32 s97, 9
    s_cselect_b32 s7, 9, 0
    s_sub_u32 s97, s97, s7
    s_add_u32 s70, s97, 0
    s_cmp_ge_u32 s70, 9
    s_cselect_b32 s61, 9, 0
    s_sub_u32 s70, s70, s61
    s_lshl_b32 s61, s70, 7
    s_add_u32 s61, s61, s96
    s_mul_i32 s70, s70, 589824
    s_add_u32 s71, s97, 1
    s_cmp_ge_u32 s71, 9
    s_cselect_b32 s62, 9, 0
    s_sub_u32 s71, s71, s62
    s_lshl_b32 s62, s71, 7
    s_add_u32 s62, s62, s96
    s_mul_i32 s71, s71, 589824
    s_lshl_b32 s84, s56, 12
    s_lshl_b32 s85, s56, 11
    s_waitcnt lgkmcnt(0)
    s_mov_b32 s8, s40
    s_and_b32 s9, s41, 0xffff
    s_mov_b32 s10, 2359296
    s_mov_b32 s11, 0x20000
    s_mov_b32 s12, s42
    s_and_b32 s13, s43, 0xffff
    s_mov_b32 s14, 5308416
    s_mov_b32 s15, 0x20000
    s_mov_b32 s20, s44
    s_and_b32 s21, s45, 0xffff
    s_mov_b32 s22, 9216
    s_mov_b32 s23, 0x20000
    v_lshlrev_b32 v34, 2, v0
    buffer_load_dword v36, v34, s[20:23], s94 offen
    s_add_u32 m0, s84, 0
    s_nop 0
    buffer_load_dwordx4 v2, s[8:11], s61 offen offset:0 lds
    buffer_load_dwordx4 v3, s[8:11], s61 offen offset:1024 lds
    buffer_load_dwordx4 v4, s[8:11], s61 offen offset:2048 lds
    buffer_load_dwordx4 v5, s[8:11], s61 offen offset:3072 lds
    s_add_u32 m0, s85, 16384
    s_nop 0
    buffer_load_dwordx4 v6, s[12:15], s70 offen offset:0 lds
    buffer_load_dwordx4 v7, s[12:15], s70 offen offset:1024 lds
    s_add_u32 m0, s84, 24576
    s_nop 0
    buffer_load_dwordx4 v2, s[8:11], s62 offen offset:0 lds
    s_add_u32 s72, s97, 2
    s_cmp_ge_u32 s72, 9
    s_cselect_b32 s63, 9, 0
    s_sub_u32 s72, s72, s63
    s_lshl_b32 s63, s72, 7
    s_add_u32 s63, s63, s96
    s_mul_i32 s72, s72, 589824
    s_add_u32 s73, s97, 3
    s_cmp_ge_u32 s73, 9
    s_cselect_b32 s64, 9, 0
    s_sub_u32 s73, s73, s64
    s_lshl_b32 s64, s73, 7
    s_add_u32 s64, s64, s96
    s_mul_i32 s73, s73, 589824
    s_add_u32 s74, s97, 4
    s_cmp_ge_u32 s74, 9
    s_cselect_b32 s65, 9, 0
    s_sub_u32 s74, s74, s65
    s_lshl_b32 s65, s74, 7
    s_add_u32 s65, s65, s96
    s_mul_i32 s74, s74, 589824
    s_add_u32 s75, s97, 5
    s_cmp_ge_u32 s75, 9
    s_cselect_b32 s66, 9, 0
    s_sub_u32 s75, s75, s66
    s_lshl_b32 s66, s75, 7
    s_add_u32 s66, s66, s96
    s_mul_i32 s75, s75, 589824
    s_add_u32 s76, s97, 6
    s_cmp_ge_u32 s76, 9
    s_cselect_b32 s67, 9, 0
    s_sub_u32 s76, s76, s67
    s_lshl_b32 s67, s76, 7
    s_add_u32 s67, s67, s96
    s_mul_i32 s76, s76, 589824
    s_add_u32 s77, s97, 7
    s_cmp_ge_u32 s77, 9
    s_cselect_b32 s68, 9, 0
    s_sub_u32 s77, s77, s68
    s_lshl_b32 s68, s77, 7
    s_add_u32 s68, s68, s96
    s_mul_i32 s77, s77, 589824
    s_add_u32 s78, s97, 8
    s_cmp_ge_u32 s78, 9
    s_cselect_b32 s69, 9, 0
    s_sub_u32 s78, s78, s69
    s_lshl_b32 s69, s78, 7
    s_add_u32 s69, s69, s96
    s_mul_i32 s78, s78, 589824
    s_and_b32 s4, s56, 1
    s_lshr_b32 s5, s56, 1
    s_mov_b32 s16, s54
    s_and_b32 s17, s55, 0xffff
    s_mov_b32 s18, 268435456
    s_mov_b32 s19, 0x20000
    s_mov_b32 s24, s46
    s_and_b32 s25, s47, 0xffff
    s_mov_b32 s26, 5308416
    s_mov_b32 s27, 0x20000
    s_mov_b32 s28, s50
    s_and_b32 s29, s51, 0xffff
    s_mov_b32 s30, 2359296
    s_mov_b32 s31, 0x20000
    s_mov_b32 s32, s48
    s_and_b32 s33, s49, 0xffff
    s_mov_b32 s34, 1152
    s_mov_b32 s35, 0x20000
    s_mov_b32 s36, s52
    s_and_b32 s37, s53, 0xffff
    s_mov_b32 s38, 256
    s_mov_b32 s39, 0x20000
    s_mov_b32 s89, s2
    s_lshl_b32 s3, s57, 7
    s_add_u32 s3, s3, 50331648
    v_lshl_add_u32 v34, v1, 2, s3
    v_mov_b32 v35, 1073741824
    v_cmp_gt_u32 vcc, 16, v1
    s_lshl_b32 s7, s58, 2
    s_add_u32 s7, s7, s59
    v_cndmask_b32 v242, v35, v34, vcc
    v_cmp_eq_u32 vcc, s7, v0
    buffer_load_dword v29, v242, s[16:19], 0 offen sc1
    s_lshl_b32 s3, s57, 4
    s_lshl_b32 s7, s7, 8
    v_cndmask_b32 v241, v35, v34, vcc
    v_mov_b32 v244, s3
    v_add_u32 v34, s7, v0
    v_cmp_eq_u32 vcc, 0, v34
    s_lshl_b32 s3, s58, 2
    s_lshl_b64 s[90:91], 15, s3
    v_cndmask_b32 v245, v35, v244, vcc
    s_mov_b32 s93, 0
    s_lshl_b32 s92, 0x1111, s59
    v_lshlrev_b32 v31, 21, v0
    v_mov_b32 v32, 1073741824
    buffer_load_dword v254, v31, s[12:15], 0 offen
    buffer_load_dword v254, v31, s[24:27], 0 offen
    s_lshl_b32 s3, s57, 2
    s_add_u32 s7, s3, s58
    s_mul_i32 s7, s7, 294912
    s_add_u32 s7, s7, 0
    v_mul_u32_u24 v33, 0xc000, v0
    v_cmp_gt_u32 vcc, 7, v0
    s_nop 1
    v_cndmask_b32 v31, v32, v33, vcc
    v_cmp_gt_u32 vcc, 4, v0
    buffer_load_dword v254, v31, s[16:19], s7 offen
    s_add_u32 s7, s3, s59
    s_mul_i32 s7, s7, 163840
    s_add_u32 s7, s7, 33554432
    v_cndmask_b32 v31, v32, v33, vcc
    buffer_load_dword v254, v31, s[16:19], s7 offen
    s_mul_i32 s7, s57, 147456
    buffer_load_dword v254, v31, s[28:31], s7 offen
    s_and_b32 s3, s57, 7
    s_lshl_b32 s3, s3, 2
    s_add_u32 s7, s3, s56
    s_mul_i32 s7, s7, 165888
    s_add_u32 s7, s7, s94
    v_mul_u32_u24 v34, 9216, v1
    v_add_u32 v34, s7, v34
    v_cmp_gt_u32 vcc, 18, v1
    s_add_u32 s3, s3, s59
    s_lshr_b32 s3, s3, 1
    s_mul_i32 s3, s3, 82944
    s_mul_i32 s7, s58, 1327104
    v_cndmask_b32 v9, v35, v34, vcc
    v_cmp_gt_u32 vcc, 27, v1
    s_add_u32 s3, s3, s7
    s_mul_i32 s7, s56, 3456
    s_add_u32 s3, s3, s7
    v_lshl_add_u32 v34, v1, 7, s3
    v_cndmask_b32 v21, v35, v34, vcc
    v_and_b32 v30, 31, v1
    v_lshrrev_b32 v31, 5, v1
    v_bfe_u32 v32, v30, 1, 3
    v_xor_b32 v32, v32, v31
    s_lshl_b32 s7, s56, 12
    s_xor_b32 s3, s7, 4096
    v_lshlrev_b32 v33, 7, v30
    v_xor_b32 v34, 0, v32
    v_lshl_add_u32 v34, v34, 4, v33
    v_add_u32 v10, s7, v34
    v_add_u32 v14, s3, v34
    v_xor_b32 v34, 2, v32
    v_lshl_add_u32 v34, v34, 4, v33
    v_add_u32 v11, s7, v34
    v_add_u32 v15, s3, v34
    v_xor_b32 v34, 4, v32
    v_lshl_add_u32 v34, v34, 4, v33
    v_add_u32 v12, s7, v34
    v_add_u32 v16, s3, v34
    v_xor_b32 v34, 6, v32
    v_lshl_add_u32 v34, v34, 4, v33
    v_add_u32 v13, s7, v34
    v_add_u32 v17, s3, v34
    v_lshlrev_b32 v27, 4, v31
    s_lshl_b32 s7, s56, 11
    s_xor_b32 s3, s7, 2048
    v_lshrrev_b32 v34, 4, v30
    v_lshlrev_b32 v34, 10, v34
    v_lshl_add_u32 v34, v31, 8, v34
    v_and_b32 v35, 15, v30
    v_lshl_add_u32 v34, v35, 4, v34
    v_add_u32 v24, s7, v34
    v_add_u32 v25, s3, v34
    v_bfe_u32 v30, v1, 2, 2
    v_lshl_add_u32 v32, v31, 3, v30
    v_bfe_u32 v34, v1, 4, 1
    v_lshlrev_b32 v34, 5, v34
    v_and_b32 v35, 3, v1
    v_lshl_add_u32 v34, v35, 3, v34
    v_lshrrev_b32 v35, 1, v30
    v_xor_b32 v35, s4, v35
    v_lshl_add_u32 v34, v35, 6, v34
    v_lshl_add_u32 v18, v32, 7, v34
    v_add_u32 v19, 0x10000, v18
    v_add_u32 v20, 0x20000, v18
    v_mov_b32 v28, 0xbdd2d3e8
    s_lshl_b32 s3, s57, 2
    s_add_u32 s3, s3, s58
    s_mul_i32 s87, s3, 294912
    s_add_u32 s3, s95, s4
    s_lshl_b32 s3, s3, 13
    s_add_u32 s40, s3, s87
    s_add_u32 s41, s40, 16384
    s_add_u32 s42, s40, 32768
    s_add_u32 s43, s40, 49152
    s_add_u32 s44, s40, 65536
    s_lshl_b32 s3, s4, 7
    s_add_u32 s3, s3, 162560
    v_add_u32 v26, s3, v27
    s_waitcnt vmcnt(13)
    v_lshlrev_b32 v34, 16, v36
    v_and_b32 v35, 0xffff0000, v36
    v_lshlrev_b32 v37, 3, v0
    v_add_u32 v37, 162560, v37
    v_cmp_gt_u32 vcc, 160, v0
    s_and_saveexec_b64 s[94:95], vcc
    ds_write_b64 v37, v[34:35]
    s_mov_b64 exec, s[94:95]
    s_bitcmp1_b32 s59, 0
    s_waitcnt lgkmcnt(0)
    s_cbranch_scc1 L_odd
    buffer_load_dwordx4 v3, s[8:11], s62 offen offset:1024 lds
    buffer_load_dwordx4 v4, s[8:11], s62 offen offset:2048 lds
    buffer_load_dwordx4 v5, s[8:11], s62 offen offset:3072 lds
    s_add_u32 m0, s85, 40960
    s_nop 0
    buffer_load_dwordx4 v6, s[12:15], s71 offen offset:0 lds
    buffer_load_dwordx4 v7, s[12:15], s71 offen offset:1024 lds
    buffer_load_dword v254, v9, s[12:15], 0 offen offset:512
    s_waitcnt vmcnt(13)
    s_barrier
    ds_read_b128 v[212:215], v26 offset:0
    ds_read_b128 v[216:219], v26 offset:32
    ds_read_b128 v[220:223], v26 offset:64
    ds_read_b128 v[224:227], v26 offset:96
    ds_read_b64_tr_b16 v[60:61], v18 offset:16384
    ds_read_b64_tr_b16 v[62:63], v18 offset:16896
    ds_read_b128 a[0:3], v10 offset:0
    ds_read_b128 a[144:147], v14 offset:0
    ds_read_b64_tr_b16 v[64:65], v18 offset:18432
    ds_read_b64_tr_b16 v[66:67], v18 offset:18944
    ds_read_b128 a[4:7], v11 offset:0
    ds_read_b128 a[148:151], v15 offset:0
    s_waitcnt lgkmcnt(8)
    ds_read_b64_tr_b16 v[68:69], v18 offset:20480
    ds_read_b64_tr_b16 v[70:71], v18 offset:20992
    ds_read_b128 a[8:11], v12 offset:0
    ds_read_b128 a[152:155], v16 offset:0
    s_waitcnt lgkmcnt(8)
    v_mfma_f32_32x32x16_bf16 v[116:131], v[60:63], a[0:3], v[212:227]
    s_add_u32 m0, s84, 49152
    ds_read_b64_tr_b16 v[72:73], v18 offset:22528
    ds_read_b64_tr_b16 v[74:75], v18 offset:23040
    buffer_load_dwordx4 v2, s[8:11], s63 offen offset:0 lds
    buffer_load_dwordx4 v3, s[8:11], s63 offen offset:1024 lds
    v_mfma_f32_32x32x16_bf16 v[132:147], v[60:63], a[144:147], v[212:227]
    s_waitcnt lgkmcnt(6)
    ds_read_b128 a[12:15], v13 offset:0
    ds_read_b128 a[156:159], v17 offset:0
    buffer_load_dwordx4 v4, s[8:11], s63 offen offset:2048 lds
    buffer_load_dwordx4 v5, s[8:11], s63 offen offset:3072 lds
    v_mfma_f32_32x32x16_bf16 v[116:131], v[64:67], a[4:7], v[116:131]
    s_add_u32 m0, s85, 65536
    s_waitcnt vmcnt(5)
    s_barrier
    ds_read_b64_tr_b16 v[76:77], v18 offset:40960
    ds_read_b64_tr_b16 v[78:79], v18 offset:41472
    buffer_load_dwordx4 v6, s[12:15], s72 offen offset:0 lds
    buffer_load_dwordx4 v7, s[12:15], s72 offen offset:1024 lds
    v_mfma_f32_32x32x16_bf16 v[132:147], v[64:67], a[148:151], v[132:147]
    s_waitcnt lgkmcnt(6)
    s_add_u32 m0, s84, 73728
    ds_read_b128 a[16:19], v10 offset:24576
    ds_read_b128 a[160:163], v14 offset:24576
    buffer_load_dwordx4 v2, s[8:11], s64 offen offset:0 lds
    buffer_load_dwordx4 v3, s[8:11], s64 offen offset:1024 lds
    v_mfma_f32_32x32x16_bf16 v[116:131], v[68:71], a[8:11], v[116:131]
    ds_read_b64_tr_b16 v[80:81], v18 offset:43008
    ds_read_b64_tr_b16 v[82:83], v18 offset:43520
    buffer_load_dwordx4 v4, s[8:11], s64 offen offset:2048 lds
    buffer_load_dwordx4 v5, s[8:11], s64 offen offset:3072 lds
    s_lshl_b32 s86, s59, 7
    s_add_u32 s94, s58, 1
    s_mul_i32 s95, s5, 36864
    v_mfma_f32_32x32x16_bf16 v[132:147], v[68:71], a[152:155], v[132:147]
    s_waitcnt lgkmcnt(6)
    s_add_u32 m0, s85, 90112
    ds_read_b128 a[20:23], v11 offset:24576
    ds_read_b128 a[164:167], v15 offset:24576
    buffer_load_dwordx4 v6, s[12:15], s73 offen offset:0 lds
    buffer_load_dwordx4 v7, s[12:15], s73 offen offset:1024 lds
    s_mul_i32 s88, s5, 9216
    s_mul_i32 s22, s4, 4096
    s_add_u32 s88, s88, s22
    v_mfma_f32_32x32x16_bf16 v[116:131], v[72:75], a[12:15], v[116:131]
    s_add_u32 m0, s84, 98304
    ds_read_b64_tr_b16 v[60:61], v18 offset:45056
    ds_read_b64_tr_b16 v[62:63], v18 offset:45568
    buffer_load_dwordx4 v2, s[8:11], s65 offen offset:0 lds
    buffer_load_dwordx4 v3, s[8:11], s65 offen offset:1024 lds
    s_mul_i32 s23, s4, 256
    v_add_u32 v30, s23, v1
    v_add_u32 v30, 0, v30
    v_mfma_f32_32x32x16_bf16 v[132:147], v[72:75], a[156:159], v[132:147]
    s_waitcnt lgkmcnt(6)
    ds_read_b128 a[24:27], v12 offset:24576
    ds_read_b128 a[168:171], v16 offset:24576
    buffer_load_dwordx4 v4, s[8:11], s65 offen offset:2048 lds
    buffer_load_dwordx4 v5, s[8:11], s65 offen offset:3072 lds
    v_mul_u32_u24 v31, 3641, v30
    v_lshrrev_b32 v31, 16, v31
    v_mul_u32_u24 v32, 18, v31
    v_mfma_f32_32x32x16_bf16 v[116:131], v[76:79], a[16:19], v[116:131]
    s_add_u32 m0, s85, 114688
    ds_read_b64_tr_b16 v[64:65], v18 offset:47104
    ds_read_b64_tr_b16 v[66:67], v18 offset:47616
    buffer_load_dwordx4 v6, s[12:15], s74 offen offset:0 lds
    buffer_load_dwordx4 v7, s[12:15], s74 offen offset:1024 lds
    v_sub_u32 v32, v30, v32
    v_lshl_add_u32 v32, s94, 2, v32
    v_and_b32 v32, 15, v32
    v_mfma_f32_32x32x16_bf16 v[132:147], v[76:79], a[160:163], v[132:147]
    s_waitcnt lgkmcnt(6)
    s_add_u32 m0, s84, 122880
    ds_read_b128 a[28:31], v13 offset:24576
    ds_read_b128 a[172:175], v17 offset:24576
    buffer_load_dwordx4 v2, s[8:11], s66 offen offset:0 lds
    buffer_load_dwordx4 v3, s[8:11], s66 offen offset:1024 lds
    v_mul_u32_u24 v31, 1152, v31
    v_lshl_add_u32 v31, v32, 4, v31
    v_add_u32 v31, s95, v31
    v_mfma_f32_32x32x16_bf16 v[116:131], v[80:83], a[20:23], v[116:131]
    s_waitcnt vmcnt(14)
    s_barrier
    v_add_u32 v23, 3, v1
    v_lshrrev_b32 v23, v23, v29
    v_and_b32 v23, 1, v23
    v_cmp_eq_u32 vcc, 0, v23
    s_and_b32 s7, vcc_lo, 0xffff
    s_lshl_b32 s7, s7, 3
    s_or_b32 s7, s7, 0x80000000
    v_mov_b32 v243, s7
    buffer_store_dword v243, v245, s[36:39], 0 offen sc1
    ds_read_b64_tr_b16 v[68:69], v19 offset:0
    ds_read_b64_tr_b16 v[70:71], v19 offset:512
    buffer_load_dwordx4 v4, s[8:11], s66 offen offset:2048 lds
    buffer_load_dwordx4 v5, s[8:11], s66 offen offset:3072 lds
    v_subrev_u32 v228, 0, v31
    v_add_u32 v30, s23, v1
    v_add_u32 v30, 64, v30
    v_mfma_f32_32x32x16_bf16 v[132:147], v[80:83], a[164:167], v[132:147]
    s_waitcnt lgkmcnt(6)
    s_add_u32 m0, s85, 139264
    ds_read_b128 a[32:35], v10 offset:49152
    ds_read_b128 a[176:179], v14 offset:49152
    buffer_load_dwordx4 v6, s[12:15], s75 offen offset:0 lds
    buffer_load_dwordx4 v7, s[12:15], s75 offen offset:1024 lds
    v_mul_u32_u24 v31, 3641, v30
    v_lshrrev_b32 v31, 16, v31
    v_mul_u32_u24 v32, 18, v31
    v_mfma_f32_32x32x16_bf16 v[116:131], v[60:63], a[24:27], v[116:131]
    s_add_u32 m0, s84, 0
    ds_read_b64_tr_b16 v[72:73], v19 offset:2048
    ds_read_b64_tr_b16 v[74:75], v19 offset:2560
    buffer_load_dwordx4 v2, s[8:11], s67 offen offset:0 lds
    v_sub_u32 v32, v30, v32
    v_lshl_add_u32 v32, s94, 2, v32
    v_and_b32 v32, 15, v32
    v_mfma_f32_32x32x16_bf16 v[132:147], v[60:63], a[168:171], v[132:147]
    s_waitcnt lgkmcnt(6)
    ds_read_b128 a[36:39], v11 offset:49152
    ds_read_b128 a[180:183], v15 offset:49152
    buffer_load_dwordx4 v3, s[8:11], s67 offen offset:1024 lds
    v_mul_u32_u24 v31, 1152, v31
    v_lshl_add_u32 v31, v32, 4, v31
    v_add_u32 v31, s95, v31
    v_mfma_f32_32x32x16_bf16 v[116:131], v[64:67], a[28:31], v[116:131]
    ds_read_b64_tr_b16 v[76:77], v19 offset:4096
    ds_read_b64_tr_b16 v[78:79], v19 offset:4608
    buffer_load_dwordx4 v4, s[8:11], s67 offen offset:2048 lds
    v_subrev_u32 v229, 1024, v31
    v_add_u32 v30, s23, v1
    v_add_u32 v30, 128, v30
    v_mfma_f32_32x32x16_bf16 v[132:147], v[64:67], a[172:175], v[132:147]
    s_waitcnt lgkmcnt(6)
    ds_read_b128 a[40:43], v12 offset:49152
    ds_read_b128 a[184:187], v16 offset:49152
    buffer_load_dwordx4 v5, s[8:11], s67 offen offset:3072 lds
    v_mul_u32_u24 v31, 3641, v30
    v_lshrrev_b32 v31, 16, v31
    v_mul_u32_u24 v32, 18, v31
    v_mfma_f32_32x32x16_bf16 v[116:131], v[68:71], a[32:35], v[116:131]
    s_add_u32 m0, s85, 16384
    ds_read_b64_tr_b16 v[80:81], v19 offset:6144
    ds_read_b64_tr_b16 v[82:83], v19 offset:6656
    buffer_load_dwordx4 v6, s[12:15], s76 offen offset:0 lds
    buffer_load_dwordx4 v7, s[12:15], s76 offen offset:1024 lds
    v_sub_u32 v32, v30, v32
    v_lshl_add_u32 v32, s94, 2, v32
    v_and_b32 v32, 15, v32
    v_mfma_f32_32x32x16_bf16 v[132:147], v[68:71], a[176:179], v[132:147]
    s_waitcnt lgkmcnt(6)
    ds_read_b128 a[44:47], v13 offset:49152
    ds_read_b128 a[188:191], v17 offset:49152
    v_mul_u32_u24 v31, 1152, v31
    v_lshl_add_u32 v31, v32, 4, v31
    v_add_u32 v31, s95, v31
    v_mfma_f32_32x32x16_bf16 v[116:131], v[72:75], a[36:39], v[116:131]
    s_waitcnt vmcnt(19)
    s_barrier
    v_add_u32 v10, 0x10000, v10
    v_add_u32 v11, 0x10000, v11
    v_add_u32 v12, 0x10000, v12
    v_add_u32 v13, 0x10000, v13
    v_add_u32 v14, 0x10000, v14
    v_add_u32 v15, 0x10000, v15
    v_add_u32 v16, 0x10000, v16
    v_add_u32 v17, 0x10000, v17
    ds_read_b64_tr_b16 v[60:61], v19 offset:24576
    ds_read_b64_tr_b16 v[62:63], v19 offset:25088
    v_subrev_u32 v230, 2048, v31
    v_add_u32 v30, s23, v1
    v_add_u32 v30, 192, v30
    v_mfma_f32_32x32x16_bf16 v[132:147], v[72:75], a[180:183], v[132:147]
    s_waitcnt lgkmcnt(6)
    s_add_u32 m0, s84, 24576
    ds_read_b128 a[48:51], v10 offset:8192
    ds_read_b128 a[192:195], v14 offset:8192
    buffer_load_dwordx4 v2, s[8:11], s68 offen offset:0 lds
    v_mul_u32_u24 v31, 3641, v30
    v_lshrrev_b32 v31, 16, v31
    v_mul_u32_u24 v32, 18, v31
    v_mfma_f32_32x32x16_bf16 v[116:131], v[76:79], a[40:43], v[116:131]
    ds_read_b64_tr_b16 v[64:65], v19 offset:26624
    ds_read_b64_tr_b16 v[66:67], v19 offset:27136
    buffer_load_dwordx4 v3, s[8:11], s68 offen offset:1024 lds
    v_sub_u32 v32, v30, v32
    v_lshl_add_u32 v32, s94, 2, v32
    v_and_b32 v32, 15, v32
    v_mfma_f32_32x32x16_bf16 v[132:147], v[76:79], a[184:187], v[132:147]
    s_waitcnt lgkmcnt(6)
    ds_read_b128 a[52:55], v11 offset:8192
    ds_read_b128 a[196:199], v15 offset:8192
    buffer_load_dwordx4 v4, s[8:11], s68 offen offset:2048 lds
    v_mul_u32_u24 v31, 1152, v31
    v_lshl_add_u32 v31, v32, 4, v31
    v_add_u32 v31, s95, v31
    v_mfma_f32_32x32x16_bf16 v[116:131], v[80:83], a[44:47], v[116:131]
    ds_read_b64_tr_b16 v[68:69], v19 offset:28672
    ds_read_b64_tr_b16 v[70:71], v19 offset:29184
    buffer_load_dwordx4 v5, s[8:11], s68 offen offset:3072 lds
    v_subrev_u32 v231, 3072, v31
    v_add_u32 v30, s23, v1
    v_add_u32 v30, 256, v30
    v_mfma_f32_32x32x16_bf16 v[132:147], v[80:83], a[188:191], v[132:147]
    s_waitcnt lgkmcnt(6)
    s_add_u32 m0, s85, 40960
    ds_read_b128 a[56:59], v12 offset:8192
    ds_read_b128 a[200:203], v16 offset:8192
    buffer_load_dwordx4 v6, s[12:15], s77 offen offset:0 lds
    v_mul_u32_u24 v31, 3641, v30
    v_lshrrev_b32 v31, 16, v31
    v_mul_u32_u24 v32, 18, v31
    v_mfma_f32_32x32x16_bf16 v[116:131], v[60:63], a[48:51], v[116:131]
    ds_read_b64_tr_b16 v[72:73], v19 offset:30720
    ds_read_b64_tr_b16 v[74:75], v19 offset:31232
    buffer_load_dwordx4 v7, s[12:15], s77 offen offset:1024 lds
    v_sub_u32 v32, v30, v32
    v_lshl_add_u32 v32, s94, 2, v32
    v_and_b32 v32, 15, v32
    v_mfma_f32_32x32x16_bf16 v[132:147], v[60:63], a[192:195], v[132:147]
    s_waitcnt lgkmcnt(6)
    ds_read_b128 a[60:63], v13 offset:8192
    ds_read_b128 a[204:207], v17 offset:8192
    v_mul_u32_u24 v31, 1152, v31
    v_lshl_add_u32 v31, v32, 4, v31
    v_add_u32 v31, s95, v31
    v_mfma_f32_32x32x16_bf16 v[116:131], v[64:67], a[52:55], v[116:131]
    s_waitcnt vmcnt(19)
    s_barrier
    ds_read_b64_tr_b16 v[76:77], v19 offset:49152
    ds_read_b64_tr_b16 v[78:79], v19 offset:49664
    v_subrev_u32 v232, 0, v31
    s_lshl_b32 s22, s56, 11
    v_lshl_add_u32 v239, v1, 4, s22
    v_mfma_f32_32x32x16_bf16 v[132:147], v[64:67], a[196:199], v[132:147]
    s_waitcnt lgkmcnt(6)
    s_add_u32 m0, s84, 49152
    ds_read_b128 a[64:67], v10 offset:32768
    ds_read_b128 a[208:211], v14 offset:32768
    buffer_load_dwordx4 v2, s[8:11], s69 offen offset:0 lds
    v_add_u32 v240, 0x2000, v239
    v_lshlrev_b32 v8, 4, v1
    s_mul_i32 s83, s58, 1327104
    v_mfma_f32_32x32x16_bf16 v[116:131], v[68:71], a[56:59], v[116:131]
    ds_read_b64_tr_b16 v[80:81], v19 offset:51200
    ds_read_b64_tr_b16 v[82:83], v19 offset:51712
    ds_read_b128 v[212:215], v26 offset:256
    buffer_load_dwordx4 v3, s[8:11], s69 offen offset:1024 lds
    s_add_u32 s83, s83, s86
    s_add_u32 s22, s59, 0
    s_and_b32 s22, s22, 3
    v_mfma_f32_32x32x16_bf16 v[132:147], v[68:71], a[200:203], v[132:147]
    s_waitcnt lgkmcnt(7)
    ds_read_b128 a[68:71], v11 offset:32768
    ds_read_b128 a[212:215], v15 offset:32768
    buffer_load_dwordx4 v4, s[8:11], s69 offen offset:2048 lds
    s_and_b32 s23, s22, 1
    s_mul_i32 s22, s22, 9
    s_add_u32 s22, s22, s23
    v_mfma_f32_32x32x16_bf16 v[116:131], v[72:75], a[60:63], v[116:131]
    ds_read_b64_tr_b16 v[60:61], v19 offset:53248
    ds_read_b64_tr_b16 v[62:63], v19 offset:53760
    ds_read_b128 v[216:219], v26 offset:288
    buffer_load_dwordx4 v5, s[8:11], s69 offen offset:3072 lds
    s_mul_i32 s50, s22, 36864
    s_lshl_b32 s79, s22, 13
    s_add_u32 s50, s50, s83
    v_mfma_f32_32x32x16_bf16 v[132:147], v[72:75], a[204:207], v[132:147]
    s_waitcnt lgkmcnt(8)
    s_add_u32 m0, s85, 65536
    ds_read_b128 a[72:75], v12 offset:32768
    ds_read_b128 a[216:219], v16 offset:32768
    buffer_load_dwordx4 v6, s[12:15], s78 offen offset:0 lds
    s_add_u32 s79, s79, s87
    s_add_u32 s22, s59, 1
    s_and_b32 s22, s22, 3
    v_mfma_f32_32x32x16_bf16 v[116:131], v[76:79], a[64:67], v[116:131]
    ds_read_b64_tr_b16 v[64:65], v19 offset:55296
    ds_read_b64_tr_b16 v[66:67], v19 offset:55808
    ds_read_b128 v[220:223], v26 offset:320
    buffer_load_dwordx4 v7, s[12:15], s78 offen offset:1024 lds
    s_and_b32 s23, s22, 1
    s_mul_i32 s22, s22, 9
    s_add_u32 s22, s22, s23
    v_mfma_f32_32x32x16_bf16 v[132:147], v[76:79], a[208:211], v[132:147]
    s_waitcnt lgkmcnt(8)
    ds_read_b128 a[76:79], v13 offset:32768
    ds_read_b128 a[220:223], v17 offset:32768
    s_mul_i32 s51, s22, 36864
    s_lshl_b32 s80, s22, 13
    s_add_u32 s51, s51, s83
    v_mfma_f32_32x32x16_bf16 v[116:131], v[80:83], a[68:71], v[116:131]
    s_waitcnt vmcnt(18)
    s_barrier
    ds_read_b64_tr_b16 v[68:69], v20 offset:8192
    ds_read_b64_tr_b16 v[70:71], v20 offset:8704
    ds_read_b128 v[224:227], v26 offset:352
    s_add_u32 s80, s80, s87
    s_add_u32 s22, s59, 2
    s_and_b32 s22, s22, 3
    v_mfma_f32_32x32x16_bf16 v[132:147], v[80:83], a[212:215], v[132:147]
    s_waitcnt lgkmcnt(8)
    v_add_u32 v6, 0x80, v6
    v_add_u32 v7, 0x80, v7
    s_add_u32 m0, s85, 73728
    ds_read_b128 a[80:83], v10 offset:57344
    ds_read_b128 a[224:227], v14 offset:57344
    buffer_load_dwordx4 v6, s[12:15], s70 offen offset:0 lds
    s_and_b32 s23, s22, 1
    s_mul_i32 s22, s22, 9
    s_add_u32 s22, s22, s23
    v_mfma_f32_32x32x16_bf16 v[116:131], v[60:63], a[72:75], v[116:131]
    ds_read_b64_tr_b16 v[72:73], v20 offset:10240
    ds_read_b64_tr_b16 v[74:75], v20 offset:10752
    s_mul_i32 s52, s22, 36864
    s_lshl_b32 s81, s22, 13
    s_add_u32 s52, s52, s83
    v_mfma_f32_32x32x16_bf16 v[132:147], v[60:63], a[216:219], v[132:147]
    s_waitcnt lgkmcnt(7)
    ds_read_b128 a[84:87], v11 offset:57344
    ds_read_b128 a[228:231], v15 offset:57344
    buffer_load_dwordx4 v7, s[12:15], s70 offen offset:1024 lds
    s_add_u32 s81, s81, s87
    s_add_u32 s22, s59, 3
    s_and_b32 s22, s22, 3
    v_mfma_f32_32x32x16_bf16 v[116:131], v[64:67], a[76:79], v[116:131]
    ds_read_b64_tr_b16 v[76:77], v20 offset:12288
    ds_read_b64_tr_b16 v[78:79], v20 offset:12800
    s_and_b32 s23, s22, 1
    s_mul_i32 s22, s22, 9
    s_add_u32 s22, s22, s23
    v_mfma_f32_32x32x16_bf16 v[132:147], v[64:67], a[220:223], v[132:147]
    s_waitcnt lgkmcnt(6)
    s_add_u32 m0, s85, 81920
    ds_read_b128 a[88:91], v12 offset:57344
    ds_read_b128 a[232:235], v16 offset:57344
    buffer_load_dwordx4 v6, s[12:15], s71 offen offset:0 lds
    s_mul_i32 s53, s22, 36864
    s_lshl_b32 s82, s22, 13
    s_add_u32 s53, s53, s83
    v_mfma_f32_32x32x16_bf16 v[116:131], v[68:71], a[80:83], v[116:131]
    ds_read_b64_tr_b16 v[80:81], v20 offset:14336
    ds_read_b64_tr_b16 v[82:83], v20 offset:14848
    buffer_load_dwordx4 v7, s[12:15], s71 offen offset:1024 lds
    s_add_u32 s82, s82, s87
    v_lshrrev_b32 v37, 4, v1
    v_lshlrev_b32 v37, 3, v37
    v_mfma_f32_32x32x16_bf16 v[132:147], v[68:71], a[224:227], v[132:147]
    s_waitcnt lgkmcnt(6)
    s_add_u32 m0, s85, 90112
    ds_read_b128 a[92:95], v13 offset:57344
    ds_read_b128 a[236:239], v17 offset:57344
    buffer_load_dwordx4 v6, s[12:15], s72 offen offset:0 lds
    buffer_load_dwordx4 v7, s[12:15], s72 offen offset:1024 lds
    s_add_u32 s22, s58, 4
    s_and_b32 s22, s22, 3
    s_lshl_b32 s22, s22, 6
    v_mfma_f32_32x32x16_bf16 v[116:131], v[72:75], a[84:87], v[116:131]
    s_waitcnt vmcnt(18)
    s_barrier
    v_add_u32 v10, 0xffff0000, v10
    v_add_u32 v11, 0xffff0000, v11
    v_add_u32 v12, 0xffff0000, v12
    v_add_u32 v13, 0xffff0000, v13
    v_add_u32 v14, 0xffff0000, v14
    v_add_u32 v15, 0xffff0000, v15
    v_add_u32 v16, 0xffff0000, v16
    v_add_u32 v17, 0xffff0000, v17
    ds_read_b64_tr_b16 v[60:61], v18 offset:16384
    ds_read_b64_tr_b16 v[62:63], v18 offset:16896
    s_add_u32 s22, s22, s86
    buffer_load_dwordx2 v[246:247], v37, s[32:35], s22 offen offset:0
    buffer_load_dwordx2 v[248:249], v37, s[32:35], s22 offen offset:32
    v_mfma_f32_32x32x16_bf16 v[132:147], v[72:75], a[228:231], v[132:147]
    s_waitcnt lgkmcnt(6)
    ds_read_b128 a[96:99], v10 offset:0
    ds_read_b128 a[240:243], v14 offset:0
    buffer_load_dword v29, v244, s[36:39], 0 offen sc1
    v_bfe_u32 v30, v1, 5, 1
    v_lshlrev_b32 v30, 4, v30
    v_bfe_u32 v31, v1, 4, 1
    v_mfma_f32_32x32x16_bf16 v[116:131], v[76:79], a[88:91], v[116:131]
    ds_read_b64_tr_b16 v[64:65], v18 offset:18432
    ds_read_b64_tr_b16 v[66:67], v18 offset:18944
    v_lshl_add_u32 v30, v31, 2, v30
    v_bfe_u32 v32, v1, 2, 2
    v_add_u32 v30, v30, v32
    v_mfma_f32_32x32x16_bf16 v[132:147], v[76:79], a[232:235], v[132:147]
    s_waitcnt lgkmcnt(6)
    s_add_u32 m0, s85, 98304
    ds_read_b128 a[100:103], v11 offset:0
    ds_read_b128 a[244:247], v15 offset:0
    buffer_load_dwordx4 v6, s[12:15], s73 offen offset:0 lds
    v_mul_u32_u24 v30, 288, v30
    v_and_b32 v32, 3, v1
    v_lshl_add_u32 v30, v32, 3, v30
    v_mfma_f32_32x32x16_bf16 v[116:131], v[80:83], a[92:95], v[116:131]
    ds_read_b64_tr_b16 v[68:69], v18 offset:20480
    ds_read_b64_tr_b16 v[70:71], v18 offset:20992
    v_mov_b32 v233, v30
    v_add_u32 v34, 0x10000, v239
    v_add_u32 v35, 0x20000, v239
    v_mfma_f32_32x32x16_bf16 v[132:147], v[80:83], a[236:239], v[132:147]
    s_waitcnt lgkmcnt(6)
    ds_read_b128 a[104:107], v12 offset:0
    ds_read_b128 a[248:251], v16 offset:0
    buffer_load_dwordx4 v7, s[12:15], s73 offen offset:1024 lds
    s_lshl_b32 s47, s4, 13
    v_add_u32 v234, 0x10000, v233
    v_add_u32 v235, 0x20000, v233
    v_mfma_f32_32x32x16_bf16 v[116:131], v[60:63], a[96:99], v[116:131]
    ds_read_b64_tr_b16 v[72:73], v18 offset:22528
    ds_read_b64_tr_b16 v[74:75], v18 offset:23040
    v_mfma_f32_32x32x16_bf16 v[132:147], v[60:63], a[240:243], v[132:147]
    s_waitcnt lgkmcnt(6)
    s_add_u32 m0, s85, 106496
    ds_read_b128 a[108:111], v13 offset:0
    ds_read_b128 a[252:255], v17 offset:0
    buffer_load_dwordx4 v6, s[12:15], s74 offen offset:0 lds
    v_mfma_f32_32x32x16_bf16 v[116:131], v[64:67], a[100:103], v[116:131]
    s_waitcnt vmcnt(18)
    s_barrier
    ds_read_b64_tr_b16 v[76:77], v18 offset:40960
    ds_read_b64_tr_b16 v[78:79], v18 offset:41472
    v_mfma_f32_32x32x16_bf16 v[132:147], v[64:67], a[244:247], v[132:147]
    s_waitcnt lgkmcnt(6)
    ds_read_b128 a[112:115], v10 offset:24576
    ds_read_b128 v[148:151], v14 offset:24576
    buffer_load_dwordx4 v7, s[12:15], s74 offen offset:1024 lds
    v_mfma_f32_32x32x16_bf16 v[116:131], v[68:71], a[104:107], v[116:131]
    ds_read_b64_tr_b16 v[80:81], v18 offset:43008
    ds_read_b64_tr_b16 v[82:83], v18 offset:43520
    v_mfma_f32_32x32x16_bf16 v[132:147], v[68:71], a[248:251], v[132:147]
    s_waitcnt lgkmcnt(6)
    s_add_u32 m0, s85, 114688
    ds_read_b128 a[116:119], v11 offset:24576
    ds_read_b128 v[152:155], v15 offset:24576
    buffer_load_dwordx4 v6, s[12:15], s75 offen offset:0 lds
    v_mfma_f32_32x32x16_bf16 v[116:131], v[72:75], a[108:111], v[116:131]
    ds_read_b64_tr_b16 v[60:61], v18 offset:45056
    ds_read_b64_tr_b16 v[62:63], v18 offset:45568
    v_mfma_f32_32x32x16_bf16 v[132:147], v[72:75], a[252:255], v[132:147]
    s_waitcnt lgkmcnt(6)
    ds_read_b128 a[120:123], v12 offset:24576
    ds_read_b128 v[156:159], v16 offset:24576
    buffer_load_dwordx4 v7, s[12:15], s75 offen offset:1024 lds
    v_mfma_f32_32x32x16_bf16 v[116:131], v[76:79], a[112:115], v[116:131]
    ds_read_b64_tr_b16 v[64:65], v18 offset:47104
    ds_read_b64_tr_b16 v[66:67], v18 offset:47616
    v_mfma_f32_32x32x16_bf16 v[132:147], v[76:79], v[148:151], v[132:147]
    s_waitcnt lgkmcnt(6)
    s_add_u32 m0, s85, 122880
    ds_read_b128 a[124:127], v13 offset:24576
    ds_read_b128 v[160:163], v17 offset:24576
    buffer_load_dwordx4 v6, s[12:15], s76 offen offset:0 lds
    v_mfma_f32_32x32x16_bf16 v[116:131], v[80:83], a[116:119], v[116:131]
    s_waitcnt vmcnt(16)
    s_barrier
    s_waitcnt vmcnt(7)
    v_readfirstlane_b32 s60, v29
    s_nop 0
    s_cmp_eq_u32 s60, 0
    s_cbranch_scc1 L_spineN
L_backeN:
    ds_read_b64_tr_b16 v[68:69], v19 offset:0
    ds_read_b64_tr_b16 v[70:71], v19 offset:512
    v_mfma_f32_32x32x16_bf16 v[132:147], v[80:83], v[152:155], v[132:147]
    s_waitcnt lgkmcnt(6)
    ds_read_b128 a[128:131], v10 offset:49152
    ds_read_b128 v[164:167], v14 offset:49152
    v_mfma_f32_32x32x16_bf16 v[116:131], v[60:63], a[120:123], v[116:131]
    ds_read_b64_tr_b16 v[72:73], v19 offset:2048
    ds_read_b64_tr_b16 v[74:75], v19 offset:2560
    buffer_load_dwordx4 v7, s[12:15], s76 offen offset:1024 lds
    v_mfma_f32_32x32x16_bf16 v[132:147], v[60:63], v[156:159], v[132:147]
    s_waitcnt lgkmcnt(6)
    ds_read_b128 a[132:135], v11 offset:49152
    ds_read_b128 v[168:171], v15 offset:49152
    v_mfma_f32_32x32x16_bf16 v[116:131], v[64:67], a[124:127], v[116:131]
    s_add_u32 m0, s85, 131072
    ds_read_b64_tr_b16 v[76:77], v19 offset:4096
    ds_read_b64_tr_b16 v[78:79], v19 offset:4608
    buffer_load_dwordx4 v6, s[12:15], s77 offen offset:0 lds
    v_mfma_f32_32x32x16_bf16 v[132:147], v[64:67], v[160:163], v[132:147]
    s_waitcnt lgkmcnt(6)
    ds_read_b128 a[136:139], v12 offset:49152
    ds_read_b128 v[172:175], v16 offset:49152
    v_mfma_f32_32x32x16_bf16 v[116:131], v[68:71], a[128:131], v[116:131]
    ds_read_b64_tr_b16 v[80:81], v19 offset:6144
    ds_read_b64_tr_b16 v[82:83], v19 offset:6656
    buffer_load_dwordx4 v7, s[12:15], s77 offen offset:1024 lds
    v_mfma_f32_32x32x16_bf16 v[132:147], v[68:71], v[164:167], v[132:147]
    s_waitcnt lgkmcnt(6)
    ds_read_b128 a[140:143], v13 offset:49152
    ds_read_b128 v[176:179], v17 offset:49152
    v_mfma_f32_32x32x16_bf16 v[116:131], v[72:75], a[132:135], v[116:131]
    s_add_u32 m0, s85, 139264
    s_barrier
    ds_read_b64_tr_b16 v[60:61], v19 offset:8192
    buffer_load_dwordx4 v6, s[12:15], s78 offen offset:0 lds
    v_mfma_f32_32x32x16_bf16 v[132:147], v[72:75], v[168:171], v[132:147]
    s_waitcnt lgkmcnt(5)
    ds_read_b64_tr_b16 v[62:63], v19 offset:8704
    v_mfma_f32_32x32x16_bf16 v[116:131], v[76:79], a[136:139], v[116:131]
    ds_read_b64_tr_b16 v[64:65], v19 offset:10240
    buffer_load_dwordx4 v7, s[12:15], s78 offen offset:1024 lds
    v_mfma_f32_32x32x16_bf16 v[132:147], v[76:79], v[172:175], v[132:147]
    s_waitcnt lgkmcnt(3)
    ds_read_b64_tr_b16 v[66:67], v19 offset:10752
    v_mfma_f32_32x32x16_bf16 v[116:131], v[80:83], a[140:143], v[116:131]
    v_add_u32 v6, 0x80, v6
    v_add_u32 v7, 0x80, v7
    s_add_u32 m0, s85, 0
    ds_read_b64_tr_b16 v[68:69], v19 offset:12288
    buffer_load_dwordx4 v6, s[12:15], s70 offen offset:0 lds
    v_mfma_f32_32x32x16_bf16 v[132:147], v[80:83], v[176:179], v[132:147]
    s_waitcnt lgkmcnt(3)
    ds_read_b64_tr_b16 v[70:71], v19 offset:12800
    v_mfma_f32_32x32x16_bf16 v[84:99], v[60:63], a[0:3], v[212:227]
    ds_read_b64_tr_b16 v[72:73], v19 offset:14336
    ds_read_b64_tr_b16 v[74:75], v19 offset:14848
    buffer_load_dwordx4 v7, s[12:15], s70 offen offset:1024 lds
    v_mfma_f32_32x32x16_bf16 v[100:115], v[60:63], a[144:147], v[212:227]
    s_waitcnt lgkmcnt(4)
    ds_read_b64_tr_b16 v[76:77], v19 offset:16384
    ds_read_b64_tr_b16 v[78:79], v19 offset:16896
    v_mfma_f32_32x32x16_bf16 v[84:99], v[64:67], a[4:7], v[84:99]
    s_add_u32 m0, s85, 8192
    ds_read_b64_tr_b16 v[80:81], v19 offset:18432
    buffer_load_dwordx4 v6, s[12:15], s71 offen offset:0 lds
    v_mfma_f32_32x32x16_bf16 v[100:115], v[64:67], a[148:151], v[100:115]
    s_waitcnt lgkmcnt(5)
    ds_read_b64_tr_b16 v[82:83], v19 offset:18944
    v_mfma_f32_32x32x16_bf16 v[84:99], v[68:71], a[8:11], v[84:99]
    ds_read_b64_tr_b16 v[60:61], v19 offset:20480
    buffer_load_dwordx4 v7, s[12:15], s71 offen offset:1024 lds
    v_mul_f32 v38, v116, v116
    v_mul_f32 v39, v117, v117
    v_fmaak_f32 v38, v38, v28, 0xc0135761
    v_mfma_f32_32x32x16_bf16 v[100:115], v[68:71], a[152:155], v[100:115]
    s_waitcnt lgkmcnt(5)
    ds_read_b64_tr_b16 v[62:63], v19 offset:20992
    v_fmaak_f32 v39, v39, v28, 0xc0135761
    v_mul_f32 v38, v38, v116
    v_mul_f32 v39, v39, v117
    v_exp_f32 v38, v38
    v_mfma_f32_32x32x16_bf16 v[84:99], v[72:75], a[12:15], v[84:99]
    s_add_u32 m0, s85, 16384
    ds_read_b64_tr_b16 v[64:65], v19 offset:22528
    buffer_load_dwordx4 v6, s[12:15], s72 offen offset:0 lds
    v_mul_f32 v40, v118, v118
    v_mul_f32 v41, v119, v119
    v_add_f32 v38, 1.0, v38
    v_mfma_f32_32x32x16_bf16 v[100:115], v[72:75], a[156:159], v[100:115]
    s_waitcnt lgkmcnt(5)
    ds_read_b64_tr_b16 v[66:67], v19 offset:23040
    v_exp_f32 v39, v39
    v_fmaak_f32 v40, v40, v28, 0xc0135761
    v_fmaak_f32 v41, v41, v28, 0xc0135761
    v_add_f32 v39, 1.0, v39
    v_mfma_f32_32x32x16_bf16 v[84:99], v[76:79], a[16:19], v[84:99]
    ds_read_b64_tr_b16 v[68:69], v19 offset:24576
    buffer_load_dwordx4 v7, s[12:15], s72 offen offset:1024 lds
    v_rcp_f32 v38, v38
    v_mul_f32 v40, v40, v118
    v_mul_f32 v41, v41, v119
    v_mfma_f32_32x32x16_bf16 v[100:115], v[76:79], a[160:163], v[100:115]
    s_waitcnt lgkmcnt(5)
    ds_read_b64_tr_b16 v[70:71], v19 offset:25088
    v_mul_f32 v38, v38, v116
    v_rcp_f32 v39, v39
    v_nop
    v_mul_f32 v39, v39, v117
    v_mfma_f32_32x32x16_bf16 v[84:99], v[80:83], a[20:23], v[84:99]
    ds_read_b64_tr_b16 v[72:73], v19 offset:26624
    v_exp_f32 v40, v40
    v_mul_f32 v42, v120, v120
    v_mul_f32 v43, v121, v121
    v_add_f32 v40, 1.0, v40
    v_mfma_f32_32x32x16_bf16 v[100:115], v[80:83], a[164:167], v[100:115]
    s_waitcnt lgkmcnt(5)
    ds_read_b64_tr_b16 v[74:75], v19 offset:27136
    v_exp_f32 v41, v41
    v_fmaak_f32 v42, v42, v28, 0xc0135761
    v_fmaak_f32 v43, v43, v28, 0xc0135761
    v_add_f32 v41, 1.0, v41
    v_mfma_f32_32x32x16_bf16 v[84:99], v[60:63], a[24:27], v[84:99]
    s_mov_b32 s20, 0
    ds_read_b64_tr_b16 v[76:77], v19 offset:28672
    buffer_load_dword v254, v21, s[24:27], s20 offen
    v_rcp_f32 v40, v40
    v_mul_f32 v42, v42, v120
    v_mul_f32 v43, v43, v121
    v_mfma_f32_32x32x16_bf16 v[100:115], v[60:63], a[168:171], v[100:115]
    s_waitcnt lgkmcnt(5)
    ds_read_b64_tr_b16 v[78:79], v19 offset:29184
    v_mul_f32 v40, v40, v118
    v_rcp_f32 v41, v41
    v_cvt_pk_bf16_f32 v44, v38, v39
    v_mul_f32 v41, v41, v119
    v_mfma_f32_32x32x16_bf16 v[84:99], v[64:67], a[28:31], v[84:99]
    ds_read_b64_tr_b16 v[80:81], v19 offset:30720
    v_exp_f32 v42, v42
    v_mul_f32 v38, v122, v122
    v_mul_f32 v39, v123, v123
    v_add_f32 v42, 1.0, v42
    v_mfma_f32_32x32x16_bf16 v[100:115], v[64:67], a[172:175], v[100:115]
    s_waitcnt lgkmcnt(5)
    ds_read_b64_tr_b16 v[82:83], v19 offset:31232
    v_exp_f32 v43, v43
    v_fmaak_f32 v38, v38, v28, 0xc0135761
    v_fmaak_f32 v39, v39, v28, 0xc0135761
    v_add_f32 v43, 1.0, v43
    v_mfma_f32_32x32x16_bf16 v[84:99], v[68:71], a[32:35], v[84:99]
    s_waitcnt vmcnt(13)
    s_barrier
    ds_read_b64_tr_b16 v[60:61], v19 offset:32768
    v_rcp_f32 v42, v42
    v_mul_f32 v38, v38, v122
    v_mfma_f32_32x32x16_bf16 v[100:115], v[68:71], a[176:179], v[100:115]
    s_waitcnt lgkmcnt(5)
    ds_read_b64_tr_b16 v[62:63], v19 offset:33280
    v_mul_f32 v39, v39, v123
    v_mul_f32 v42, v42, v120
    v_rcp_f32 v43, v43
    v_cvt_pk_bf16_f32 v45, v40, v41
    v_mfma_f32_32x32x16_bf16 v[84:99], v[72:75], a[36:39], v[84:99]
    s_mov_b32 s20, 13824
    ds_read_b64_tr_b16 v[64:65], v19 offset:34816
    buffer_load_dword v254, v21, s[24:27], s20 offen
    v_mul_f32 v43, v43, v121
    v_exp_f32 v38, v38
    v_mul_f32 v40, v124, v124
    v_mfma_f32_32x32x16_bf16 v[100:115], v[72:75], a[180:183], v[100:115]
    s_waitcnt lgkmcnt(5)
    ds_read_b64_tr_b16 v[66:67], v19 offset:35328
    v_mul_f32 v41, v125, v125
    v_add_f32 v38, 1.0, v38
    v_exp_f32 v39, v39
    v_fmaak_f32 v40, v40, v28, 0xc0135761
    v_mfma_f32_32x32x16_bf16 v[84:99], v[76:79], a[40:43], v[84:99]
    s_add_u32 m0, s85, 24576
    ds_read_b64_tr_b16 v[68:69], v19 offset:36864
    buffer_load_dwordx4 v6, s[12:15], s73 offen offset:0 lds
    v_fmaak_f32 v41, v41, v28, 0xc0135761
    v_add_f32 v39, 1.0, v39
    v_rcp_f32 v38, v38
    v_mfma_f32_32x32x16_bf16 v[100:115], v[76:79], a[184:187], v[100:115]
    s_waitcnt lgkmcnt(5)
    ds_read_b64_tr_b16 v[70:71], v19 offset:37376
    v_mul_f32 v40, v40, v124
    v_mul_f32 v41, v41, v125
    v_mul_f32 v38, v38, v122
    v_rcp_f32 v39, v39
    v_mfma_f32_32x32x16_bf16 v[84:99], v[80:83], a[44:47], v[84:99]
    ds_read_b64_tr_b16 v[72:73], v19 offset:38912
    v_cvt_pk_bf16_f32 v46, v42, v43
    v_mul_f32 v39, v39, v123
    v_exp_f32 v40, v40
    v_mul_f32 v42, v126, v126
    v_mfma_f32_32x32x16_bf16 v[100:115], v[80:83], a[188:191], v[100:115]
    s_waitcnt lgkmcnt(5)
    ds_read_b64_tr_b16 v[74:75], v19 offset:39424
    v_mul_f32 v43, v127, v127
    v_add_f32 v40, 1.0, v40
    v_exp_f32 v41, v41
    v_fmaak_f32 v42, v42, v28, 0xc0135761
    v_mfma_f32_32x32x16_bf16 v[84:99], v[60:63], a[48:51], v[84:99]
    ds_read_b64_tr_b16 v[76:77], v19 offset:40960
    v_fmaak_f32 v43, v43, v28, 0xc0135761
    v_add_f32 v41, 1.0, v41
    v_rcp_f32 v40, v40
    v_mul_f32 v42, v42, v126
    v_mfma_f32_32x32x16_bf16 v[100:115], v[60:63], a[192:195], v[100:115]
    s_waitcnt lgkmcnt(5)
    ds_read_b64_tr_b16 v[78:79], v19 offset:41472
    v_mul_f32 v43, v43, v127
    v_mul_f32 v40, v40, v124
    v_rcp_f32 v41, v41
    v_cvt_pk_bf16_f32 v47, v38, v39
    v_mfma_f32_32x32x16_bf16 v[84:99], v[64:67], a[52:55], v[84:99]
    ds_read_b64_tr_b16 v[80:81], v19 offset:43008
    v_mul_f32 v41, v41, v125
    v_exp_f32 v42, v42
    v_mul_f32 v38, v128, v128
    v_mul_f32 v39, v129, v129
    v_mfma_f32_32x32x16_bf16 v[100:115], v[64:67], a[196:199], v[100:115]
    s_waitcnt lgkmcnt(5)
    ds_read_b64_tr_b16 v[82:83], v19 offset:43520
    v_add_f32 v42, 1.0, v42
    v_exp_f32 v43, v43
    v_fmaak_f32 v38, v38, v28, 0xc0135761
    v_fmaak_f32 v39, v39, v28, 0xc0135761
    v_mfma_f32_32x32x16_bf16 v[84:99], v[68:71], a[56:59], v[84:99]
    ds_read_b64_tr_b16 v[60:61], v19 offset:45056
    ds_read_b128 v[212:215], v26 offset:512
    v_add_f32 v43, 1.0, v43
    v_rcp_f32 v42, v42
    v_mul_f32 v38, v38, v128
    v_mfma_f32_32x32x16_bf16 v[100:115], v[68:71], a[200:203], v[100:115]
    s_waitcnt lgkmcnt(6)
    ds_read_b64_tr_b16 v[62:63], v19 offset:45568
    v_mul_f32 v39, v39, v129
    v_mul_f32 v42, v42, v126
    v_rcp_f32 v43, v43
    v_cvt_pk_bf16_f32 v48, v40, v41
    v_mfma_f32_32x32x16_bf16 v[84:99], v[72:75], a[60:63], v[84:99]
    ds_read_b64_tr_b16 v[64:65], v19 offset:47104
    ds_read_b128 v[216:219], v26 offset:544
    v_mul_f32 v43, v43, v127
    v_exp_f32 v38, v38
    v_mul_f32 v40, v130, v130
    v_mfma_f32_32x32x16_bf16 v[100:115], v[72:75], a[204:207], v[100:115]
    s_waitcnt lgkmcnt(7)
    ds_read_b64_tr_b16 v[66:67], v19 offset:47616
    v_mul_f32 v41, v131, v131
    v_add_f32 v38, 1.0, v38
    v_exp_f32 v39, v39
    v_fmaak_f32 v40, v40, v28, 0xc0135761
    v_mfma_f32_32x32x16_bf16 v[84:99], v[76:79], a[64:67], v[84:99]
    ds_read_b64_tr_b16 v[68:69], v19 offset:49152
    ds_read_b128 v[220:223], v26 offset:576
    v_fmaak_f32 v41, v41, v28, 0xc0135761
    v_add_f32 v39, 1.0, v39
    v_rcp_f32 v38, v38
    v_mfma_f32_32x32x16_bf16 v[100:115], v[76:79], a[208:211], v[100:115]
    s_waitcnt lgkmcnt(8)
    ds_read_b64_tr_b16 v[70:71], v19 offset:49664
    v_mul_f32 v40, v40, v130
    v_mul_f32 v41, v41, v131
    v_mul_f32 v38, v38, v128
    v_rcp_f32 v39, v39
    v_mfma_f32_32x32x16_bf16 v[84:99], v[80:83], a[68:71], v[84:99]
    ds_read_b64_tr_b16 v[72:73], v19 offset:51200
    ds_read_b128 v[224:227], v26 offset:608
    v_cvt_pk_bf16_f32 v49, v42, v43
    v_mul_f32 v39, v39, v129
    v_exp_f32 v40, v40
    v_mfma_f32_32x32x16_bf16 v[100:115], v[80:83], a[212:215], v[100:115]
    s_waitcnt lgkmcnt(8)
    ds_read_b64_tr_b16 v[74:75], v19 offset:51712
    v_mul_f32 v42, v132, v132
    v_mul_f32 v43, v133, v133
    v_add_f32 v40, 1.0, v40
    v_exp_f32 v41, v41
    v_mfma_f32_32x32x16_bf16 v[84:99], v[60:63], a[72:75], v[84:99]
    ds_read_b64_tr_b16 v[76:77], v19 offset:53248
    v_fmaak_f32 v42, v42, v28, 0xc0135761
    v_fmaak_f32 v43, v43, v28, 0xc0135761
    v_add_f32 v41, 1.0, v41
    v_rcp_f32 v40, v40
    v_mfma_f32_32x32x16_bf16 v[100:115], v[60:63], a[216:219], v[100:115]
    s_waitcnt lgkmcnt(7)
    ds_read_b64_tr_b16 v[78:79], v19 offset:53760
    v_mul_f32 v42, v42, v132
    v_mul_f32 v43, v43, v133
    v_mul_f32 v40, v40, v130
    v_rcp_f32 v41, v41
    v_mfma_f32_32x32x16_bf16 v[84:99], v[64:67], a[76:79], v[84:99]
    ds_read_b64_tr_b16 v[80:81], v19 offset:55296
    v_cvt_pk_bf16_f32 v50, v38, v39
    v_mul_f32 v41, v41, v131
    v_exp_f32 v42, v42
    v_mul_f32 v38, v134, v134
    v_mfma_f32_32x32x16_bf16 v[100:115], v[64:67], a[220:223], v[100:115]
    s_waitcnt lgkmcnt(6)
    ds_read_b64_tr_b16 v[82:83], v19 offset:55808
    v_mul_f32 v39, v135, v135
    v_add_f32 v42, 1.0, v42
    v_exp_f32 v43, v43
    v_fmaak_f32 v38, v38, v28, 0xc0135761
    v_mfma_f32_32x32x16_bf16 v[84:99], v[68:71], a[80:83], v[84:99]
    s_waitcnt vmcnt(9)
    s_barrier
    ds_read_b64_tr_b16 v[60:61], v19 offset:57344
    v_fmaak_f32 v39, v39, v28, 0xc0135761
    v_add_f32 v43, 1.0, v43
    v_mfma_f32_32x32x16_bf16 v[100:115], v[68:71], a[224:227], v[100:115]
    s_waitcnt lgkmcnt(5)
    ds_read_b64_tr_b16 v[62:63], v19 offset:57856
    v_rcp_f32 v42, v42
    v_mul_f32 v38, v38, v134
    v_mul_f32 v39, v39, v135
    v_mul_f32 v42, v42, v132
    v_mfma_f32_32x32x16_bf16 v[84:99], v[72:75], a[84:87], v[84:99]
    ds_read_b64_tr_b16 v[64:65], v19 offset:59392
    v_rcp_f32 v43, v43
    v_cvt_pk_bf16_f32 v51, v40, v41
    v_mul_f32 v43, v43, v133
    v_mfma_f32_32x32x16_bf16 v[100:115], v[72:75], a[228:231], v[100:115]
    s_waitcnt lgkmcnt(5)
    ds_read_b64_tr_b16 v[66:67], v19 offset:59904
    v_exp_f32 v38, v38
    v_mul_f32 v40, v136, v136
    v_mul_f32 v41, v137, v137
    v_add_f32 v38, 1.0, v38
    v_mfma_f32_32x32x16_bf16 v[84:99], v[76:79], a[88:91], v[84:99]
    ds_read_b64_tr_b16 v[68:69], v19 offset:61440
    v_exp_f32 v39, v39
    v_fmaak_f32 v40, v40, v28, 0xc0135761
    v_fmaak_f32 v41, v41, v28, 0xc0135761
    v_add_f32 v39, 1.0, v39
    v_mfma_f32_32x32x16_bf16 v[100:115], v[76:79], a[232:235], v[100:115]
    s_waitcnt lgkmcnt(5)
    ds_read_b64_tr_b16 v[70:71], v19 offset:61952
    v_rcp_f32 v38, v38
    v_mul_f32 v40, v40, v136
    v_mul_f32 v41, v41, v137
    v_mul_f32 v38, v38, v134
    v_mfma_f32_32x32x16_bf16 v[84:99], v[80:83], a[92:95], v[84:99]
    ds_read_b64_tr_b16 v[72:73], v19 offset:63488
    v_rcp_f32 v39, v39
    v_cvt_pk_bf16_f32 v52, v42, v43
    v_mul_f32 v39, v39, v135
    v_mfma_f32_32x32x16_bf16 v[100:115], v[80:83], a[236:239], v[100:115]
    s_waitcnt lgkmcnt(5)
    ds_read_b64_tr_b16 v[74:75], v19 offset:64000
    v_exp_f32 v40, v40
    v_mul_f32 v42, v138, v138
    v_mul_f32 v43, v139, v139
    v_add_f32 v40, 1.0, v40
    v_mfma_f32_32x32x16_bf16 v[84:99], v[60:63], a[96:99], v[84:99]
    ds_read_b64_tr_b16 v[76:77], v20 offset:0
    v_exp_f32 v41, v41
    v_fmaak_f32 v42, v42, v28, 0xc0135761
    v_fmaak_f32 v43, v43, v28, 0xc0135761
    v_add_f32 v41, 1.0, v41
    v_mfma_f32_32x32x16_bf16 v[100:115], v[60:63], a[240:243], v[100:115]
    s_waitcnt lgkmcnt(5)
    ds_read_b64_tr_b16 v[78:79], v20 offset:512
    v_rcp_f32 v40, v40
    v_mul_f32 v42, v42, v138
    v_mul_f32 v43, v43, v139
    v_mul_f32 v40, v40, v136
    v_mfma_f32_32x32x16_bf16 v[84:99], v[64:67], a[100:103], v[84:99]
    ds_read_b64_tr_b16 v[80:81], v20 offset:2048
    v_rcp_f32 v41, v41
    v_cvt_pk_bf16_f32 v53, v38, v39
    v_mul_f32 v41, v41, v137
    v_mfma_f32_32x32x16_bf16 v[100:115], v[64:67], a[244:247], v[100:115]
    s_waitcnt lgkmcnt(5)
    ds_read_b64_tr_b16 v[82:83], v20 offset:2560
    v_exp_f32 v42, v42
    v_mul_f32 v38, v140, v140
    v_mul_f32 v39, v141, v141
    v_add_f32 v42, 1.0, v42
    v_mfma_f32_32x32x16_bf16 v[84:99], v[68:71], a[104:107], v[84:99]
    ds_read_b64_tr_b16 v[60:61], v20 offset:4096
    v_exp_f32 v43, v43
    v_fmaak_f32 v38, v38, v28, 0xc0135761
    v_fmaak_f32 v39, v39, v28, 0xc0135761
    v_add_f32 v43, 1.0, v43
    v_mfma_f32_32x32x16_bf16 v[100:115], v[68:71], a[248:251], v[100:115]
    s_waitcnt lgkmcnt(5)
    ds_read_b64_tr_b16 v[62:63], v20 offset:4608
    v_rcp_f32 v42, v42
    v_mul_f32 v38, v38, v140
    v_mul_f32 v39, v39, v141
    v_mul_f32 v42, v42, v138
    v_mfma_f32_32x32x16_bf16 v[84:99], v[72:75], a[108:111], v[84:99]
    ds_read_b64_tr_b16 v[64:65], v20 offset:6144
    v_rcp_f32 v43, v43
    v_cvt_pk_bf16_f32 v54, v40, v41
    v_mul_f32 v43, v43, v139
    v_mfma_f32_32x32x16_bf16 v[100:115], v[72:75], a[252:255], v[100:115]
    s_waitcnt lgkmcnt(5)
    ds_read_b64_tr_b16 v[66:67], v20 offset:6656
    v_exp_f32 v38, v38
    v_mul_f32 v40, v142, v142
    v_mul_f32 v41, v143, v143
    v_add_f32 v38, 1.0, v38
    v_mfma_f32_32x32x16_bf16 v[84:99], v[76:79], a[112:115], v[84:99]
    ds_read_b64_tr_b16 v[68:69], v20 offset:8192
    v_exp_f32 v39, v39
    v_fmaak_f32 v40, v40, v28, 0xc0135761
    v_fmaak_f32 v41, v41, v28, 0xc0135761
    v_add_f32 v39, 1.0, v39
    v_mfma_f32_32x32x16_bf16 v[100:115], v[76:79], v[148:151], v[100:115]
    s_waitcnt lgkmcnt(5)
    ds_read_b64_tr_b16 v[70:71], v20 offset:8704
    v_rcp_f32 v38, v38
    v_mul_f32 v40, v40, v142
    v_mul_f32 v41, v41, v143
    v_mul_f32 v38, v38, v140
    v_mfma_f32_32x32x16_bf16 v[84:99], v[80:83], a[116:119], v[84:99]
    ds_read_b64_tr_b16 v[72:73], v20 offset:10240
    buffer_load_dwordx4 v7, s[12:15], s73 offen offset:1024 lds
    v_rcp_f32 v39, v39
    v_cvt_pk_bf16_f32 v55, v42, v43
    v_mul_f32 v39, v39, v141
    v_mfma_f32_32x32x16_bf16 v[100:115], v[80:83], v[152:155], v[100:115]
    s_waitcnt lgkmcnt(5)
    ds_read_b64_tr_b16 v[74:75], v20 offset:10752
    v_exp_f32 v40, v40
    v_mul_f32 v42, v144, v144
    v_mul_f32 v43, v145, v145
    v_add_f32 v40, 1.0, v40
    v_mfma_f32_32x32x16_bf16 v[84:99], v[60:63], a[120:123], v[84:99]
    s_add_u32 m0, s85, 32768
    ds_read_b64_tr_b16 v[76:77], v20 offset:12288
    buffer_load_dwordx4 v6, s[12:15], s74 offen offset:0 lds
    v_exp_f32 v41, v41
    v_fmaak_f32 v42, v42, v28, 0xc0135761
    v_fmaak_f32 v43, v43, v28, 0xc0135761
    v_mfma_f32_32x32x16_bf16 v[100:115], v[60:63], v[156:159], v[100:115]
    s_waitcnt lgkmcnt(5)
    ds_read_b64_tr_b16 v[78:79], v20 offset:12800
    buffer_load_dwordx4 v7, s[12:15], s74 offen offset:1024 lds
    v_add_f32 v41, 1.0, v41
    v_rcp_f32 v40, v40
    v_mul_f32 v42, v42, v144
    v_mfma_f32_32x32x16_bf16 v[84:99], v[64:67], a[124:127], v[84:99]
    ds_read_b64_tr_b16 v[80:81], v20 offset:14336
    v_mul_f32 v43, v43, v145
    v_mul_f32 v40, v40, v142
    v_rcp_f32 v41, v41
    v_cvt_pk_bf16_f32 v56, v38, v39
    v_mfma_f32_32x32x16_bf16 v[100:115], v[64:67], v[160:163], v[100:115]
    s_waitcnt lgkmcnt(5)
    ds_read_b64_tr_b16 v[82:83], v20 offset:14848
    v_mul_f32 v41, v41, v143
    v_exp_f32 v42, v42
    v_mul_f32 v38, v146, v146
    v_mul_f32 v39, v147, v147
    v_mfma_f32_32x32x16_bf16 v[84:99], v[68:71], a[128:131], v[84:99]
    s_waitcnt vmcnt(6)
    s_barrier
    ds_read_b64_tr_b16 v[60:61], v18 offset:0
    v_add_f32 v42, 1.0, v42
    v_exp_f32 v43, v43
    v_mfma_f32_32x32x16_bf16 v[100:115], v[68:71], v[164:167], v[100:115]
    s_waitcnt lgkmcnt(5)
    ds_read_b64_tr_b16 v[62:63], v18 offset:512
    v_fmaak_f32 v38, v38, v28, 0xc0135761
    v_fmaak_f32 v39, v39, v28, 0xc0135761
    v_add_f32 v43, 1.0, v43
    v_rcp_f32 v42, v42
    v_mfma_f32_32x32x16_bf16 v[84:99], v[72:75], a[132:135], v[84:99]
    s_add_u32 m0, s85, 40960
    ds_read_b64_tr_b16 v[64:65], v18 offset:2048
    buffer_load_dwordx4 v6, s[12:15], s75 offen offset:0 lds
    v_mul_f32 v38, v38, v146
    v_mul_f32 v39, v39, v147
    v_mul_f32 v42, v42, v144
    v_mfma_f32_32x32x16_bf16 v[100:115], v[72:75], v[168:171], v[100:115]
    s_waitcnt lgkmcnt(5)
    ds_read_b64_tr_b16 v[66:67], v18 offset:2560
    buffer_load_dwordx4 v7, s[12:15], s75 offen offset:1024 lds
    v_rcp_f32 v43, v43
    v_cvt_pk_bf16_f32 v57, v40, v41
    v_mul_f32 v43, v43, v145
    v_mfma_f32_32x32x16_bf16 v[84:99], v[76:79], a[136:139], v[84:99]
    ds_read_b64_tr_b16 v[68:69], v18 offset:4096
    v_exp_f32 v38, v38
    v_exp_f32 v39, v39
    v_add_f32 v38, 1.0, v38
    v_mfma_f32_32x32x16_bf16 v[100:115], v[76:79], v[172:175], v[100:115]
    s_waitcnt lgkmcnt(5)
    ds_read_b64_tr_b16 v[70:71], v18 offset:4608
    v_add_f32 v39, 1.0, v39
    v_rcp_f32 v38, v38
    v_rcp_f32 v39, v39
    v_mfma_f32_32x32x16_bf16 v[84:99], v[80:83], a[140:143], v[84:99]
    s_add_u32 m0, s85, 49152
    ds_read_b64_tr_b16 v[72:73], v18 offset:6144
    buffer_load_dwordx4 v6, s[12:15], s76 offen offset:0 lds
    v_mul_f32 v38, v38, v146
    v_cvt_pk_bf16_f32 v58, v42, v43
    v_mul_f32 v39, v39, v147
    v_mfma_f32_32x32x16_bf16 v[100:115], v[80:83], v[176:179], v[100:115]
    s_waitcnt lgkmcnt(5)
    ds_read_b64_tr_b16 v[74:75], v18 offset:6656
    buffer_load_dwordx4 v7, s[12:15], s76 offen offset:1024 lds
    v_cvt_pk_bf16_f32 v59, v38, v39
    v_mfma_f32_32x32x16_bf16 v[180:195], v[60:63], a[0:3], v[212:227]
    s_add_u32 m0, s85, 57344
    ds_read_b64_tr_b16 v[76:77], v18 offset:8192
    buffer_load_dwordx4 v6, s[12:15], s77 offen offset:0 lds
    buffer_store_dwordx4 v[44:47], v24, s[16:19], s40 offen offset:0 sc1
    v_mfma_f32_32x32x16_bf16 v[196:211], v[60:63], a[144:147], v[212:227]
    s_waitcnt lgkmcnt(5)
    ds_read_b64_tr_b16 v[78:79], v18 offset:8704
    buffer_load_dwordx4 v7, s[12:15], s77 offen offset:1024 lds
    buffer_store_dwordx4 v[48:51], v24, s[16:19], s40 offen offset:512 sc1
    v_mfma_f32_32x32x16_bf16 v[180:195], v[64:67], a[4:7], v[180:195]
    s_add_u32 m0, s85, 65536
    ds_read_b64_tr_b16 v[80:81], v18 offset:10240
    buffer_load_dwordx4 v6, s[12:15], s78 offen offset:0 lds
    buffer_store_dwordx4 v[52:55], v25, s[16:19], s40 offen offset:0 sc1
    v_mfma_f32_32x32x16_bf16 v[196:211], v[64:67], a[148:151], v[196:211]
    s_waitcnt lgkmcnt(5)
    ds_read_b64_tr_b16 v[82:83], v18 offset:10752
    buffer_load_dwordx4 v7, s[12:15], s78 offen offset:1024 lds
    buffer_store_dwordx4 v[56:59], v25, s[16:19], s40 offen offset:512 sc1
    v_mfma_f32_32x32x16_bf16 v[180:195], v[68:71], a[8:11], v[180:195]
    ds_read_b64_tr_b16 v[60:61], v18 offset:12288
    v_mul_f32 v38, v84, v84
    v_mul_f32 v39, v85, v85
    v_fmaak_f32 v38, v38, v28, 0xc0135761
    v_fmaak_f32 v39, v39, v28, 0xc0135761
    v_mfma_f32_32x32x16_bf16 v[196:211], v[68:71], a[152:155], v[196:211]
    s_waitcnt lgkmcnt(5)
    ds_read_b64_tr_b16 v[62:63], v18 offset:12800
    v_mul_f32 v38, v38, v84
    v_mul_f32 v39, v39, v85
    v_exp_f32 v38, v38
    v_mul_f32 v40, v86, v86
    v_mfma_f32_32x32x16_bf16 v[180:195], v[72:75], a[12:15], v[180:195]
    ds_read_b64_tr_b16 v[64:65], v18 offset:14336
    v_mul_f32 v41, v87, v87
    v_add_f32 v38, 1.0, v38
    v_exp_f32 v39, v39
    v_fmaak_f32 v40, v40, v28, 0xc0135761
    v_mfma_f32_32x32x16_bf16 v[196:211], v[72:75], a[156:159], v[196:211]
    s_waitcnt lgkmcnt(5)
    ds_read_b64_tr_b16 v[66:67], v18 offset:14848
    v_fmaak_f32 v41, v41, v28, 0xc0135761
    v_add_f32 v39, 1.0, v39
    v_rcp_f32 v38, v38
    v_mul_f32 v40, v40, v86
    v_mfma_f32_32x32x16_bf16 v[180:195], v[76:79], a[16:19], v[180:195]
    ds_read_b64_tr_b16 v[68:69], v18 offset:16384
    v_mul_f32 v41, v41, v87
    v_mul_f32 v38, v38, v84
    v_rcp_f32 v39, v39
    v_nop
    v_mfma_f32_32x32x16_bf16 v[196:211], v[76:79], a[160:163], v[196:211]
    s_waitcnt lgkmcnt(5)
    ds_read_b64_tr_b16 v[70:71], v18 offset:16896
    v_mul_f32 v39, v39, v85
    v_exp_f32 v40, v40
    v_mul_f32 v42, v88, v88
    v_mul_f32 v43, v89, v89
    v_mfma_f32_32x32x16_bf16 v[180:195], v[80:83], a[20:23], v[180:195]
    ds_read_b64_tr_b16 v[72:73], v18 offset:18432
    v_add_f32 v40, 1.0, v40
    v_exp_f32 v41, v41
    v_fmaak_f32 v42, v42, v28, 0xc0135761
    v_fmaak_f32 v43, v43, v28, 0xc0135761
    v_mfma_f32_32x32x16_bf16 v[196:211], v[80:83], a[164:167], v[196:211]
    s_waitcnt lgkmcnt(5)
    ds_read_b64_tr_b16 v[74:75], v18 offset:18944
    v_add_f32 v41, 1.0, v41
    v_rcp_f32 v40, v40
    v_mul_f32 v42, v42, v88
    v_mul_f32 v43, v43, v89
    v_mfma_f32_32x32x16_bf16 v[180:195], v[60:63], a[24:27], v[180:195]
    s_mov_b32 s20, 27648
    ds_read_b64_tr_b16 v[76:77], v18 offset:20480
    buffer_load_dword v254, v21, s[24:27], s20 offen
    v_mul_f32 v40, v40, v86
    v_rcp_f32 v41, v41
    v_cvt_pk_bf16_f32 v44, v38, v39
    v_mfma_f32_32x32x16_bf16 v[196:211], v[60:63], a[168:171], v[196:211]
    s_waitcnt lgkmcnt(5)
    ds_read_b64_tr_b16 v[78:79], v18 offset:20992
    v_mul_f32 v41, v41, v87
    v_exp_f32 v42, v42
    v_mul_f32 v38, v90, v90
    v_mul_f32 v39, v91, v91
    v_mfma_f32_32x32x16_bf16 v[180:195], v[64:67], a[28:31], v[180:195]
    v_add_u32 v6, 0x80, v6
    ds_read_b64_tr_b16 v[80:81], v18 offset:22528
    v_add_f32 v42, 1.0, v42
    v_exp_f32 v43, v43
    v_fmaak_f32 v38, v38, v28, 0xc0135761
    v_fmaak_f32 v39, v39, v28, 0xc0135761
    v_mfma_f32_32x32x16_bf16 v[196:211], v[64:67], a[172:175], v[196:211]
    s_waitcnt lgkmcnt(5)
    ds_read_b64_tr_b16 v[82:83], v18 offset:23040
    v_add_f32 v43, 1.0, v43
    v_rcp_f32 v42, v42
    v_mul_f32 v38, v38, v90
    v_mul_f32 v39, v39, v91
    v_mfma_f32_32x32x16_bf16 v[180:195], v[68:71], a[32:35], v[180:195]
    v_add_u32 v7, 0x80, v7
    s_waitcnt vmcnt(11)
    s_barrier
    ds_read_b64_tr_b16 v[60:61], v18 offset:24576
    v_mul_f32 v42, v42, v88
    v_rcp_f32 v43, v43
    v_mfma_f32_32x32x16_bf16 v[196:211], v[68:71], a[176:179], v[196:211]
    s_waitcnt lgkmcnt(5)
    ds_read_b64_tr_b16 v[62:63], v18 offset:25088
    v_cvt_pk_bf16_f32 v45, v40, v41
    v_mul_f32 v43, v43, v89
    v_exp_f32 v38, v38
    v_mul_f32 v40, v92, v92
    v_mfma_f32_32x32x16_bf16 v[180:195], v[72:75], a[36:39], v[180:195]
    s_add_u32 m0, s85, 73728
    ds_read_b64_tr_b16 v[64:65], v18 offset:26624
    buffer_load_dwordx4 v6, s[12:15], s70 offen offset:0 lds
    v_mul_f32 v41, v93, v93
    v_add_f32 v38, 1.0, v38
    v_exp_f32 v39, v39
    v_mfma_f32_32x32x16_bf16 v[196:211], v[72:75], a[180:183], v[196:211]
    s_waitcnt lgkmcnt(5)
    ds_read_b64_tr_b16 v[66:67], v18 offset:27136
    v_fmaak_f32 v40, v40, v28, 0xc0135761
    v_fmaak_f32 v41, v41, v28, 0xc0135761
    v_add_f32 v39, 1.0, v39
    v_rcp_f32 v38, v38
    v_mfma_f32_32x32x16_bf16 v[180:195], v[76:79], a[40:43], v[180:195]
    ds_read_b64_tr_b16 v[68:69], v18 offset:28672
    v_mul_f32 v40, v40, v92
    v_mul_f32 v41, v41, v93
    v_mul_f32 v38, v38, v90
    v_rcp_f32 v39, v39
    v_mfma_f32_32x32x16_bf16 v[196:211], v[76:79], a[184:187], v[196:211]
    s_waitcnt lgkmcnt(5)
    ds_read_b64_tr_b16 v[70:71], v18 offset:29184
    buffer_load_dwordx4 v7, s[12:15], s70 offen offset:1024 lds
    v_cvt_pk_bf16_f32 v46, v42, v43
    v_mul_f32 v39, v39, v91
    v_exp_f32 v40, v40
    v_mfma_f32_32x32x16_bf16 v[180:195], v[80:83], a[44:47], v[180:195]
    ds_read_b64_tr_b16 v[72:73], v18 offset:30720
    v_mul_f32 v42, v94, v94
    v_mul_f32 v43, v95, v95
    v_add_f32 v40, 1.0, v40
    v_exp_f32 v41, v41
    v_mfma_f32_32x32x16_bf16 v[196:211], v[80:83], a[188:191], v[196:211]
    s_waitcnt lgkmcnt(5)
    ds_read_b64_tr_b16 v[74:75], v18 offset:31232
    v_fmaak_f32 v42, v42, v28, 0xc0135761
    v_fmaak_f32 v43, v43, v28, 0xc0135761
    v_add_f32 v41, 1.0, v41
    v_rcp_f32 v40, v40
    v_mfma_f32_32x32x16_bf16 v[180:195], v[60:63], a[48:51], v[180:195]
    ds_read_b64_tr_b16 v[76:77], v18 offset:32768
    v_mul_f32 v42, v42, v94
    v_mul_f32 v43, v43, v95
    v_mul_f32 v40, v40, v92
    v_rcp_f32 v41, v41
    v_mfma_f32_32x32x16_bf16 v[196:211], v[60:63], a[192:195], v[196:211]
    s_waitcnt lgkmcnt(5)
    ds_read_b64_tr_b16 v[78:79], v18 offset:33280
    v_cvt_pk_bf16_f32 v47, v38, v39
    v_mul_f32 v41, v41, v93
    v_exp_f32 v42, v42
    v_mul_f32 v38, v96, v96
    v_mfma_f32_32x32x16_bf16 v[180:195], v[64:67], a[52:55], v[180:195]
    ds_read_b64_tr_b16 v[80:81], v18 offset:34816
    v_mul_f32 v39, v97, v97
    v_add_f32 v42, 1.0, v42
    v_exp_f32 v43, v43
    v_fmaak_f32 v38, v38, v28, 0xc0135761
    v_mfma_f32_32x32x16_bf16 v[196:211], v[64:67], a[196:199], v[196:211]
    s_waitcnt lgkmcnt(5)
    ds_read_b64_tr_b16 v[82:83], v18 offset:35328
    v_fmaak_f32 v39, v39, v28, 0xc0135761
    v_add_f32 v43, 1.0, v43
    v_rcp_f32 v42, v42
    v_mul_f32 v38, v38, v96
    v_mfma_f32_32x32x16_bf16 v[180:195], v[68:71], a[56:59], v[180:195]
    ds_read_b64_tr_b16 v[60:61], v18 offset:36864
    ds_read_b128 v[212:215], v26 offset:768
    v_mul_f32 v39, v39, v97
    v_mul_f32 v42, v42, v94
    v_rcp_f32 v43, v43
    v_mfma_f32_32x32x16_bf16 v[196:211], v[68:71], a[200:203], v[196:211]
    s_waitcnt lgkmcnt(6)
    ds_read_b64_tr_b16 v[62:63], v18 offset:37376
    v_cvt_pk_bf16_f32 v48, v40, v41
    v_mul_f32 v43, v43, v95
    v_exp_f32 v38, v38
    v_mul_f32 v40, v98, v98
    v_mfma_f32_32x32x16_bf16 v[180:195], v[72:75], a[60:63], v[180:195]
    s_add_u32 m0, s85, 81920
    ds_read_b64_tr_b16 v[64:65], v18 offset:38912
    ds_read_b128 v[216:219], v26 offset:800
    buffer_load_dwordx4 v6, s[12:15], s71 offen offset:0 lds
    v_mul_f32 v41, v99, v99
    v_add_f32 v38, 1.0, v38
    v_mfma_f32_32x32x16_bf16 v[196:211], v[72:75], a[204:207], v[196:211]
    s_waitcnt lgkmcnt(7)
    ds_read_b64_tr_b16 v[66:67], v18 offset:39424
    v_exp_f32 v39, v39
    v_fmaak_f32 v40, v40, v28, 0xc0135761
    v_fmaak_f32 v41, v41, v28, 0xc0135761
    v_add_f32 v39, 1.0, v39
    v_mfma_f32_32x32x16_bf16 v[180:195], v[76:79], a[64:67], v[180:195]
    ds_read_b64_tr_b16 v[68:69], v18 offset:40960
    ds_read_b128 v[220:223], v26 offset:832
    v_rcp_f32 v38, v38
    v_mul_f32 v40, v40, v98
    v_mul_f32 v41, v41, v99
    v_mfma_f32_32x32x16_bf16 v[196:211], v[76:79], a[208:211], v[196:211]
    s_waitcnt lgkmcnt(8)
    ds_read_b64_tr_b16 v[70:71], v18 offset:41472
    v_mul_f32 v38, v38, v96
    v_rcp_f32 v39, v39
    v_cvt_pk_bf16_f32 v49, v42, v43
    v_mul_f32 v39, v39, v97
    v_mfma_f32_32x32x16_bf16 v[180:195], v[80:83], a[68:71], v[180:195]
    ds_read_b64_tr_b16 v[72:73], v18 offset:43008
    ds_read_b128 v[224:227], v26 offset:864
    v_exp_f32 v40, v40
    v_mul_f32 v42, v100, v100
    v_mul_f32 v43, v101, v101
    v_mfma_f32_32x32x16_bf16 v[196:211], v[80:83], a[212:215], v[196:211]
    s_waitcnt lgkmcnt(8)
    ds_read_b64_tr_b16 v[74:75], v18 offset:43520
    v_add_f32 v40, 1.0, v40
    v_exp_f32 v41, v41
    v_fmaak_f32 v42, v42, v28, 0xc0135761
    v_fmaak_f32 v43, v43, v28, 0xc0135761
    v_mfma_f32_32x32x16_bf16 v[180:195], v[60:63], a[72:75], v[180:195]
    ds_read_b64_tr_b16 v[76:77], v18 offset:45056
    buffer_load_dwordx4 v7, s[12:15], s71 offen offset:1024 lds
    v_add_f32 v41, 1.0, v41
    v_rcp_f32 v40, v40
    v_mul_f32 v42, v42, v100
    v_mfma_f32_32x32x16_bf16 v[196:211], v[60:63], a[216:219], v[196:211]
    s_waitcnt lgkmcnt(7)
    ds_read_b64_tr_b16 v[78:79], v18 offset:45568
    v_mul_f32 v43, v43, v101
    v_mul_f32 v40, v40, v98
    v_rcp_f32 v41, v41
    v_cvt_pk_bf16_f32 v50, v38, v39
    v_mfma_f32_32x32x16_bf16 v[180:195], v[64:67], a[76:79], v[180:195]
    ds_read_b64_tr_b16 v[80:81], v18 offset:47104
    v_mul_f32 v41, v41, v99
    v_exp_f32 v42, v42
    v_mul_f32 v38, v102, v102
    v_mul_f32 v39, v103, v103
    v_mfma_f32_32x32x16_bf16 v[196:211], v[64:67], a[220:223], v[196:211]
    s_waitcnt lgkmcnt(6)
    ds_read_b64_tr_b16 v[82:83], v18 offset:47616
    v_add_f32 v42, 1.0, v42
    v_exp_f32 v43, v43
    v_fmaak_f32 v38, v38, v28, 0xc0135761
    v_fmaak_f32 v39, v39, v28, 0xc0135761
    v_mfma_f32_32x32x16_bf16 v[180:195], v[68:71], a[80:83], v[180:195]
    s_waitcnt vmcnt(6)
    s_barrier
    ds_read_b64_tr_b16 v[60:61], v18 offset:49152
    v_add_f32 v43, 1.0, v43
    v_rcp_f32 v42, v42
    v_mfma_f32_32x32x16_bf16 v[196:211], v[68:71], a[224:227], v[196:211]
    s_waitcnt lgkmcnt(5)
    ds_read_b64_tr_b16 v[62:63], v18 offset:49664
    v_mul_f32 v38, v38, v102
    v_mul_f32 v39, v39, v103
    v_mul_f32 v42, v42, v100
    v_rcp_f32 v43, v43
    v_mfma_f32_32x32x16_bf16 v[180:195], v[72:75], a[84:87], v[180:195]
    ds_read_b64_tr_b16 v[64:65], v18 offset:51200
    v_cvt_pk_bf16_f32 v51, v40, v41
    v_mul_f32 v43, v43, v101
    v_exp_f32 v38, v38
    v_mul_f32 v40, v104, v104
    v_mfma_f32_32x32x16_bf16 v[196:211], v[72:75], a[228:231], v[196:211]
    s_waitcnt lgkmcnt(5)
    ds_read_b64_tr_b16 v[66:67], v18 offset:51712
    v_mul_f32 v41, v105, v105
    v_add_f32 v38, 1.0, v38
    v_exp_f32 v39, v39
    v_fmaak_f32 v40, v40, v28, 0xc0135761
    v_mfma_f32_32x32x16_bf16 v[180:195], v[76:79], a[88:91], v[180:195]
    ds_read_b64_tr_b16 v[68:69], v18 offset:53248
    v_fmaak_f32 v41, v41, v28, 0xc0135761
    v_add_f32 v39, 1.0, v39
    v_rcp_f32 v38, v38
    v_mul_f32 v40, v40, v104
    v_mfma_f32_32x32x16_bf16 v[196:211], v[76:79], a[232:235], v[196:211]
    s_waitcnt lgkmcnt(5)
    ds_read_b64_tr_b16 v[70:71], v18 offset:53760
    v_mul_f32 v41, v41, v105
    v_mul_f32 v38, v38, v102
    v_rcp_f32 v39, v39
    v_cvt_pk_bf16_f32 v52, v42, v43
    v_mfma_f32_32x32x16_bf16 v[180:195], v[80:83], a[92:95], v[180:195]
    ds_read_b64_tr_b16 v[72:73], v18 offset:55296
    v_mul_f32 v39, v39, v103
    v_exp_f32 v40, v40
    v_mul_f32 v42, v106, v106
    v_mul_f32 v43, v107, v107
    v_mfma_f32_32x32x16_bf16 v[196:211], v[80:83], a[236:239], v[196:211]
    s_waitcnt lgkmcnt(5)
    ds_read_b64_tr_b16 v[74:75], v18 offset:55808
    v_add_f32 v40, 1.0, v40
    v_exp_f32 v41, v41
    v_fmaak_f32 v42, v42, v28, 0xc0135761
    v_fmaak_f32 v43, v43, v28, 0xc0135761
    v_mfma_f32_32x32x16_bf16 v[180:195], v[60:63], a[96:99], v[180:195]
    ds_read_b64_tr_b16 v[76:77], v18 offset:57344
    v_add_f32 v41, 1.0, v41
    v_rcp_f32 v40, v40
    v_mul_f32 v42, v42, v106
    v_mul_f32 v43, v43, v107
    v_mfma_f32_32x32x16_bf16 v[196:211], v[60:63], a[240:243], v[196:211]
    s_waitcnt lgkmcnt(5)
    ds_read_b64_tr_b16 v[78:79], v18 offset:57856
    v_mul_f32 v40, v40, v104
    v_rcp_f32 v41, v41
    v_cvt_pk_bf16_f32 v53, v38, v39
    v_mul_f32 v41, v41, v105
    v_mfma_f32_32x32x16_bf16 v[180:195], v[64:67], a[100:103], v[180:195]
    s_add_u32 m0, s85, 90112
    ds_read_b64_tr_b16 v[80:81], v18 offset:59392
    buffer_load_dwordx4 v6, s[12:15], s72 offen offset:0 lds
    v_exp_f32 v42, v42
    v_mul_f32 v38, v108, v108
    v_mul_f32 v39, v109, v109
    v_mfma_f32_32x32x16_bf16 v[196:211], v[64:67], a[244:247], v[196:211]
    s_waitcnt lgkmcnt(5)
    ds_read_b64_tr_b16 v[82:83], v18 offset:59904
    buffer_load_dwordx4 v7, s[12:15], s72 offen offset:1024 lds
    v_add_f32 v42, 1.0, v42
    v_exp_f32 v43, v43
    v_fmaak_f32 v38, v38, v28, 0xc0135761
    v_mfma_f32_32x32x16_bf16 v[180:195], v[68:71], a[104:107], v[180:195]
    s_add_u32 m0, s85, 98304
    ds_read_b64_tr_b16 v[60:61], v18 offset:61440
    buffer_load_dwordx4 v6, s[12:15], s73 offen offset:0 lds
    v_fmaak_f32 v39, v39, v28, 0xc0135761
    v_add_f32 v43, 1.0, v43
    v_rcp_f32 v42, v42
    v_mfma_f32_32x32x16_bf16 v[196:211], v[68:71], a[248:251], v[196:211]
    s_waitcnt lgkmcnt(5)
    ds_read_b64_tr_b16 v[62:63], v18 offset:61952
    buffer_load_dwordx4 v7, s[12:15], s73 offen offset:1024 lds
    v_mul_f32 v38, v38, v108
    v_mul_f32 v39, v39, v109
    v_mul_f32 v42, v42, v106
    v_mfma_f32_32x32x16_bf16 v[180:195], v[72:75], a[108:111], v[180:195]
    s_add_u32 m0, s85, 106496
    ds_read_b64_tr_b16 v[64:65], v18 offset:63488
    buffer_load_dwordx4 v6, s[12:15], s74 offen offset:0 lds
    v_rcp_f32 v43, v43
    v_cvt_pk_bf16_f32 v54, v40, v41
    v_mul_f32 v43, v43, v107
    v_mfma_f32_32x32x16_bf16 v[196:211], v[72:75], a[252:255], v[196:211]
    s_waitcnt lgkmcnt(5)
    ds_read_b64_tr_b16 v[66:67], v18 offset:64000
    buffer_load_dwordx4 v7, s[12:15], s74 offen offset:1024 lds
    v_exp_f32 v38, v38
    v_mul_f32 v40, v110, v110
    v_mul_f32 v41, v111, v111
    v_mfma_f32_32x32x16_bf16 v[180:195], v[76:79], a[112:115], v[180:195]
    ds_read_b64_tr_b16 v[68:69], v19 offset:0
    v_add_f32 v38, 1.0, v38
    v_exp_f32 v39, v39
    v_fmaak_f32 v40, v40, v28, 0xc0135761
    v_fmaak_f32 v41, v41, v28, 0xc0135761
    v_mfma_f32_32x32x16_bf16 v[196:211], v[76:79], v[148:151], v[196:211]
    s_waitcnt lgkmcnt(5)
    ds_read_b64_tr_b16 v[70:71], v19 offset:512
    v_add_f32 v39, 1.0, v39
    v_rcp_f32 v38, v38
    v_mul_f32 v40, v40, v110
    v_mul_f32 v41, v41, v111
    v_mfma_f32_32x32x16_bf16 v[180:195], v[80:83], a[116:119], v[180:195]
    s_add_u32 m0, s85, 114688
    ds_read_b64_tr_b16 v[72:73], v19 offset:2048
    buffer_load_dwordx4 v6, s[12:15], s75 offen offset:0 lds
    v_mul_f32 v38, v38, v108
    v_rcp_f32 v39, v39
    v_cvt_pk_bf16_f32 v55, v42, v43
    v_mfma_f32_32x32x16_bf16 v[196:211], v[80:83], v[152:155], v[196:211]
    s_waitcnt lgkmcnt(5)
    ds_read_b64_tr_b16 v[74:75], v19 offset:2560
    buffer_load_dwordx4 v7, s[12:15], s75 offen offset:1024 lds
    v_mul_f32 v39, v39, v109
    v_exp_f32 v40, v40
    v_mul_f32 v42, v112, v112
    v_mfma_f32_32x32x16_bf16 v[180:195], v[60:63], a[120:123], v[180:195]
    ds_read_b64_tr_b16 v[76:77], v19 offset:4096
    v_mul_f32 v43, v113, v113
    v_add_f32 v40, 1.0, v40
    v_exp_f32 v41, v41
    v_fmaak_f32 v42, v42, v28, 0xc0135761
    v_mfma_f32_32x32x16_bf16 v[196:211], v[60:63], v[156:159], v[196:211]
    s_waitcnt lgkmcnt(5)
    ds_read_b64_tr_b16 v[78:79], v19 offset:4608
    v_fmaak_f32 v43, v43, v28, 0xc0135761
    v_add_f32 v41, 1.0, v41
    v_rcp_f32 v40, v40
    v_mul_f32 v42, v42, v112
    v_mfma_f32_32x32x16_bf16 v[180:195], v[64:67], a[124:127], v[180:195]
    s_add_u32 m0, s85, 0
    ds_read_b64_tr_b16 v[80:81], v19 offset:6144
    buffer_load_dwordx4 v6, s[12:15], s76 offen offset:0 lds
    v_mul_f32 v43, v43, v113
    v_mul_f32 v40, v40, v110
    v_rcp_f32 v41, v41
    v_mfma_f32_32x32x16_bf16 v[196:211], v[64:67], v[160:163], v[196:211]
    s_waitcnt lgkmcnt(5)
    ds_read_b64_tr_b16 v[82:83], v19 offset:6656
    v_cvt_pk_bf16_f32 v56, v38, v39
    v_mul_f32 v41, v41, v111
    v_exp_f32 v42, v42
    v_mul_f32 v38, v114, v114
    v_mfma_f32_32x32x16_bf16 v[180:195], v[68:71], a[128:131], v[180:195]
    s_waitcnt vmcnt(7)
    s_barrier
    ds_read_b64_tr_b16 v[60:61], v19 offset:8192
    buffer_load_dwordx4 v7, s[12:15], s76 offen offset:1024 lds
    v_mul_f32 v39, v115, v115
    v_add_f32 v42, 1.0, v42
    v_mfma_f32_32x32x16_bf16 v[196:211], v[68:71], v[164:167], v[196:211]
    s_waitcnt lgkmcnt(5)
    ds_read_b64_tr_b16 v[62:63], v19 offset:8704
    v_exp_f32 v43, v43
    v_fmaak_f32 v38, v38, v28, 0xc0135761
    v_fmaak_f32 v39, v39, v28, 0xc0135761
    v_add_f32 v43, 1.0, v43
    v_mfma_f32_32x32x16_bf16 v[180:195], v[72:75], a[132:135], v[180:195]
    s_add_u32 m0, s85, 8192
    ds_read_b64_tr_b16 v[64:65], v19 offset:10240
    buffer_load_dwordx4 v6, s[12:15], s77 offen offset:0 lds
    v_rcp_f32 v42, v42
    v_mul_f32 v38, v38, v114
    v_mul_f32 v39, v39, v115
    v_mfma_f32_32x32x16_bf16 v[196:211], v[72:75], v[168:171], v[196:211]
    s_waitcnt lgkmcnt(5)
    ds_read_b64_tr_b16 v[66:67], v19 offset:10752
    v_mul_f32 v42, v42, v112
    v_rcp_f32 v43, v43
    v_cvt_pk_bf16_f32 v57, v40, v41
    v_mul_f32 v43, v43, v113
    v_mfma_f32_32x32x16_bf16 v[180:195], v[76:79], a[136:139], v[180:195]
    ds_read_b64_tr_b16 v[68:69], v19 offset:12288
    buffer_load_dwordx4 v7, s[12:15], s77 offen offset:1024 lds
    v_exp_f32 v38, v38
    v_exp_f32 v39, v39
    v_mfma_f32_32x32x16_bf16 v[196:211], v[76:79], v[172:175], v[196:211]
    s_waitcnt lgkmcnt(5)
    ds_read_b64_tr_b16 v[70:71], v19 offset:12800
    v_add_f32 v38, 1.0, v38
    v_add_f32 v39, 1.0, v39
    v_rcp_f32 v38, v38
    v_mfma_f32_32x32x16_bf16 v[180:195], v[80:83], a[140:143], v[180:195]
    s_add_u32 m0, s85, 16384
    ds_read_b64_tr_b16 v[72:73], v19 offset:14336
    buffer_load_dwordx4 v6, s[12:15], s78 offen offset:0 lds
    v_rcp_f32 v39, v39
    v_mul_f32 v38, v38, v114
    v_cvt_pk_bf16_f32 v58, v42, v43
    v_mfma_f32_32x32x16_bf16 v[196:211], v[80:83], v[176:179], v[196:211]
    s_waitcnt lgkmcnt(5)
    ds_read_b64_tr_b16 v[74:75], v19 offset:14848
    v_mul_f32 v39, v39, v115
    v_cvt_pk_bf16_f32 v59, v38, v39
    v_mfma_f32_32x32x16_bf16 v[116:131], v[60:63], a[0:3], v[212:227]
    ds_read_b64_tr_b16 v[76:77], v19 offset:16384
    buffer_load_dwordx4 v7, s[12:15], s78 offen offset:1024 lds
    buffer_store_dwordx4 v[44:47], v24, s[16:19], s41 offen offset:0 sc1
    s_nop 1
    v_mfma_f32_32x32x16_bf16 v[132:147], v[60:63], a[144:147], v[212:227]
    s_waitcnt lgkmcnt(5)
    ds_read_b64_tr_b16 v[78:79], v19 offset:16896
    buffer_store_dwordx4 v[48:51], v24, s[16:19], s41 offen offset:512 sc1
    v_mfma_f32_32x32x16_bf16 v[116:131], v[64:67], a[4:7], v[116:131]
    v_add_u32 v6, 0x80, v6
    ds_read_b64_tr_b16 v[80:81], v19 offset:18432
    buffer_store_dwordx4 v[52:55], v25, s[16:19], s41 offen offset:0 sc1
    v_mfma_f32_32x32x16_bf16 v[132:147], v[64:67], a[148:151], v[132:147]
    s_waitcnt lgkmcnt(5)
    ds_read_b64_tr_b16 v[82:83], v19 offset:18944
    buffer_store_dwordx4 v[56:59], v25, s[16:19], s41 offen offset:512 sc1
    v_mfma_f32_32x32x16_bf16 v[116:131], v[68:71], a[8:11], v[116:131]
    v_add_u32 v7, 0x80, v7
    ds_read_b64_tr_b16 v[60:61], v19 offset:20480
    v_mul_f32 v38, v180, v180
    v_mul_f32 v39, v181, v181
    v_fmaak_f32 v38, v38, v28, 0xc0135761
    v_fmaak_f32 v39, v39, v28, 0xc0135761
    v_mfma_f32_32x32x16_bf16 v[132:147], v[68:71], a[152:155], v[132:147]
    s_waitcnt lgkmcnt(5)
    ds_read_b64_tr_b16 v[62:63], v19 offset:20992
    v_mul_f32 v38, v38, v180
    v_mul_f32 v39, v39, v181
    v_exp_f32 v38, v38
    v_mul_f32 v40, v182, v182
    v_mfma_f32_32x32x16_bf16 v[116:131], v[72:75], a[12:15], v[116:131]
    s_add_u32 m0, s85, 24576
    ds_read_b64_tr_b16 v[64:65], v19 offset:22528
    buffer_load_dwordx4 v6, s[12:15], s70 offen offset:0 lds
    v_mul_f32 v41, v183, v183
    v_add_f32 v38, 1.0, v38
    v_exp_f32 v39, v39
    v_mfma_f32_32x32x16_bf16 v[132:147], v[72:75], a[156:159], v[132:147]
    s_waitcnt lgkmcnt(5)
    ds_read_b64_tr_b16 v[66:67], v19 offset:23040
    v_fmaak_f32 v40, v40, v28, 0xc0135761
    v_fmaak_f32 v41, v41, v28, 0xc0135761
    v_add_f32 v39, 1.0, v39
    v_rcp_f32 v38, v38
    v_mfma_f32_32x32x16_bf16 v[116:131], v[76:79], a[16:19], v[116:131]
    ds_read_b64_tr_b16 v[68:69], v19 offset:24576
    buffer_load_dwordx4 v7, s[12:15], s70 offen offset:1024 lds
    v_mul_f32 v40, v40, v182
    v_mul_f32 v41, v41, v183
    v_mul_f32 v38, v38, v180
    v_mfma_f32_32x32x16_bf16 v[132:147], v[76:79], a[160:163], v[132:147]
    s_waitcnt lgkmcnt(5)
    ds_read_b64_tr_b16 v[70:71], v19 offset:25088
    v_rcp_f32 v39, v39
    v_nop
    v_mul_f32 v39, v39, v181
    v_mfma_f32_32x32x16_bf16 v[116:131], v[80:83], a[20:23], v[116:131]
    s_add_u32 m0, s85, 32768
    ds_read_b64_tr_b16 v[72:73], v19 offset:26624
    buffer_load_dwordx4 v6, s[12:15], s71 offen offset:0 lds
    v_exp_f32 v40, v40
    v_mul_f32 v42, v184, v184
    v_mul_f32 v43, v185, v185
    v_mfma_f32_32x32x16_bf16 v[132:147], v[80:83], a[164:167], v[132:147]
    s_waitcnt lgkmcnt(5)
    ds_read_b64_tr_b16 v[74:75], v19 offset:27136
    v_add_f32 v40, 1.0, v40
    v_exp_f32 v41, v41
    v_fmaak_f32 v42, v42, v28, 0xc0135761
    v_fmaak_f32 v43, v43, v28, 0xc0135761
    v_mfma_f32_32x32x16_bf16 v[116:131], v[60:63], a[24:27], v[116:131]
    ds_read_b64_tr_b16 v[76:77], v19 offset:28672
    buffer_load_dwordx4 v7, s[12:15], s71 offen offset:1024 lds
    v_add_f32 v41, 1.0, v41
    v_rcp_f32 v40, v40
    v_mul_f32 v42, v42, v184
    v_mfma_f32_32x32x16_bf16 v[132:147], v[60:63], a[168:171], v[132:147]
    s_waitcnt lgkmcnt(5)
    ds_read_b64_tr_b16 v[78:79], v19 offset:29184
    v_mul_f32 v43, v43, v185
    v_mul_f32 v40, v40, v182
    v_rcp_f32 v41, v41
    v_cvt_pk_bf16_f32 v44, v38, v39
    v_mfma_f32_32x32x16_bf16 v[116:131], v[64:67], a[28:31], v[116:131]
    s_add_u32 m0, s85, 40960
    ds_read_b64_tr_b16 v[80:81], v19 offset:30720
    buffer_load_dwordx4 v6, s[12:15], s72 offen offset:0 lds
    v_mul_f32 v41, v41, v183
    v_exp_f32 v42, v42
    v_mul_f32 v38, v186, v186
    v_mfma_f32_32x32x16_bf16 v[132:147], v[64:67], a[172:175], v[132:147]
    s_waitcnt lgkmcnt(5)
    ds_read_b64_tr_b16 v[82:83], v19 offset:31232
    v_mul_f32 v39, v187, v187
    v_add_f32 v42, 1.0, v42
    v_exp_f32 v43, v43
    v_fmaak_f32 v38, v38, v28, 0xc0135761
    v_mfma_f32_32x32x16_bf16 v[116:131], v[68:71], a[32:35], v[116:131]
    s_waitcnt vmcnt(15)
    s_barrier
    ds_read_b64_tr_b16 v[60:61], v19 offset:32768
    buffer_load_dwordx4 v7, s[12:15], s72 offen offset:1024 lds
    v_fmaak_f32 v39, v39, v28, 0xc0135761
    v_add_f32 v43, 1.0, v43
    v_mfma_f32_32x32x16_bf16 v[132:147], v[68:71], a[176:179], v[132:147]
    s_waitcnt lgkmcnt(5)
    ds_read_b64_tr_b16 v[62:63], v19 offset:33280
    v_rcp_f32 v42, v42
    v_mul_f32 v38, v38, v186
    v_mul_f32 v39, v39, v187
    v_mul_f32 v42, v42, v184
    v_mfma_f32_32x32x16_bf16 v[116:131], v[72:75], a[36:39], v[116:131]
    s_add_u32 m0, s85, 49152
    ds_read_b64_tr_b16 v[64:65], v19 offset:34816
    buffer_load_dwordx4 v6, s[12:15], s73 offen offset:0 lds
    v_rcp_f32 v43, v43
    v_cvt_pk_bf16_f32 v45, v40, v41
    v_mul_f32 v43, v43, v185
    v_mfma_f32_32x32x16_bf16 v[132:147], v[72:75], a[180:183], v[132:147]
    s_waitcnt lgkmcnt(5)
    ds_read_b64_tr_b16 v[66:67], v19 offset:35328
    v_exp_f32 v38, v38
    v_mul_f32 v40, v188, v188
    v_mul_f32 v41, v189, v189
    v_add_f32 v38, 1.0, v38
    v_mfma_f32_32x32x16_bf16 v[116:131], v[76:79], a[40:43], v[116:131]
    ds_read_b64_tr_b16 v[68:69], v19 offset:36864
    buffer_load_dwordx4 v7, s[12:15], s73 offen offset:1024 lds
    v_exp_f32 v39, v39
    v_fmaak_f32 v40, v40, v28, 0xc0135761
    v_fmaak_f32 v41, v41, v28, 0xc0135761
    v_mfma_f32_32x32x16_bf16 v[132:147], v[76:79], a[184:187], v[132:147]
    s_waitcnt lgkmcnt(5)
    ds_read_b64_tr_b16 v[70:71], v19 offset:37376
    v_add_f32 v39, 1.0, v39
    v_rcp_f32 v38, v38
    v_mul_f32 v40, v40, v188
    v_mul_f32 v41, v41, v189
    v_mfma_f32_32x32x16_bf16 v[116:131], v[80:83], a[44:47], v[116:131]
    ds_read_b64_tr_b16 v[72:73], v19 offset:38912
    v_mul_f32 v38, v38, v186
    v_rcp_f32 v39, v39
    v_cvt_pk_bf16_f32 v46, v42, v43
    v_mul_f32 v39, v39, v187
    v_mfma_f32_32x32x16_bf16 v[132:147], v[80:83], a[188:191], v[132:147]
    s_waitcnt lgkmcnt(5)
    ds_read_b64_tr_b16 v[74:75], v19 offset:39424
    v_exp_f32 v40, v40
    v_mul_f32 v42, v190, v190
    v_mul_f32 v43, v191, v191
    v_add_f32 v40, 1.0, v40
    v_mfma_f32_32x32x16_bf16 v[116:131], v[60:63], a[48:51], v[116:131]
    ds_read_b64_tr_b16 v[76:77], v19 offset:40960
    v_exp_f32 v41, v41
    v_fmaak_f32 v42, v42, v28, 0xc0135761
    v_fmaak_f32 v43, v43, v28, 0xc0135761
    v_add_f32 v41, 1.0, v41
    v_mfma_f32_32x32x16_bf16 v[132:147], v[60:63], a[192:195], v[132:147]
    s_waitcnt lgkmcnt(5)
    ds_read_b64_tr_b16 v[78:79], v19 offset:41472
    v_rcp_f32 v40, v40
    v_mul_f32 v42, v42, v190
    v_mul_f32 v43, v43, v191
    v_mul_f32 v40, v40, v188
    v_mfma_f32_32x32x16_bf16 v[116:131], v[64:67], a[52:55], v[116:131]
    ds_read_b64_tr_b16 v[80:81], v19 offset:43008
    v_rcp_f32 v41, v41
    v_cvt_pk_bf16_f32 v47, v38, v39
    v_mul_f32 v41, v41, v189
    v_mfma_f32_32x32x16_bf16 v[132:147], v[64:67], a[196:199], v[132:147]
    s_waitcnt lgkmcnt(5)
    ds_read_b64_tr_b16 v[82:83], v19 offset:43520
    v_exp_f32 v42, v42
    v_mul_f32 v38, v192, v192
    v_mul_f32 v39, v193, v193
    v_add_f32 v42, 1.0, v42
    v_mfma_f32_32x32x16_bf16 v[116:131], v[68:71], a[56:59], v[116:131]
    ds_read_b64_tr_b16 v[60:61], v19 offset:45056
    ds_read_b128 v[212:215], v26 offset:1024
    v_exp_f32 v43, v43
    v_fmaak_f32 v38, v38, v28, 0xc0135761
    v_fmaak_f32 v39, v39, v28, 0xc0135761
    v_mfma_f32_32x32x16_bf16 v[132:147], v[68:71], a[200:203], v[132:147]
    s_waitcnt lgkmcnt(6)
    ds_read_b64_tr_b16 v[62:63], v19 offset:45568
    v_add_f32 v43, 1.0, v43
    v_rcp_f32 v42, v42
    v_mul_f32 v38, v38, v192
    v_mul_f32 v39, v39, v193
    v_mfma_f32_32x32x16_bf16 v[116:131], v[72:75], a[60:63], v[116:131]
    ds_read_b64_tr_b16 v[64:65], v19 offset:47104
    ds_read_b128 v[216:219], v26 offset:1056
    v_mul_f32 v42, v42, v190
    v_rcp_f32 v43, v43
    v_cvt_pk_bf16_f32 v48, v40, v41
    v_mfma_f32_32x32x16_bf16 v[132:147], v[72:75], a[204:207], v[132:147]
    s_waitcnt lgkmcnt(7)
    ds_read_b64_tr_b16 v[66:67], v19 offset:47616
    v_mul_f32 v43, v43, v191
    v_exp_f32 v38, v38
    v_mul_f32 v40, v194, v194
    v_mul_f32 v41, v195, v195
    v_mfma_f32_32x32x16_bf16 v[116:131], v[76:79], a[64:67], v[116:131]
    ds_read_b64_tr_b16 v[68:69], v19 offset:49152
    ds_read_b128 v[220:223], v26 offset:1088
    v_add_f32 v38, 1.0, v38
    v_exp_f32 v39, v39
    v_fmaak_f32 v40, v40, v28, 0xc0135761
    v_mfma_f32_32x32x16_bf16 v[132:147], v[76:79], a[208:211], v[132:147]
    s_waitcnt lgkmcnt(8)
    ds_read_b64_tr_b16 v[70:71], v19 offset:49664
    v_fmaak_f32 v41, v41, v28, 0xc0135761
    v_add_f32 v39, 1.0, v39
    v_rcp_f32 v38, v38
    v_mul_f32 v40, v40, v194
    v_mfma_f32_32x32x16_bf16 v[116:131], v[80:83], a[68:71], v[116:131]
    ds_read_b64_tr_b16 v[72:73], v19 offset:51200
    ds_read_b128 v[224:227], v26 offset:1120
    v_mul_f32 v41, v41, v195
    v_mul_f32 v38, v38, v192
    v_rcp_f32 v39, v39
    v_mfma_f32_32x32x16_bf16 v[132:147], v[80:83], a[212:215], v[132:147]
    s_waitcnt lgkmcnt(8)
    ds_read_b64_tr_b16 v[74:75], v19 offset:51712
    v_cvt_pk_bf16_f32 v49, v42, v43
    v_mul_f32 v39, v39, v193
    v_exp_f32 v40, v40
    v_mul_f32 v42, v196, v196
    v_mfma_f32_32x32x16_bf16 v[116:131], v[60:63], a[72:75], v[116:131]
    ds_read_b64_tr_b16 v[76:77], v19 offset:53248
    v_mul_f32 v43, v197, v197
    v_add_f32 v40, 1.0, v40
    v_exp_f32 v41, v41
    v_fmaak_f32 v42, v42, v28, 0xc0135761
    v_mfma_f32_32x32x16_bf16 v[132:147], v[60:63], a[216:219], v[132:147]
    s_waitcnt lgkmcnt(7)
    ds_read_b64_tr_b16 v[78:79], v19 offset:53760
    v_fmaak_f32 v43, v43, v28, 0xc0135761
    v_add_f32 v41, 1.0, v41
    v_rcp_f32 v40, v40
    v_mul_f32 v42, v42, v196
    v_mfma_f32_32x32x16_bf16 v[116:131], v[64:67], a[76:79], v[116:131]
    ds_read_b64_tr_b16 v[80:81], v19 offset:55296
    v_mul_f32 v43, v43, v197
    v_mul_f32 v40, v40, v194
    v_rcp_f32 v41, v41
    v_cvt_pk_bf16_f32 v50, v38, v39
    v_mfma_f32_32x32x16_bf16 v[132:147], v[64:67], a[220:223], v[132:147]
    s_waitcnt lgkmcnt(6)
    ds_read_b64_tr_b16 v[82:83], v19 offset:55808
    v_mul_f32 v41, v41, v195
    v_exp_f32 v42, v42
    v_mul_f32 v38, v198, v198
    v_mul_f32 v39, v199, v199
    v_mfma_f32_32x32x16_bf16 v[116:131], v[68:71], a[80:83], v[116:131]
    s_waitcnt vmcnt(8)
    s_barrier
    ds_read_b64_tr_b16 v[60:61], v18 offset:0
    v_add_f32 v42, 1.0, v42
    v_exp_f32 v43, v43
    v_mfma_f32_32x32x16_bf16 v[132:147], v[68:71], a[224:227], v[132:147]
    s_waitcnt lgkmcnt(5)
    ds_read_b64_tr_b16 v[62:63], v18 offset:512
    v_fmaak_f32 v38, v38, v28, 0xc0135761
    v_fmaak_f32 v39, v39, v28, 0xc0135761
    v_add_f32 v43, 1.0, v43
    v_rcp_f32 v42, v42
    v_mfma_f32_32x32x16_bf16 v[116:131], v[72:75], a[84:87], v[116:131]
    s_or_b32 s21, s60, 1
    ds_read_b64_tr_b16 v[64:65], v18 offset:2048
    v_mul_f32 v38, v38, v198
    v_mul_f32 v39, v39, v199
    v_mul_f32 v42, v42, v196
    v_rcp_f32 v43, v43
    v_mfma_f32_32x32x16_bf16 v[132:147], v[72:75], a[228:231], v[132:147]
    s_waitcnt lgkmcnt(5)
    ds_read_b64_tr_b16 v[66:67], v18 offset:2560
    v_cvt_pk_bf16_f32 v51, v40, v41
    v_mul_f32 v43, v43, v197
    v_exp_f32 v38, v38
    v_mul_f32 v40, v200, v200
    v_mfma_f32_32x32x16_bf16 v[116:131], v[76:79], a[88:91], v[116:131]
    v_mov_b32 v243, s21
    ds_read_b64_tr_b16 v[68:69], v18 offset:4096
    buffer_store_dword v243, v241, s[16:19], 0 offen sc1
    v_mul_f32 v41, v201, v201
    v_add_f32 v38, 1.0, v38
    v_exp_f32 v39, v39
    v_mfma_f32_32x32x16_bf16 v[132:147], v[76:79], a[232:235], v[132:147]
    s_waitcnt lgkmcnt(5)
    ds_read_b64_tr_b16 v[70:71], v18 offset:4608
    v_fmaak_f32 v40, v40, v28, 0xc0135761
    v_fmaak_f32 v41, v41, v28, 0xc0135761
    v_add_f32 v39, 1.0, v39
    v_rcp_f32 v38, v38
    v_mfma_f32_32x32x16_bf16 v[116:131], v[80:83], a[92:95], v[116:131]
    s_add_u32 m0, s85, 57344
    ds_read_b64_tr_b16 v[72:73], v18 offset:6144
    buffer_load_dwordx4 v6, s[12:15], s74 offen offset:0 lds
    v_mul_f32 v40, v40, v200
    v_mul_f32 v41, v41, v201
    v_mul_f32 v38, v38, v198
    v_mfma_f32_32x32x16_bf16 v[132:147], v[80:83], a[236:239], v[132:147]
    s_waitcnt lgkmcnt(5)
    ds_read_b64_tr_b16 v[74:75], v18 offset:6656
    buffer_load_dwordx4 v7, s[12:15], s74 offen offset:1024 lds
    v_rcp_f32 v39, v39
    v_cvt_pk_bf16_f32 v52, v42, v43
    v_mul_f32 v39, v39, v199
    v_mfma_f32_32x32x16_bf16 v[116:131], v[60:63], a[96:99], v[116:131]
    s_add_u32 m0, s85, 65536
    ds_read_b64_tr_b16 v[76:77], v18 offset:8192
    buffer_load_dwordx4 v6, s[12:15], s75 offen offset:0 lds
    v_exp_f32 v40, v40
    v_mul_f32 v42, v202, v202
    v_mul_f32 v43, v203, v203
    v_mfma_f32_32x32x16_bf16 v[132:147], v[60:63], a[240:243], v[132:147]
    s_waitcnt lgkmcnt(5)
    ds_read_b64_tr_b16 v[78:79], v18 offset:8704
    buffer_load_dwordx4 v7, s[12:15], s75 offen offset:1024 lds
    v_add_f32 v40, 1.0, v40
    v_exp_f32 v41, v41
    v_fmaak_f32 v42, v42, v28, 0xc0135761
    v_mfma_f32_32x32x16_bf16 v[116:131], v[64:67], a[100:103], v[116:131]
    ds_read_b64_tr_b16 v[80:81], v18 offset:10240
    v_fmaak_f32 v43, v43, v28, 0xc0135761
    v_add_f32 v41, 1.0, v41
    v_rcp_f32 v40, v40
    v_mul_f32 v42, v42, v202
    v_mfma_f32_32x32x16_bf16 v[132:147], v[64:67], a[244:247], v[132:147]
    s_waitcnt lgkmcnt(5)
    ds_read_b64_tr_b16 v[82:83], v18 offset:10752
    v_mul_f32 v43, v43, v203
    v_mul_f32 v40, v40, v200
    v_rcp_f32 v41, v41
    v_cvt_pk_bf16_f32 v53, v38, v39
    v_mfma_f32_32x32x16_bf16 v[116:131], v[68:71], a[104:107], v[116:131]
    s_add_u32 m0, s85, 73728
    ds_read_b64_tr_b16 v[60:61], v18 offset:12288
    buffer_load_dwordx4 v6, s[12:15], s76 offen offset:0 lds
    v_mul_f32 v41, v41, v201
    v_exp_f32 v42, v42
    v_mul_f32 v38, v204, v204
    v_mfma_f32_32x32x16_bf16 v[132:147], v[68:71], a[248:251], v[132:147]
    s_waitcnt lgkmcnt(5)
    ds_read_b64_tr_b16 v[62:63], v18 offset:12800
    v_mul_f32 v39, v205, v205
    v_add_f32 v42, 1.0, v42
    v_exp_f32 v43, v43
    v_fmaak_f32 v38, v38, v28, 0xc0135761
    v_mfma_f32_32x32x16_bf16 v[116:131], v[72:75], a[108:111], v[116:131]
    ds_read_b64_tr_b16 v[64:65], v18 offset:14336
    buffer_load_dwordx4 v7, s[12:15], s76 offen offset:1024 lds
    v_fmaak_f32 v39, v39, v28, 0xc0135761
    v_add_f32 v43, 1.0, v43
    v_rcp_f32 v42, v42
    v_mfma_f32_32x32x16_bf16 v[132:147], v[72:75], a[252:255], v[132:147]
    s_waitcnt lgkmcnt(5)
    ds_read_b64_tr_b16 v[66:67], v18 offset:14848
    v_mul_f32 v38, v38, v204
    v_mul_f32 v39, v39, v205
    v_mul_f32 v42, v42, v202
    v_rcp_f32 v43, v43
    v_mfma_f32_32x32x16_bf16 v[116:131], v[76:79], a[112:115], v[116:131]
    s_add_u32 m0, s85, 81920
    ds_read_b64_tr_b16 v[68:69], v18 offset:16384
    buffer_load_dwordx4 v6, s[12:15], s77 offen offset:0 lds
    v_cvt_pk_bf16_f32 v54, v40, v41
    v_mul_f32 v43, v43, v203
    v_exp_f32 v38, v38
    v_mfma_f32_32x32x16_bf16 v[132:147], v[76:79], v[148:151], v[132:147]
    s_waitcnt lgkmcnt(5)
    ds_read_b64_tr_b16 v[70:71], v18 offset:16896
    v_mul_f32 v40, v206, v206
    v_mul_f32 v41, v207, v207
    v_add_f32 v38, 1.0, v38
    v_exp_f32 v39, v39
    v_mfma_f32_32x32x16_bf16 v[116:131], v[80:83], a[116:119], v[116:131]
    ds_read_b64_tr_b16 v[72:73], v18 offset:18432
    buffer_load_dwordx4 v7, s[12:15], s77 offen offset:1024 lds
    v_fmaak_f32 v40, v40, v28, 0xc0135761
    v_fmaak_f32 v41, v41, v28, 0xc0135761
    v_add_f32 v39, 1.0, v39
    v_mfma_f32_32x32x16_bf16 v[132:147], v[80:83], v[152:155], v[132:147]
    s_waitcnt lgkmcnt(5)
    ds_read_b64_tr_b16 v[74:75], v18 offset:18944
    v_rcp_f32 v38, v38
    v_mul_f32 v40, v40, v206
    v_mul_f32 v41, v41, v207
    v_mul_f32 v38, v38, v204
    v_mfma_f32_32x32x16_bf16 v[116:131], v[60:63], a[120:123], v[116:131]
    s_add_u32 m0, s85, 90112
    ds_read_b64_tr_b16 v[76:77], v18 offset:20480
    buffer_load_dwordx4 v6, s[12:15], s78 offen offset:0 lds
    v_rcp_f32 v39, v39
    v_cvt_pk_bf16_f32 v55, v42, v43
    v_mul_f32 v39, v39, v205
    v_mfma_f32_32x32x16_bf16 v[132:147], v[60:63], v[156:159], v[132:147]
    s_waitcnt lgkmcnt(5)
    ds_read_b64_tr_b16 v[78:79], v18 offset:20992
    v_exp_f32 v40, v40
    v_mul_f32 v42, v208, v208
    v_mul_f32 v43, v209, v209
    v_add_f32 v40, 1.0, v40
    v_mfma_f32_32x32x16_bf16 v[116:131], v[64:67], a[124:127], v[116:131]
    ds_read_b64_tr_b16 v[80:81], v18 offset:22528
    buffer_load_dwordx4 v7, s[12:15], s78 offen offset:1024 lds
    v_exp_f32 v41, v41
    v_fmaak_f32 v42, v42, v28, 0xc0135761
    v_fmaak_f32 v43, v43, v28, 0xc0135761
    v_mfma_f32_32x32x16_bf16 v[132:147], v[64:67], v[160:163], v[132:147]
    s_waitcnt lgkmcnt(5)
    ds_read_b64_tr_b16 v[82:83], v18 offset:23040
    v_add_f32 v41, 1.0, v41
    v_rcp_f32 v40, v40
    v_mul_f32 v42, v42, v208
    v_mul_f32 v43, v43, v209
    v_mfma_f32_32x32x16_bf16 v[116:131], v[68:71], a[128:131], v[116:131]
    s_waitcnt vmcnt(13)
    s_barrier
    ds_read_b64_tr_b16 v[60:61], v18 offset:24576
    v_mul_f32 v40, v40, v206
    v_rcp_f32 v41, v41
    v_mfma_f32_32x32x16_bf16 v[132:147], v[68:71], v[164:167], v[132:147]
    s_waitcnt lgkmcnt(5)
    ds_read_b64_tr_b16 v[62:63], v18 offset:25088
    v_cvt_pk_bf16_f32 v56, v38, v39
    v_mul_f32 v41, v41, v207
    v_exp_f32 v42, v42
    v_mul_f32 v38, v210, v210
    v_mfma_f32_32x32x16_bf16 v[116:131], v[72:75], a[132:135], v[116:131]
    ds_read_b64_tr_b16 v[64:65], v18 offset:26624
    v_mul_f32 v39, v211, v211
    v_add_f32 v42, 1.0, v42
    v_exp_f32 v43, v43
    v_fmaak_f32 v38, v38, v28, 0xc0135761
    v_mfma_f32_32x32x16_bf16 v[132:147], v[72:75], v[168:171], v[132:147]
    s_waitcnt lgkmcnt(5)
    ds_read_b64_tr_b16 v[66:67], v18 offset:27136
    v_fmaak_f32 v39, v39, v28, 0xc0135761
    v_add_f32 v43, 1.0, v43
    v_rcp_f32 v42, v42
    v_mul_f32 v38, v38, v210
    v_mfma_f32_32x32x16_bf16 v[116:131], v[76:79], a[136:139], v[116:131]
    ds_read_b64_tr_b16 v[68:69], v18 offset:28672
    v_mul_f32 v39, v39, v211
    v_mul_f32 v42, v42, v208
    v_rcp_f32 v43, v43
    v_cvt_pk_bf16_f32 v57, v40, v41
    v_mfma_f32_32x32x16_bf16 v[132:147], v[76:79], v[172:175], v[132:147]
    s_waitcnt lgkmcnt(5)
    ds_read_b64_tr_b16 v[70:71], v18 offset:29184
    v_mul_f32 v43, v43, v209
    v_exp_f32 v38, v38
    v_exp_f32 v39, v39
    v_mfma_f32_32x32x16_bf16 v[116:131], v[80:83], a[140:143], v[116:131]
    ds_read_b64_tr_b16 v[72:73], v18 offset:30720
    v_add_f32 v38, 1.0, v38
    v_add_f32 v39, 1.0, v39
    v_rcp_f32 v38, v38
    v_mfma_f32_32x32x16_bf16 v[132:147], v[80:83], v[176:179], v[132:147]
    s_waitcnt lgkmcnt(5)
    ds_read_b64_tr_b16 v[74:75], v18 offset:31232
    v_rcp_f32 v39, v39
    v_mul_f32 v38, v38, v210
    s_add_u32 s46, s47, 146176
    v_add_u32 v22, s46, v24
    v_mfma_f32_32x32x16_bf16 v[84:99], v[60:63], a[0:3], v[212:227]
    ds_read_b64_tr_b16 v[76:77], v18 offset:32768
    v_add_u32 v36, s46, v25
    v_cvt_pk_bf16_f32 v58, v42, v43
    v_mul_f32 v39, v39, v211
    v_cvt_pk_bf16_f32 v59, v38, v39
    s_nop 1
    v_mfma_f32_32x32x16_bf16 v[100:115], v[60:63], a[144:147], v[212:227]
    s_waitcnt lgkmcnt(5)
    ds_read_b64_tr_b16 v[78:79], v18 offset:33280
    buffer_store_dwordx4 v[44:47], v24, s[16:19], s42 offen offset:0 sc1
    ds_write_b128 v22, v[44:47] offset:0
    v_mfma_f32_32x32x16_bf16 v[84:99], v[64:67], a[4:7], v[84:99]
    ds_read_b64_tr_b16 v[80:81], v18 offset:34816
    buffer_store_dwordx4 v[48:51], v24, s[16:19], s42 offen offset:512 sc1
    ds_write_b128 v22, v[48:51] offset:512
    v_mfma_f32_32x32x16_bf16 v[100:115], v[64:67], a[148:151], v[100:115]
    s_waitcnt lgkmcnt(7)
    ds_read_b64_tr_b16 v[82:83], v18 offset:35328
    buffer_store_dwordx4 v[52:55], v25, s[16:19], s42 offen offset:0 sc1
    ds_write_b128 v36, v[52:55] offset:0
    v_mfma_f32_32x32x16_bf16 v[84:99], v[68:71], a[8:11], v[84:99]
    ds_read_b64_tr_b16 v[60:61], v18 offset:36864
    buffer_store_dwordx4 v[56:59], v25, s[16:19], s42 offen offset:512 sc1
    ds_write_b128 v36, v[56:59] offset:512
    v_mfma_f32_32x32x16_bf16 v[100:115], v[68:71], a[152:155], v[100:115]
    s_waitcnt lgkmcnt(9)
    ds_read_b64_tr_b16 v[62:63], v18 offset:37376
    v_mul_f32 v38, v116, v116
    v_mul_f32 v39, v117, v117
    v_fmaak_f32 v38, v38, v28, 0xc0135761
    v_fmaak_f32 v39, v39, v28, 0xc0135761
    v_mfma_f32_32x32x16_bf16 v[84:99], v[72:75], a[12:15], v[84:99]
    s_add_u32 s55, s79, 0
    ds_read_b64_tr_b16 v[64:65], v18 offset:38912
    buffer_load_dwordx4 a[0:3], v239, s[16:19], s55 offen offset:0 sc1
    v_mul_f32 v38, v38, v116
    v_mul_f32 v39, v39, v117
    v_exp_f32 v38, v38
    v_mfma_f32_32x32x16_bf16 v[100:115], v[72:75], a[156:159], v[100:115]
    s_waitcnt lgkmcnt(9)
    ds_read_b64_tr_b16 v[66:67], v18 offset:39424
    v_mul_f32 v40, v118, v118
    v_mul_f32 v41, v119, v119
    v_add_f32 v38, 1.0, v38
    v_exp_f32 v39, v39
    v_mfma_f32_32x32x16_bf16 v[84:99], v[76:79], a[16:19], v[84:99]
    ds_read_b64_tr_b16 v[68:69], v18 offset:40960
    buffer_load_dwordx4 a[144:147], v239, s[16:19], s55 offen offset:1024 sc1
    v_fmaak_f32 v40, v40, v28, 0xc0135761
    v_fmaak_f32 v41, v41, v28, 0xc0135761
    v_add_f32 v39, 1.0, v39
    v_mfma_f32_32x32x16_bf16 v[100:115], v[76:79], a[160:163], v[100:115]
    s_waitcnt lgkmcnt(7)
    ds_read_b64_tr_b16 v[70:71], v18 offset:41472
    v_rcp_f32 v38, v38
    v_mul_f32 v40, v40, v118
    v_mul_f32 v41, v41, v119
    v_mul_f32 v38, v38, v116
    v_mfma_f32_32x32x16_bf16 v[84:99], v[80:83], a[20:23], v[84:99]
    ds_read_b64_tr_b16 v[72:73], v18 offset:43008
    buffer_load_dwordx4 a[4:7], v240, s[16:19], s55 offen offset:0 sc1
    v_rcp_f32 v39, v39
    v_nop
    v_mul_f32 v39, v39, v117
    v_mfma_f32_32x32x16_bf16 v[100:115], v[80:83], a[164:167], v[100:115]
    s_waitcnt lgkmcnt(5)
    ds_read_b64_tr_b16 v[74:75], v18 offset:43520
    v_exp_f32 v40, v40
    v_mul_f32 v42, v120, v120
    v_mul_f32 v43, v121, v121
    v_add_f32 v40, 1.0, v40
    v_mfma_f32_32x32x16_bf16 v[84:99], v[60:63], a[24:27], v[84:99]
    ds_read_b64_tr_b16 v[76:77], v18 offset:45056
    buffer_load_dwordx4 a[148:151], v240, s[16:19], s55 offen offset:1024 sc1
    v_exp_f32 v41, v41
    v_fmaak_f32 v42, v42, v28, 0xc0135761
    v_fmaak_f32 v43, v43, v28, 0xc0135761
    v_mfma_f32_32x32x16_bf16 v[100:115], v[60:63], a[168:171], v[100:115]
    s_waitcnt lgkmcnt(5)
    ds_read_b64_tr_b16 v[78:79], v18 offset:45568
    v_add_f32 v41, 1.0, v41
    v_rcp_f32 v40, v40
    v_mul_f32 v42, v42, v120
    v_mul_f32 v43, v43, v121
    v_mfma_f32_32x32x16_bf16 v[84:99], v[64:67], a[28:31], v[84:99]
    s_add_u32 s55, s79, 16384
    ds_read_b64_tr_b16 v[80:81], v18 offset:47104
    buffer_load_dwordx4 a[8:11], v239, s[16:19], s55 offen offset:0 sc1
    v_mul_f32 v40, v40, v118
    v_rcp_f32 v41, v41
    v_cvt_pk_bf16_f32 v44, v38, v39
    v_mfma_f32_32x32x16_bf16 v[100:115], v[64:67], a[172:175], v[100:115]
    s_waitcnt lgkmcnt(5)
    ds_read_b64_tr_b16 v[82:83], v18 offset:47616
    v_mul_f32 v41, v41, v119
    v_exp_f32 v42, v42
    v_mul_f32 v38, v122, v122
    v_mul_f32 v39, v123, v123
    v_mfma_f32_32x32x16_bf16 v[84:99], v[68:71], a[32:35], v[84:99]
    s_waitcnt vmcnt(15)
    s_barrier
    ds_read_b64_tr_b16 v[60:61], v18 offset:49152
    buffer_load_dwordx4 a[152:155], v239, s[16:19], s55 offen offset:1024 sc1
    v_add_f32 v42, 1.0, v42
    v_mfma_f32_32x32x16_bf16 v[100:115], v[68:71], a[176:179], v[100:115]
    s_waitcnt lgkmcnt(5)
    ds_read_b64_tr_b16 v[62:63], v18 offset:49664
    v_exp_f32 v43, v43
    v_fmaak_f32 v38, v38, v28, 0xc0135761
    v_fmaak_f32 v39, v39, v28, 0xc0135761
    v_add_f32 v43, 1.0, v43
    v_mfma_f32_32x32x16_bf16 v[84:99], v[72:75], a[36:39], v[84:99]
    s_add_u32 s54, s50, 0
    ds_read_b64_tr_b16 v[64:65], v18 offset:51200
    ds_read_b128 a[16:19], v35 offset:15104
    v_rcp_f32 v42, v42
    v_mul_f32 v38, v38, v122
    v_mul_f32 v39, v39, v123
    v_mfma_f32_32x32x16_bf16 v[100:115], v[72:75], a[180:183], v[100:115]
    s_waitcnt lgkmcnt(6)
    ds_read_b64_tr_b16 v[66:67], v18 offset:51712
    ds_read_b128 a[160:163], v35 offset:16128
    v_mul_f32 v42, v42, v120
    v_rcp_f32 v43, v43
    v_cvt_pk_bf16_f32 v45, v40, v41
    v_mfma_f32_32x32x16_bf16 v[84:99], v[76:79], a[40:43], v[84:99]
    s_add_u32 m0, s88, 0
    ds_read_b64_tr_b16 v[68:69], v18 offset:53248
    buffer_load_dwordx4 v228, s[24:27], s54 offen offset:0 lds
    ds_read_b128 a[20:23], v35 offset:23296
    v_mul_f32 v43, v43, v121
    v_exp_f32 v38, v38
    v_mfma_f32_32x32x16_bf16 v[100:115], v[76:79], a[184:187], v[100:115]
    s_waitcnt lgkmcnt(8)
    ds_read_b64_tr_b16 v[70:71], v18 offset:53760
    buffer_load_dwordx4 v229, s[24:27], s54 offen offset:1024 lds
    ds_read_b128 a[164:167], v35 offset:24320
    v_mul_f32 v40, v124, v124
    v_mul_f32 v41, v125, v125
    v_mfma_f32_32x32x16_bf16 v[84:99], v[80:83], a[44:47], v[84:99]
    ds_read_b64_tr_b16 v[72:73], v18 offset:55296
    v_add_f32 v38, 1.0, v38
    v_exp_f32 v39, v39
    v_fmaak_f32 v40, v40, v28, 0xc0135761
    v_fmaak_f32 v41, v41, v28, 0xc0135761
    v_mfma_f32_32x32x16_bf16 v[100:115], v[80:83], a[188:191], v[100:115]
    s_waitcnt lgkmcnt(9)
    ds_read_b64_tr_b16 v[74:75], v18 offset:55808
    v_add_f32 v39, 1.0, v39
    v_rcp_f32 v38, v38
    v_mul_f32 v40, v40, v124
    v_mul_f32 v41, v41, v125
    v_mfma_f32_32x32x16_bf16 v[84:99], v[60:63], a[48:51], v[84:99]
    ds_read_b64_tr_b16 v[76:77], v18 offset:57344
    v_mul_f32 v38, v38, v122
    v_rcp_f32 v39, v39
    v_cvt_pk_bf16_f32 v46, v42, v43
    v_mul_f32 v39, v39, v123
    v_mfma_f32_32x32x16_bf16 v[100:115], v[60:63], a[192:195], v[100:115]
    s_waitcnt lgkmcnt(8)
    ds_read_b64_tr_b16 v[78:79], v18 offset:57856
    v_exp_f32 v40, v40
    v_mul_f32 v42, v126, v126
    v_mul_f32 v43, v127, v127
    v_add_f32 v40, 1.0, v40
    v_mfma_f32_32x32x16_bf16 v[84:99], v[64:67], a[52:55], v[84:99]
    ds_read_b64_tr_b16 v[80:81], v18 offset:59392
    v_exp_f32 v41, v41
    v_fmaak_f32 v42, v42, v28, 0xc0135761
    v_fmaak_f32 v43, v43, v28, 0xc0135761
    v_add_f32 v41, 1.0, v41
    v_mfma_f32_32x32x16_bf16 v[100:115], v[64:67], a[196:199], v[100:115]
    s_waitcnt lgkmcnt(6)
    ds_read_b64_tr_b16 v[82:83], v18 offset:59904
    v_rcp_f32 v40, v40
    v_mul_f32 v42, v42, v126
    v_mul_f32 v43, v43, v127
    s_add_u32 s46, s47, 129792
    v_mfma_f32_32x32x16_bf16 v[84:99], v[68:71], a[56:59], v[84:99]
    ds_read_b64_tr_b16 v[60:61], v18 offset:61440
    v_add_u32 v22, s46, v24
    v_add_u32 v36, s46, v25
    v_mul_f32 v40, v40, v124
    v_rcp_f32 v41, v41
    v_mfma_f32_32x32x16_bf16 v[100:115], v[68:71], a[200:203], v[100:115]
    s_waitcnt lgkmcnt(5)
    ds_read_b64_tr_b16 v[62:63], v18 offset:61952
    v_cvt_pk_bf16_f32 v47, v38, v39
    v_mfma_f32_32x32x16_bf16 v[84:99], v[72:75], a[60:63], v[84:99]
    ds_read_b64_tr_b16 v[64:65], v18 offset:63488
    buffer_store_dwordx4 v[44:47], v24, s[16:19], s43 offen offset:0 sc1
    ds_write_b128 v22, v[44:47] offset:0
    v_mul_f32 v41, v41, v125
    v_exp_f32 v42, v42
    v_mfma_f32_32x32x16_bf16 v[100:115], v[72:75], a[204:207], v[100:115]
    s_waitcnt lgkmcnt(6)
    ds_read_b64_tr_b16 v[66:67], v18 offset:64000
    v_mul_f32 v38, v128, v128
    v_mul_f32 v39, v129, v129
    v_add_f32 v42, 1.0, v42
    v_exp_f32 v43, v43
    v_mfma_f32_32x32x16_bf16 v[84:99], v[76:79], a[64:67], v[84:99]
    ds_read_b64_tr_b16 v[68:69], v19 offset:0
    buffer_load_dwordx4 v230, s[24:27], s54 offen offset:2048 lds
    v_fmaak_f32 v38, v38, v28, 0xc0135761
    v_fmaak_f32 v39, v39, v28, 0xc0135761
    v_add_f32 v43, 1.0, v43
    v_mfma_f32_32x32x16_bf16 v[100:115], v[76:79], a[208:211], v[100:115]
    s_waitcnt lgkmcnt(6)
    ds_read_b64_tr_b16 v[70:71], v19 offset:512
    v_rcp_f32 v42, v42
    v_mul_f32 v38, v38, v128
    v_mul_f32 v39, v39, v129
    v_mul_f32 v42, v42, v126
    v_mfma_f32_32x32x16_bf16 v[84:99], v[80:83], a[68:71], v[84:99]
    ds_read_b64_tr_b16 v[72:73], v19 offset:2048
    buffer_load_dwordx4 v231, s[24:27], s54 offen offset:3072 lds
    v_rcp_f32 v43, v43
    v_cvt_pk_bf16_f32 v48, v40, v41
    v_mul_f32 v43, v43, v127
    v_mfma_f32_32x32x16_bf16 v[100:115], v[80:83], a[212:215], v[100:115]
    s_waitcnt lgkmcnt(6)
    ds_read_b64_tr_b16 v[74:75], v19 offset:2560
    v_exp_f32 v38, v38
    v_mul_f32 v40, v130, v130
    v_mul_f32 v41, v131, v131
    v_add_f32 v38, 1.0, v38
    v_mfma_f32_32x32x16_bf16 v[84:99], v[60:63], a[72:75], v[84:99]
    s_add_u32 m0, s88, 4096
    ds_read_b64_tr_b16 v[76:77], v19 offset:4096
    buffer_load_dwordx4 v232, s[24:27], s54 offen offset:0 lds
    v_exp_f32 v39, v39
    v_fmaak_f32 v40, v40, v28, 0xc0135761
    v_fmaak_f32 v41, v41, v28, 0xc0135761
    v_mfma_f32_32x32x16_bf16 v[100:115], v[60:63], a[216:219], v[100:115]
    s_waitcnt lgkmcnt(5)
    ds_read_b64_tr_b16 v[78:79], v19 offset:4608
    v_add_f32 v39, 1.0, v39
    v_rcp_f32 v38, v38
    v_mul_f32 v40, v40, v130
    v_mul_f32 v41, v41, v131
    v_mfma_f32_32x32x16_bf16 v[84:99], v[64:67], a[76:79], v[84:99]
    ds_read_b64_tr_b16 v[80:81], v19 offset:6144
    v_mul_f32 v38, v38, v128
    v_rcp_f32 v39, v39
    v_cvt_pk_bf16_f32 v49, v42, v43
    v_mul_f32 v39, v39, v129
    v_mfma_f32_32x32x16_bf16 v[100:115], v[64:67], a[220:223], v[100:115]
    s_waitcnt lgkmcnt(5)
    ds_read_b64_tr_b16 v[82:83], v19 offset:6656
    buffer_load_dwordx4 a[12:15], v240, s[16:19], s55 offen offset:0 sc1
    v_exp_f32 v40, v40
    v_mul_f32 v42, v132, v132
    v_mul_f32 v43, v133, v133
    v_mfma_f32_32x32x16_bf16 v[84:99], v[68:71], a[80:83], v[84:99]
    s_waitcnt vmcnt(17)
    s_barrier
    ds_read_b64_tr_b16 v[60:61], v19 offset:8192
    v_add_f32 v40, 1.0, v40
    v_exp_f32 v41, v41
    v_mfma_f32_32x32x16_bf16 v[100:115], v[68:71], a[224:227], v[100:115]
    s_waitcnt lgkmcnt(5)
    ds_read_b64_tr_b16 v[62:63], v19 offset:8704
    v_fmaak_f32 v42, v42, v28, 0xc0135761
    v_fmaak_f32 v43, v43, v28, 0xc0135761
    v_add_f32 v41, 1.0, v41
    v_rcp_f32 v40, v40
    v_mfma_f32_32x32x16_bf16 v[84:99], v[72:75], a[84:87], v[84:99]
    s_add_u32 s54, s50, 73728
    ds_read_b64_tr_b16 v[64:65], v19 offset:10240
    v_mul_f32 v42, v42, v132
    v_mul_f32 v43, v43, v133
    v_mul_f32 v40, v40, v130
    v_rcp_f32 v41, v41
    v_mfma_f32_32x32x16_bf16 v[100:115], v[72:75], a[228:231], v[100:115]
    s_waitcnt lgkmcnt(5)
    ds_read_b64_tr_b16 v[66:67], v19 offset:10752
    v_cvt_pk_bf16_f32 v50, v38, v39
    v_mul_f32 v41, v41, v131
    v_exp_f32 v42, v42
    v_mul_f32 v38, v134, v134
    v_mfma_f32_32x32x16_bf16 v[84:99], v[76:79], a[88:91], v[84:99]
    s_add_u32 m0, s88, 18432
    ds_read_b64_tr_b16 v[68:69], v19 offset:12288
    buffer_load_dwordx4 v228, s[24:27], s54 offen offset:0 lds
    v_mul_f32 v39, v135, v135
    v_add_f32 v42, 1.0, v42
    v_exp_f32 v43, v43
    v_mfma_f32_32x32x16_bf16 v[100:115], v[76:79], a[232:235], v[100:115]
    s_waitcnt lgkmcnt(5)
    ds_read_b64_tr_b16 v[70:71], v19 offset:12800
    buffer_load_dwordx4 v229, s[24:27], s54 offen offset:1024 lds
    v_fmaak_f32 v38, v38, v28, 0xc0135761
    v_fmaak_f32 v39, v39, v28, 0xc0135761
    v_add_f32 v43, 1.0, v43
    v_mfma_f32_32x32x16_bf16 v[84:99], v[80:83], a[92:95], v[84:99]
    ds_read_b64_tr_b16 v[72:73], v19 offset:14336
    buffer_load_dwordx4 v230, s[24:27], s54 offen offset:2048 lds
    v_rcp_f32 v42, v42
    v_mul_f32 v38, v38, v134
    v_mul_f32 v39, v39, v135
    v_mfma_f32_32x32x16_bf16 v[100:115], v[80:83], a[236:239], v[100:115]
    s_waitcnt lgkmcnt(5)
    ds_read_b64_tr_b16 v[74:75], v19 offset:14848
    buffer_load_dwordx4 v231, s[24:27], s54 offen offset:3072 lds
    v_mul_f32 v42, v42, v132
    v_rcp_f32 v43, v43
    v_cvt_pk_bf16_f32 v51, v40, v41
    v_mfma_f32_32x32x16_bf16 v[84:99], v[60:63], a[96:99], v[84:99]
    ds_read_b64_tr_b16 v[76:77], v19 offset:16384
    buffer_load_dwordx4 a[156:159], v240, s[16:19], s55 offen offset:1024 sc1
    buffer_store_dwordx4 v[48:51], v24, s[16:19], s43 offen offset:512 sc1
    ds_write_b128 v22, v[48:51] offset:512
    v_mul_f32 v43, v43, v133
    v_mfma_f32_32x32x16_bf16 v[100:115], v[60:63], a[240:243], v[100:115]
    s_waitcnt lgkmcnt(6)
    ds_read_b64_tr_b16 v[78:79], v19 offset:16896
    v_exp_f32 v38, v38
    v_mul_f32 v40, v136, v136
    v_mul_f32 v41, v137, v137
    v_add_f32 v38, 1.0, v38
    v_mfma_f32_32x32x16_bf16 v[84:99], v[64:67], a[100:103], v[84:99]
    ds_read_b64_tr_b16 v[80:81], v19 offset:18432
    v_exp_f32 v39, v39
    v_fmaak_f32 v40, v40, v28, 0xc0135761
    v_fmaak_f32 v41, v41, v28, 0xc0135761
    v_add_f32 v39, 1.0, v39
    v_mfma_f32_32x32x16_bf16 v[100:115], v[64:67], a[244:247], v[100:115]
    s_waitcnt lgkmcnt(6)
    ds_read_b64_tr_b16 v[82:83], v19 offset:18944
    v_rcp_f32 v38, v38
    v_mul_f32 v40, v40, v136
    v_mul_f32 v41, v41, v137
    v_mul_f32 v38, v38, v134
    v_mfma_f32_32x32x16_bf16 v[84:99], v[68:71], a[104:107], v[84:99]
    ds_read_b64_tr_b16 v[60:61], v19 offset:20480
    v_rcp_f32 v39, v39
    v_cvt_pk_bf16_f32 v52, v42, v43
    v_mul_f32 v39, v39, v135
    v_mfma_f32_32x32x16_bf16 v[100:115], v[68:71], a[248:251], v[100:115]
    s_waitcnt lgkmcnt(6)
    ds_read_b64_tr_b16 v[62:63], v19 offset:20992
    v_exp_f32 v40, v40
    v_mul_f32 v42, v138, v138
    v_mul_f32 v43, v139, v139
    v_add_f32 v40, 1.0, v40
    v_mfma_f32_32x32x16_bf16 v[84:99], v[72:75], a[108:111], v[84:99]
    s_add_u32 m0, s88, 22528
    ds_read_b64_tr_b16 v[64:65], v19 offset:22528
    buffer_load_dwordx4 v232, s[24:27], s54 offen offset:0 lds
    v_exp_f32 v41, v41
    v_fmaak_f32 v42, v42, v28, 0xc0135761
    v_fmaak_f32 v43, v43, v28, 0xc0135761
    v_mfma_f32_32x32x16_bf16 v[100:115], v[72:75], a[252:255], v[100:115]
    s_waitcnt lgkmcnt(5)
    ds_read_b64_tr_b16 v[66:67], v19 offset:23040
    v_add_f32 v41, 1.0, v41
    v_rcp_f32 v40, v40
    v_mul_f32 v42, v42, v138
    v_mul_f32 v43, v43, v139
    v_mfma_f32_32x32x16_bf16 v[84:99], v[76:79], a[112:115], v[84:99]
    ds_read_b64_tr_b16 v[68:69], v19 offset:24576
    v_mul_f32 v40, v40, v136
    v_rcp_f32 v41, v41
    v_cvt_pk_bf16_f32 v53, v38, v39
    v_mul_f32 v41, v41, v137
    v_mfma_f32_32x32x16_bf16 v[100:115], v[76:79], v[148:151], v[100:115]
    s_waitcnt lgkmcnt(5)
    ds_read_b64_tr_b16 v[70:71], v19 offset:25088
    v_exp_f32 v42, v42
    v_mul_f32 v38, v140, v140
    v_mul_f32 v39, v141, v141
    v_add_f32 v42, 1.0, v42
    v_mfma_f32_32x32x16_bf16 v[84:99], v[80:83], a[116:119], v[84:99]
    ds_read_b64_tr_b16 v[72:73], v19 offset:26624
    v_exp_f32 v43, v43
    v_fmaak_f32 v38, v38, v28, 0xc0135761
    v_fmaak_f32 v39, v39, v28, 0xc0135761
    v_add_f32 v43, 1.0, v43
    v_mfma_f32_32x32x16_bf16 v[100:115], v[80:83], v[152:155], v[100:115]
    s_waitcnt lgkmcnt(5)
    ds_read_b64_tr_b16 v[74:75], v19 offset:27136
    v_rcp_f32 v42, v42
    v_mul_f32 v38, v38, v140
    v_mul_f32 v39, v39, v141
    v_mul_f32 v42, v42, v138
    v_mfma_f32_32x32x16_bf16 v[84:99], v[60:63], a[120:123], v[84:99]
    ds_read_b64_tr_b16 v[76:77], v19 offset:28672
    v_rcp_f32 v43, v43
    v_cvt_pk_bf16_f32 v54, v40, v41
    v_mul_f32 v43, v43, v139
    v_mfma_f32_32x32x16_bf16 v[100:115], v[60:63], v[156:159], v[100:115]
    s_waitcnt lgkmcnt(5)
    ds_read_b64_tr_b16 v[78:79], v19 offset:29184
    v_exp_f32 v38, v38
    v_mul_f32 v40, v142, v142
    v_mul_f32 v41, v143, v143
    v_add_f32 v38, 1.0, v38
    v_mfma_f32_32x32x16_bf16 v[84:99], v[64:67], a[124:127], v[84:99]
    ds_read_b64_tr_b16 v[80:81], v19 offset:30720
    v_exp_f32 v39, v39
    v_fmaak_f32 v40, v40, v28, 0xc0135761
    v_fmaak_f32 v41, v41, v28, 0xc0135761
    v_add_f32 v39, 1.0, v39
    v_mfma_f32_32x32x16_bf16 v[100:115], v[64:67], v[160:163], v[100:115]
    s_waitcnt lgkmcnt(5)
    ds_read_b64_tr_b16 v[82:83], v19 offset:31232
    v_rcp_f32 v38, v38
    v_mul_f32 v40, v40, v142
    v_mul_f32 v41, v41, v143
    v_mul_f32 v38, v38, v140
    v_mfma_f32_32x32x16_bf16 v[84:99], v[68:71], a[128:131], v[84:99]
    s_waitcnt vmcnt(8)
    s_barrier
    ds_read_b64_tr_b16 v[60:61], v233 offset:0
    v_rcp_f32 v39, v39
    v_cvt_pk_bf16_f32 v55, v42, v43
    v_mfma_f32_32x32x16_bf16 v[100:115], v[68:71], v[164:167], v[100:115]
    s_waitcnt lgkmcnt(5)
    ds_read_b64_tr_b16 v[62:63], v233 offset:2304
    buffer_load_dword v29, v242, s[16:19], 0 offen sc1
    buffer_store_dwordx4 v[52:55], v25, s[16:19], s43 offen offset:0 sc1
    ds_write_b128 v36, v[52:55] offset:0
    v_mul_f32 v39, v39, v141
    v_mfma_f32_32x32x16_bf16 v[84:99], v[72:75], a[132:135], v[84:99]
    s_add_u32 s54, s50, 147456
    ds_read_b64_tr_b16 v[64:65], v233 offset:32
    v_exp_f32 v40, v40
    v_mul_f32 v42, v144, v144
    v_mul_f32 v43, v145, v145
    v_add_f32 v40, 1.0, v40
    v_mfma_f32_32x32x16_bf16 v[100:115], v[72:75], v[168:171], v[100:115]
    s_waitcnt lgkmcnt(6)
    ds_read_b64_tr_b16 v[66:67], v233 offset:2336
    v_exp_f32 v41, v41
    v_fmaak_f32 v42, v42, v28, 0xc0135761
    v_fmaak_f32 v43, v43, v28, 0xc0135761
    v_add_f32 v41, 1.0, v41
    v_mfma_f32_32x32x16_bf16 v[84:99], v[76:79], a[136:139], v[84:99]
    s_add_u32 m0, s88, 36864
    ds_read_b64_tr_b16 v[68:69], v233 offset:64
    buffer_load_dwordx4 v228, s[24:27], s54 offen offset:0 lds
    v_rcp_f32 v40, v40
    v_mul_f32 v42, v42, v144
    v_mul_f32 v43, v43, v145
    v_mfma_f32_32x32x16_bf16 v[100:115], v[76:79], v[172:175], v[100:115]
    s_waitcnt lgkmcnt(6)
    ds_read_b64_tr_b16 v[70:71], v233 offset:2368
    buffer_load_dwordx4 v229, s[24:27], s54 offen offset:1024 lds
    v_mul_f32 v40, v40, v142
    v_rcp_f32 v41, v41
    v_cvt_pk_bf16_f32 v56, v38, v39
    v_mfma_f32_32x32x16_bf16 v[84:99], v[80:83], a[140:143], v[84:99]
    ds_read_b64_tr_b16 v[72:73], v233 offset:96
    buffer_load_dwordx4 v230, s[24:27], s54 offen offset:2048 lds
    v_mul_f32 v41, v41, v143
    v_exp_f32 v42, v42
    v_mul_f32 v38, v146, v146
    v_mfma_f32_32x32x16_bf16 v[100:115], v[80:83], v[176:179], v[100:115]
    s_waitcnt lgkmcnt(6)
    ds_read_b64_tr_b16 v[74:75], v233 offset:2400
    buffer_load_dwordx4 v231, s[24:27], s54 offen offset:3072 lds
    v_mul_f32 v39, v147, v147
    v_add_f32 v42, 1.0, v42
    v_exp_f32 v43, v43
    v_mfma_f32_16x16x32_bf16 v[148:151], v[60:63], a[0:3], 0
    s_add_u32 m0, s88, 40960
    v_fmaak_f32 v38, v38, v28, 0xc0135761
    v_fmaak_f32 v39, v39, v28, 0xc0135761
    v_add_f32 v43, 1.0, v43
    v_mfma_f32_16x16x32_bf16 v[152:155], v[60:63], a[144:147], 0
    s_waitcnt lgkmcnt(4)
    ds_read_b64_tr_b16 v[76:77], v233 offset:128
    ds_read_b64_tr_b16 v[78:79], v233 offset:2432
    ds_read_b64_tr_b16 v[80:81], v233 offset:160
    ds_read_b64_tr_b16 v[82:83], v233 offset:2464
    v_mfma_f32_16x16x32_bf16 v[156:159], v[64:67], a[0:3], 0
    buffer_load_dwordx4 v232, s[24:27], s54 offen offset:0 lds
    v_rcp_f32 v42, v42
    v_mul_f32 v38, v38, v146
    v_mfma_f32_16x16x32_bf16 v[160:163], v[64:67], a[144:147], 0
    s_waitcnt lgkmcnt(6)
    ds_read_b64_tr_b16 v[60:61], v233 offset:192
    ds_read_b64_tr_b16 v[62:63], v233 offset:2496
    v_mfma_f32_16x16x32_bf16 v[164:167], v[68:71], a[0:3], 0
    s_add_u32 s54, s50, 221184
    v_mul_f32 v39, v39, v147
    v_mul_f32 v42, v42, v144
    v_rcp_f32 v43, v43
    v_mfma_f32_16x16x32_bf16 v[168:171], v[68:71], a[144:147], 0
    s_waitcnt lgkmcnt(6)
    ds_read_b64_tr_b16 v[64:65], v233 offset:224
    ds_read_b64_tr_b16 v[66:67], v233 offset:2528
    v_mfma_f32_16x16x32_bf16 v[172:175], v[72:75], a[0:3], 0
    s_add_u32 m0, s88, 55296
    v_cvt_pk_bf16_f32 v57, v40, v41
    v_mul_f32 v43, v43, v145
    v_exp_f32 v38, v38
    v_mfma_f32_16x16x32_bf16 v[176:179], v[72:75], a[144:147], 0
    s_waitcnt lgkmcnt(6)
    ds_read_b64_tr_b16 v[68:69], v233 offset:9216
    ds_read_b64_tr_b16 v[70:71], v233 offset:11520
    v_mfma_f32_16x16x32_bf16 v[180:183], v[76:79], a[0:3], 0
    buffer_load_dwordx4 v228, s[24:27], s54 offen offset:0 lds
    v_exp_f32 v39, v39
    v_add_f32 v38, 1.0, v38
    v_mfma_f32_16x16x32_bf16 v[184:187], v[76:79], a[144:147], 0
    s_waitcnt lgkmcnt(6)
    ds_read_b64_tr_b16 v[72:73], v233 offset:9248
    ds_read_b64_tr_b16 v[74:75], v233 offset:11552
    v_mfma_f32_16x16x32_bf16 v[188:191], v[80:83], a[0:3], 0
    buffer_load_dwordx4 v229, s[24:27], s54 offen offset:1024 lds
    v_add_f32 v39, 1.0, v39
    v_rcp_f32 v38, v38
    v_mfma_f32_16x16x32_bf16 v[192:195], v[80:83], a[144:147], 0
    s_waitcnt lgkmcnt(6)
    ds_read_b64_tr_b16 v[76:77], v233 offset:9280
    ds_read_b64_tr_b16 v[78:79], v233 offset:11584
    v_mfma_f32_16x16x32_bf16 v[196:199], v[60:63], a[0:3], 0
    buffer_load_dwordx4 v230, s[24:27], s54 offen offset:2048 lds
    v_rcp_f32 v39, v39
    v_mul_f32 v38, v38, v146
    v_mfma_f32_16x16x32_bf16 v[200:203], v[60:63], a[144:147], 0
    s_waitcnt lgkmcnt(6)
    ds_read_b64_tr_b16 v[80:81], v233 offset:9312
    ds_read_b64_tr_b16 v[82:83], v233 offset:11616
    v_mfma_f32_16x16x32_bf16 v[204:207], v[64:67], a[0:3], 0
    buffer_load_dwordx4 v231, s[24:27], s54 offen offset:3072 lds
    v_cvt_pk_bf16_f32 v58, v42, v43
    v_mul_f32 v39, v39, v147
    v_cvt_pk_bf16_f32 v59, v38, v39
    v_mfma_f32_16x16x32_bf16 v[208:211], v[64:67], a[144:147], 0
    s_waitcnt lgkmcnt(6)
    ds_read_b64_tr_b16 v[60:61], v233 offset:9344
    ds_read_b64_tr_b16 v[62:63], v233 offset:11648
    v_mfma_f32_16x16x32_bf16 v[148:151], v[68:71], a[4:7], v[148:151]
    buffer_store_dwordx4 v[56:59], v25, s[16:19], s43 offen offset:512 sc1
    ds_write_b128 v36, v[56:59] offset:512
    v_mfma_f32_16x16x32_bf16 v[152:155], v[68:71], a[148:151], v[152:155]
    s_waitcnt lgkmcnt(7)
    ds_read_b64_tr_b16 v[64:65], v233 offset:9376
    ds_read_b64_tr_b16 v[66:67], v233 offset:11680
    v_mfma_f32_16x16x32_bf16 v[156:159], v[72:75], a[4:7], v[156:159]
    s_add_u32 m0, s88, 59392
    v_mul_f32 v38, v84, v84
    v_mul_f32 v39, v85, v85
    v_fmaak_f32 v38, v38, v28, 0xc0135761
    v_fmaak_f32 v39, v39, v28, 0xc0135761
    v_mfma_f32_16x16x32_bf16 v[160:163], v[72:75], a[148:151], v[160:163]
    s_waitcnt lgkmcnt(7)
    ds_read_b64_tr_b16 v[68:69], v233 offset:9408
    ds_read_b64_tr_b16 v[70:71], v233 offset:11712
    v_mfma_f32_16x16x32_bf16 v[164:167], v[76:79], a[4:7], v[164:167]
    buffer_load_dwordx4 v232, s[24:27], s54 offen offset:0 lds
    v_mul_f32 v38, v38, v84
    v_mul_f32 v39, v39, v85
    v_mfma_f32_16x16x32_bf16 v[168:171], v[76:79], a[148:151], v[168:171]
    s_waitcnt lgkmcnt(7)
    ds_read_b64_tr_b16 v[72:73], v233 offset:9440
    ds_read_b64_tr_b16 v[74:75], v233 offset:11744
    v_mfma_f32_16x16x32_bf16 v[172:175], v[80:83], a[4:7], v[172:175]
    v_exp_f32 v38, v38
    v_mul_f32 v40, v86, v86
    v_mul_f32 v41, v87, v87
    v_mfma_f32_16x16x32_bf16 v[176:179], v[80:83], a[148:151], v[176:179]
    s_waitcnt lgkmcnt(7)
    s_waitcnt vmcnt(13) lgkmcnt(6)
    s_barrier
    s_waitcnt vmcnt(12)
    s_add_u32 s3, s60, 1
    v_subrev_u32 v23, s3, v29
    v_cmp_ge_u32 vcc, 6, v23
    s_and_b64 vcc, vcc, s[90:91]
    s_cmp_eq_u64 vcc, s[90:91]
    s_cbranch_scc0 L_spine1
L_backe1:
    ds_read_b64_tr_b16 v[76:77], v233 offset:18432
    ds_read_b64_tr_b16 v[78:79], v233 offset:20736
    v_mfma_f32_16x16x32_bf16 v[180:183], v[60:63], a[4:7], v[180:183]
    s_add_u32 s54, s51, 0
    ds_read_b128 a[24:27], v34 offset:64256
    v_add_f32 v38, 1.0, v38
    v_exp_f32 v39, v39
    v_mfma_f32_16x16x32_bf16 v[184:187], v[60:63], a[148:151], v[184:187]
    s_waitcnt lgkmcnt(7)
    ds_read_b64_tr_b16 v[80:81], v233 offset:18464
    ds_read_b64_tr_b16 v[82:83], v233 offset:20768
    v_mfma_f32_16x16x32_bf16 v[188:191], v[64:67], a[4:7], v[188:191]
    s_add_u32 m0, s88, 73728
    ds_read_b128 a[168:171], v34 offset:65280
    v_fmaak_f32 v40, v40, v28, 0xc0135761
    v_fmaak_f32 v41, v41, v28, 0xc0135761
    v_add_f32 v39, 1.0, v39
    v_mfma_f32_16x16x32_bf16 v[192:195], v[64:67], a[148:151], v[192:195]
    s_waitcnt lgkmcnt(8)
    ds_read_b64_tr_b16 v[60:61], v233 offset:18496
    ds_read_b64_tr_b16 v[62:63], v233 offset:20800
    v_mfma_f32_16x16x32_bf16 v[196:199], v[68:71], a[4:7], v[196:199]
    ds_read_b128 a[28:31], v35 offset:6912
    buffer_load_dwordx4 v228, s[24:27], s54 offen offset:0 lds
    v_rcp_f32 v38, v38
    v_mfma_f32_16x16x32_bf16 v[200:203], v[68:71], a[148:151], v[200:203]
    s_waitcnt lgkmcnt(9)
    ds_read_b64_tr_b16 v[64:65], v233 offset:18528
    ds_read_b64_tr_b16 v[66:67], v233 offset:20832
    v_mfma_f32_16x16x32_bf16 v[204:207], v[72:75], a[4:7], v[204:207]
    s_add_u32 s55, s80, 0
    ds_read_b128 a[172:175], v35 offset:7936
    buffer_load_dwordx4 a[32:35], v239, s[16:19], s55 offen offset:0 sc1
    v_mul_f32 v40, v40, v86
    v_mul_f32 v41, v41, v87
    v_mfma_f32_16x16x32_bf16 v[208:211], v[72:75], a[148:151], v[208:211]
    s_waitcnt lgkmcnt(10)
    ds_read_b64_tr_b16 v[68:69], v233 offset:18560
    ds_read_b64_tr_b16 v[70:71], v233 offset:20864
    v_mfma_f32_16x16x32_bf16 v[148:151], v[76:79], a[8:11], v[148:151]
    buffer_load_dwordx4 v229, s[24:27], s54 offen offset:1024 lds
    v_mul_f32 v38, v38, v84
    v_rcp_f32 v39, v39
    v_mfma_f32_16x16x32_bf16 v[152:155], v[76:79], a[152:155], v[152:155]
    s_waitcnt lgkmcnt(9)
    ds_read_b64_tr_b16 v[72:73], v233 offset:18592
    ds_read_b64_tr_b16 v[74:75], v233 offset:20896
    v_mfma_f32_16x16x32_bf16 v[156:159], v[80:83], a[8:11], v[156:159]
    buffer_load_dwordx4 a[176:179], v239, s[16:19], s55 offen offset:1024 sc1
    v_nop
    v_mul_f32 v39, v39, v85
    v_mfma_f32_16x16x32_bf16 v[160:163], v[80:83], a[152:155], v[160:163]
    s_waitcnt lgkmcnt(8)
    ds_read_b64_tr_b16 v[76:77], v233 offset:18624
    ds_read_b64_tr_b16 v[78:79], v233 offset:20928
    v_mfma_f32_16x16x32_bf16 v[164:167], v[60:63], a[8:11], v[164:167]
    v_exp_f32 v40, v40
    v_mul_f32 v42, v88, v88
    v_mul_f32 v43, v89, v89
    v_mfma_f32_16x16x32_bf16 v[168:171], v[60:63], a[152:155], v[168:171]
    s_waitcnt lgkmcnt(7)
    ds_read_b64_tr_b16 v[80:81], v233 offset:18656
    ds_read_b64_tr_b16 v[82:83], v233 offset:20960
    v_mfma_f32_16x16x32_bf16 v[172:175], v[64:67], a[8:11], v[172:175]
    buffer_load_dwordx4 v230, s[24:27], s54 offen offset:2048 lds
    v_add_f32 v40, 1.0, v40
    v_exp_f32 v41, v41
    v_mfma_f32_16x16x32_bf16 v[176:179], v[64:67], a[152:155], v[176:179]
    s_waitcnt lgkmcnt(6)
    ds_read_b64_tr_b16 v[60:61], v233 offset:27648
    ds_read_b64_tr_b16 v[62:63], v233 offset:29952
    v_mfma_f32_16x16x32_bf16 v[180:183], v[68:71], a[8:11], v[180:183]
    buffer_load_dwordx4 a[36:39], v240, s[16:19], s55 offen offset:0 sc1
    v_fmaak_f32 v42, v42, v28, 0xc0135761
    v_fmaak_f32 v43, v43, v28, 0xc0135761
    v_add_f32 v41, 1.0, v41
    v_mfma_f32_16x16x32_bf16 v[184:187], v[68:71], a[152:155], v[184:187]
    s_waitcnt lgkmcnt(6)
    ds_read_b64_tr_b16 v[64:65], v233 offset:27680
    ds_read_b64_tr_b16 v[66:67], v233 offset:29984
    v_mfma_f32_16x16x32_bf16 v[188:191], v[72:75], a[8:11], v[188:191]
    v_rcp_f32 v40, v40
    v_mul_f32 v42, v42, v88
    v_mul_f32 v43, v43, v89
    v_mfma_f32_16x16x32_bf16 v[192:195], v[72:75], a[152:155], v[192:195]
    s_waitcnt lgkmcnt(6)
    ds_read_b64_tr_b16 v[68:69], v233 offset:27712
    ds_read_b64_tr_b16 v[70:71], v233 offset:30016
    v_mfma_f32_16x16x32_bf16 v[196:199], v[76:79], a[8:11], v[196:199]
    buffer_load_dwordx4 v231, s[24:27], s54 offen offset:3072 lds
    v_mul_f32 v40, v40, v86
    v_rcp_f32 v41, v41
    v_mfma_f32_16x16x32_bf16 v[200:203], v[76:79], a[152:155], v[200:203]
    s_waitcnt lgkmcnt(6)
    ds_read_b64_tr_b16 v[72:73], v233 offset:27744
    ds_read_b64_tr_b16 v[74:75], v233 offset:30048
    v_mfma_f32_16x16x32_bf16 v[204:207], v[80:83], a[8:11], v[204:207]
    v_cvt_pk_bf16_f32 v44, v38, v39
    v_mul_f32 v41, v41, v87
    v_exp_f32 v42, v42
    v_mfma_f32_16x16x32_bf16 v[208:211], v[80:83], a[152:155], v[208:211]
    s_waitcnt lgkmcnt(6)
    ds_read_b64_tr_b16 v[76:77], v233 offset:27776
    ds_read_b64_tr_b16 v[78:79], v233 offset:30080
    v_mfma_f32_16x16x32_bf16 v[148:151], v[60:63], a[12:15], v[148:151]
    buffer_load_dwordx4 a[180:183], v240, s[16:19], s55 offen offset:1024 sc1
    v_mul_f32 v38, v90, v90
    v_mul_f32 v39, v91, v91
    v_add_f32 v42, 1.0, v42
    v_mfma_f32_16x16x32_bf16 v[152:155], v[60:63], a[156:159], v[152:155]
    s_waitcnt lgkmcnt(6)
    ds_read_b64_tr_b16 v[80:81], v233 offset:27808
    ds_read_b64_tr_b16 v[82:83], v233 offset:30112
    v_mfma_f32_16x16x32_bf16 v[156:159], v[64:67], a[12:15], v[156:159]
    v_exp_f32 v43, v43
    v_fmaak_f32 v38, v38, v28, 0xc0135761
    v_fmaak_f32 v39, v39, v28, 0xc0135761
    v_mfma_f32_16x16x32_bf16 v[160:163], v[64:67], a[156:159], v[160:163]
    s_waitcnt lgkmcnt(6)
    ds_read_b64_tr_b16 v[60:61], v233 offset:27840
    ds_read_b64_tr_b16 v[62:63], v233 offset:30144
    v_mfma_f32_16x16x32_bf16 v[164:167], v[68:71], a[12:15], v[164:167]
    s_add_u32 m0, s88, 77824
    v_add_f32 v43, 1.0, v43
    v_rcp_f32 v42, v42
    v_mul_f32 v38, v38, v90
    v_mfma_f32_16x16x32_bf16 v[168:171], v[68:71], a[156:159], v[168:171]
    s_waitcnt lgkmcnt(6)
    ds_read_b64_tr_b16 v[64:65], v233 offset:27872
    ds_read_b64_tr_b16 v[66:67], v233 offset:30176
    v_mfma_f32_16x16x32_bf16 v[172:175], v[72:75], a[12:15], v[172:175]
    buffer_load_dwordx4 v232, s[24:27], s54 offen offset:0 lds
    v_mul_f32 v39, v39, v91
    v_mul_f32 v42, v42, v88
    v_mfma_f32_16x16x32_bf16 v[176:179], v[72:75], a[156:159], v[176:179]
    s_waitcnt lgkmcnt(6)
    s_waitcnt vmcnt(15)
    s_barrier
    ds_read_b64_tr_b16 v[68:69], v233 offset:36864
    ds_read_b64_tr_b16 v[70:71], v233 offset:39168
    v_mfma_f32_16x16x32_bf16 v[180:183], v[76:79], a[12:15], v[180:183]
    s_add_u32 s54, s52, 0
    v_rcp_f32 v43, v43
    v_cvt_pk_bf16_f32 v45, v40, v41
    v_mul_f32 v43, v43, v89
    v_mfma_f32_16x16x32_bf16 v[184:187], v[76:79], a[156:159], v[184:187]
    s_waitcnt lgkmcnt(6)
    ds_read_b64_tr_b16 v[72:73], v233 offset:36896
    ds_read_b64_tr_b16 v[74:75], v233 offset:39200
    v_mfma_f32_16x16x32_bf16 v[188:191], v[80:83], a[12:15], v[188:191]
    s_add_u32 m0, s88, 92160
    v_exp_f32 v38, v38
    v_mul_f32 v40, v92, v92
    v_mul_f32 v41, v93, v93
    v_mfma_f32_16x16x32_bf16 v[192:195], v[80:83], a[156:159], v[192:195]
    s_waitcnt lgkmcnt(6)
    ds_read_b64_tr_b16 v[76:77], v233 offset:36928
    ds_read_b64_tr_b16 v[78:79], v233 offset:39232
    v_mfma_f32_16x16x32_bf16 v[196:199], v[60:63], a[12:15], v[196:199]
    buffer_load_dwordx4 v228, s[24:27], s54 offen offset:0 lds
    v_add_f32 v38, 1.0, v38
    v_exp_f32 v39, v39
    v_mfma_f32_16x16x32_bf16 v[200:203], v[60:63], a[156:159], v[200:203]
    s_waitcnt lgkmcnt(6)
    ds_read_b64_tr_b16 v[80:81], v233 offset:36960
    ds_read_b64_tr_b16 v[82:83], v233 offset:39264
    v_mfma_f32_16x16x32_bf16 v[204:207], v[64:67], a[12:15], v[204:207]
    s_add_u32 s55, s81, 0
    buffer_load_dwordx4 a[40:43], v239, s[16:19], s55 offen offset:0 sc1
    v_fmaak_f32 v40, v40, v28, 0xc0135761
    v_fmaak_f32 v41, v41, v28, 0xc0135761
    v_add_f32 v39, 1.0, v39
    v_mfma_f32_16x16x32_bf16 v[208:211], v[64:67], a[156:159], v[208:211]
    s_waitcnt lgkmcnt(6)
    ds_read_b64_tr_b16 v[60:61], v233 offset:36992
    ds_read_b64_tr_b16 v[62:63], v233 offset:39296
    v_mfma_f32_16x16x32_bf16 v[148:151], v[68:71], a[16:19], v[148:151]
    buffer_load_dwordx4 v229, s[24:27], s54 offen offset:1024 lds
    v_rcp_f32 v38, v38
    v_mul_f32 v40, v40, v92
    v_mfma_f32_16x16x32_bf16 v[152:155], v[68:71], a[160:163], v[152:155]
    s_waitcnt lgkmcnt(6)
    ds_read_b64_tr_b16 v[64:65], v233 offset:37024
    ds_read_b64_tr_b16 v[66:67], v233 offset:39328
    v_mfma_f32_16x16x32_bf16 v[156:159], v[72:75], a[16:19], v[156:159]
    buffer_load_dwordx4 a[184:187], v239, s[16:19], s55 offen offset:1024 sc1
    v_mul_f32 v41, v41, v93
    v_mul_f32 v38, v38, v90
    v_mfma_f32_16x16x32_bf16 v[160:163], v[72:75], a[160:163], v[160:163]
    s_waitcnt lgkmcnt(6)
    ds_read_b64_tr_b16 v[68:69], v233 offset:37056
    ds_read_b64_tr_b16 v[70:71], v233 offset:39360
    v_mfma_f32_16x16x32_bf16 v[164:167], v[76:79], a[16:19], v[164:167]
    v_rcp_f32 v39, v39
    v_cvt_pk_bf16_f32 v46, v42, v43
    v_mul_f32 v39, v39, v91
    v_mfma_f32_16x16x32_bf16 v[168:171], v[76:79], a[160:163], v[168:171]
    s_waitcnt lgkmcnt(6)
    ds_read_b64_tr_b16 v[72:73], v233 offset:37088
    ds_read_b64_tr_b16 v[74:75], v233 offset:39392
    v_mfma_f32_16x16x32_bf16 v[172:175], v[80:83], a[16:19], v[172:175]
    buffer_load_dwordx4 v230, s[24:27], s54 offen offset:2048 lds
    v_exp_f32 v40, v40
    v_mul_f32 v42, v94, v94
    v_mfma_f32_16x16x32_bf16 v[176:179], v[80:83], a[160:163], v[176:179]
    s_waitcnt lgkmcnt(6)
    ds_read_b64_tr_b16 v[76:77], v233 offset:46080
    ds_read_b64_tr_b16 v[78:79], v233 offset:48384
    v_mfma_f32_16x16x32_bf16 v[180:183], v[60:63], a[16:19], v[180:183]
    buffer_load_dwordx4 a[44:47], v240, s[16:19], s55 offen offset:0 sc1
    v_mul_f32 v43, v95, v95
    v_add_f32 v40, 1.0, v40
    v_mfma_f32_16x16x32_bf16 v[184:187], v[60:63], a[160:163], v[184:187]
    s_waitcnt lgkmcnt(6)
    ds_read_b64_tr_b16 v[80:81], v233 offset:46112
    ds_read_b64_tr_b16 v[82:83], v233 offset:48416
    v_mfma_f32_16x16x32_bf16 v[188:191], v[64:67], a[16:19], v[188:191]
    v_exp_f32 v41, v41
    v_fmaak_f32 v42, v42, v28, 0xc0135761
    v_fmaak_f32 v43, v43, v28, 0xc0135761
    v_mfma_f32_16x16x32_bf16 v[192:195], v[64:67], a[160:163], v[192:195]
    s_waitcnt lgkmcnt(6)
    ds_read_b64_tr_b16 v[60:61], v233 offset:46144
    ds_read_b64_tr_b16 v[62:63], v233 offset:48448
    v_mfma_f32_16x16x32_bf16 v[196:199], v[68:71], a[16:19], v[196:199]
    buffer_load_dwordx4 v231, s[24:27], s54 offen offset:3072 lds
    v_add_f32 v41, 1.0, v41
    v_rcp_f32 v40, v40
    v_mfma_f32_16x16x32_bf16 v[200:203], v[68:71], a[160:163], v[200:203]
    s_waitcnt lgkmcnt(6)
    ds_read_b64_tr_b16 v[64:65], v233 offset:46176
    ds_read_b64_tr_b16 v[66:67], v233 offset:48480
    v_mfma_f32_16x16x32_bf16 v[204:207], v[72:75], a[16:19], v[204:207]
    v_mul_f32 v42, v42, v94
    v_mul_f32 v43, v43, v95
    s_add_u32 s46, s47, 113408
    v_add_u32 v22, s46, v24
    v_mfma_f32_16x16x32_bf16 v[208:211], v[72:75], a[160:163], v[208:211]
    s_waitcnt lgkmcnt(6)
    ds_read_b64_tr_b16 v[68:69], v233 offset:46208
    ds_read_b64_tr_b16 v[70:71], v233 offset:48512
    v_mfma_f32_16x16x32_bf16 v[148:151], v[76:79], a[20:23], v[148:151]
    buffer_load_dwordx4 a[188:191], v240, s[16:19], s55 offen offset:1024 sc1
    v_add_u32 v36, s46, v25
    v_mul_f32 v40, v40, v92
    v_mfma_f32_16x16x32_bf16 v[152:155], v[76:79], a[164:167], v[152:155]
    s_waitcnt lgkmcnt(6)
    ds_read_b64_tr_b16 v[72:73], v233 offset:46240
    ds_read_b64_tr_b16 v[74:75], v233 offset:48544
    v_mfma_f32_16x16x32_bf16 v[156:159], v[80:83], a[20:23], v[156:159]
    v_rcp_f32 v41, v41
    v_cvt_pk_bf16_f32 v47, v38, v39
    v_mfma_f32_16x16x32_bf16 v[160:163], v[80:83], a[164:167], v[160:163]
    s_waitcnt lgkmcnt(6)
    ds_read_b64_tr_b16 v[76:77], v233 offset:46272
    ds_read_b64_tr_b16 v[78:79], v233 offset:48576
    v_mfma_f32_16x16x32_bf16 v[164:167], v[60:63], a[20:23], v[164:167]
    s_add_u32 m0, s88, 96256
    buffer_store_dwordx4 v[44:47], v24, s[16:19], s44 offen offset:0 sc1
    ds_write_b128 v22, v[44:47] offset:0
    v_mul_f32 v41, v41, v93
    v_mfma_f32_16x16x32_bf16 v[168:171], v[60:63], a[164:167], v[168:171]
    s_waitcnt lgkmcnt(7)
    ds_read_b64_tr_b16 v[80:81], v233 offset:46304
    ds_read_b64_tr_b16 v[82:83], v233 offset:48608
    v_mfma_f32_16x16x32_bf16 v[172:175], v[64:67], a[20:23], v[172:175]
    buffer_load_dwordx4 v232, s[24:27], s54 offen offset:0 lds
    v_exp_f32 v42, v42
    v_mul_f32 v38, v96, v96
    v_mfma_f32_16x16x32_bf16 v[176:179], v[64:67], a[164:167], v[176:179]
    s_waitcnt lgkmcnt(7)
    s_waitcnt vmcnt(19)
    s_barrier
    ds_read_b64_tr_b16 v[60:61], v233 offset:55296
    ds_read_b64_tr_b16 v[62:63], v233 offset:57600
    v_mfma_f32_16x16x32_bf16 v[180:183], v[68:71], a[20:23], v[180:183]
    s_or_b32 s21, s60, 2
    v_mov_b32 v243, s21
    v_mul_f32 v39, v97, v97
    v_add_f32 v42, 1.0, v42
    v_mfma_f32_16x16x32_bf16 v[184:187], v[68:71], a[164:167], v[184:187]
    s_waitcnt lgkmcnt(7)
    ds_read_b64_tr_b16 v[64:65], v233 offset:55328
    ds_read_b64_tr_b16 v[66:67], v233 offset:57632
    v_mfma_f32_16x16x32_bf16 v[188:191], v[72:75], a[20:23], v[188:191]
    buffer_store_dword v243, v241, s[16:19], 0 offen sc1
    v_exp_f32 v43, v43
    v_fmaak_f32 v38, v38, v28, 0xc0135761
    v_mfma_f32_16x16x32_bf16 v[192:195], v[72:75], a[164:167], v[192:195]
    s_waitcnt lgkmcnt(7)
    ds_read_b64_tr_b16 v[68:69], v233 offset:55360
    ds_read_b64_tr_b16 v[70:71], v233 offset:57664
    v_mfma_f32_16x16x32_bf16 v[196:199], v[76:79], a[20:23], v[196:199]
    s_add_u32 s54, s53, 0
    v_fmaak_f32 v39, v39, v28, 0xc0135761
    v_add_f32 v43, 1.0, v43
    v_rcp_f32 v42, v42
    v_mfma_f32_16x16x32_bf16 v[200:203], v[76:79], a[164:167], v[200:203]
    s_waitcnt lgkmcnt(6)
    ds_read_b64_tr_b16 v[72:73], v233 offset:55392
    ds_read_b64_tr_b16 v[74:75], v233 offset:57696
    v_mfma_f32_16x16x32_bf16 v[204:207], v[80:83], a[20:23], v[204:207]
    s_add_u32 m0, s88, 0
    v_mul_f32 v38, v38, v96
    v_mul_f32 v39, v39, v97
    v_mul_f32 v42, v42, v94
    v_mfma_f32_16x16x32_bf16 v[208:211], v[80:83], a[164:167], v[208:211]
    s_waitcnt lgkmcnt(6)
    ds_read_b64_tr_b16 v[76:77], v233 offset:55424
    ds_read_b64_tr_b16 v[78:79], v233 offset:57728
    v_mfma_f32_16x16x32_bf16 v[148:151], v[60:63], a[24:27], v[148:151]
    buffer_load_dwordx4 v228, s[24:27], s54 offen offset:0 lds
    v_rcp_f32 v43, v43
    v_cvt_pk_bf16_f32 v48, v40, v41
    v_mfma_f32_16x16x32_bf16 v[152:155], v[60:63], a[168:171], v[152:155]
    s_waitcnt lgkmcnt(6)
    ds_read_b64_tr_b16 v[80:81], v233 offset:55456
    ds_read_b64_tr_b16 v[82:83], v233 offset:57760
    v_mfma_f32_16x16x32_bf16 v[156:159], v[64:67], a[24:27], v[156:159]
    s_add_u32 s55, s82, 0
    buffer_load_dwordx4 a[48:51], v239, s[16:19], s55 offen offset:0 sc1
    v_mul_f32 v43, v43, v95
    v_exp_f32 v38, v38
    v_mfma_f32_16x16x32_bf16 v[160:163], v[64:67], a[168:171], v[160:163]
    s_waitcnt lgkmcnt(6)
    ds_read_b64_tr_b16 v[60:61], v233 offset:55488
    ds_read_b64_tr_b16 v[62:63], v233 offset:57792
    v_mfma_f32_16x16x32_bf16 v[164:167], v[68:71], a[24:27], v[164:167]
    buffer_load_dwordx4 v229, s[24:27], s54 offen offset:1024 lds
    v_mul_f32 v40, v98, v98
    v_mul_f32 v41, v99, v99
    v_add_f32 v38, 1.0, v38
    v_mfma_f32_16x16x32_bf16 v[168:171], v[68:71], a[168:171], v[168:171]
    s_waitcnt lgkmcnt(6)
    ds_read_b64_tr_b16 v[64:65], v233 offset:55520
    ds_read_b64_tr_b16 v[66:67], v233 offset:57824
    v_mfma_f32_16x16x32_bf16 v[172:175], v[72:75], a[24:27], v[172:175]
    buffer_load_dwordx4 a[192:195], v239, s[16:19], s55 offen offset:1024 sc1
    v_exp_f32 v39, v39
    v_fmaak_f32 v40, v40, v28, 0xc0135761
    v_mfma_f32_16x16x32_bf16 v[176:179], v[72:75], a[168:171], v[176:179]
    s_waitcnt lgkmcnt(6)
    ds_read_b64_tr_b16 v[68:69], v233 offset:64512
    ds_read_b64_tr_b16 v[70:71], v234 offset:1280
    v_mfma_f32_16x16x32_bf16 v[180:183], v[76:79], a[24:27], v[180:183]
    v_fmaak_f32 v41, v41, v28, 0xc0135761
    v_add_f32 v39, 1.0, v39
    v_rcp_f32 v38, v38
    v_mfma_f32_16x16x32_bf16 v[184:187], v[76:79], a[168:171], v[184:187]
    s_waitcnt lgkmcnt(6)
    ds_read_b64_tr_b16 v[72:73], v233 offset:64544
    ds_read_b64_tr_b16 v[74:75], v234 offset:1312
    v_mfma_f32_16x16x32_bf16 v[188:191], v[80:83], a[24:27], v[188:191]
    buffer_load_dwordx4 v230, s[24:27], s54 offen offset:2048 lds
    v_mul_f32 v40, v40, v98
    v_mul_f32 v41, v41, v99
    v_mul_f32 v38, v38, v96
    v_mfma_f32_16x16x32_bf16 v[192:195], v[80:83], a[168:171], v[192:195]
    s_waitcnt lgkmcnt(6)
    ds_read_b64_tr_b16 v[76:77], v233 offset:64576
    ds_read_b64_tr_b16 v[78:79], v234 offset:1344
    v_mfma_f32_16x16x32_bf16 v[196:199], v[60:63], a[24:27], v[196:199]
    buffer_load_dwordx4 a[52:55], v240, s[16:19], s55 offen offset:0 sc1
    v_rcp_f32 v39, v39
    v_cvt_pk_bf16_f32 v49, v42, v43
    v_mfma_f32_16x16x32_bf16 v[200:203], v[60:63], a[168:171], v[200:203]
    s_waitcnt lgkmcnt(6)
    ds_read_b64_tr_b16 v[80:81], v233 offset:64608
    ds_read_b64_tr_b16 v[82:83], v234 offset:1376
    v_mfma_f32_16x16x32_bf16 v[204:207], v[64:67], a[24:27], v[204:207]
    v_mul_f32 v39, v39, v97
    v_exp_f32 v40, v40
    v_mul_f32 v42, v100, v100
    v_mfma_f32_16x16x32_bf16 v[208:211], v[64:67], a[168:171], v[208:211]
    s_waitcnt lgkmcnt(6)
    ds_read_b64_tr_b16 v[60:61], v233 offset:64640
    ds_read_b64_tr_b16 v[62:63], v234 offset:1408
    v_mfma_f32_16x16x32_bf16 v[148:151], v[68:71], a[28:31], v[148:151]
    buffer_load_dwordx4 v231, s[24:27], s54 offen offset:3072 lds
    v_mul_f32 v43, v101, v101
    v_add_f32 v40, 1.0, v40
    v_mfma_f32_16x16x32_bf16 v[152:155], v[68:71], a[172:175], v[152:155]
    s_waitcnt lgkmcnt(6)
    ds_read_b64_tr_b16 v[64:65], v233 offset:64672
    ds_read_b64_tr_b16 v[66:67], v234 offset:1440
    v_mfma_f32_16x16x32_bf16 v[156:159], v[72:75], a[28:31], v[156:159]
    v_exp_f32 v41, v41
    v_fmaak_f32 v42, v42, v28, 0xc0135761
    v_fmaak_f32 v43, v43, v28, 0xc0135761
    v_mfma_f32_16x16x32_bf16 v[160:163], v[72:75], a[172:175], v[160:163]
    s_waitcnt lgkmcnt(6)
    ds_read_b64_tr_b16 v[68:69], v233 offset:64704
    ds_read_b64_tr_b16 v[70:71], v234 offset:1472
    v_mfma_f32_16x16x32_bf16 v[164:167], v[76:79], a[28:31], v[164:167]
    buffer_load_dwordx4 a[196:199], v240, s[16:19], s55 offen offset:1024 sc1
    v_add_f32 v41, 1.0, v41
    v_rcp_f32 v40, v40
    v_mfma_f32_16x16x32_bf16 v[168:171], v[76:79], a[172:175], v[168:171]
    s_waitcnt lgkmcnt(6)
    ds_read_b64_tr_b16 v[72:73], v233 offset:64736
    ds_read_b64_tr_b16 v[74:75], v234 offset:1504
    v_mfma_f32_16x16x32_bf16 v[172:175], v[80:83], a[28:31], v[172:175]
    v_mul_f32 v42, v42, v100
    v_mul_f32 v43, v43, v101
    v_mul_f32 v40, v40, v98
    v_mfma_f32_16x16x32_bf16 v[176:179], v[80:83], a[172:175], v[176:179]
    s_waitcnt lgkmcnt(6)
    s_waitcnt vmcnt(19)
    s_barrier
    ds_read_b64_tr_b16 v[76:77], v234 offset:8192
    ds_read_b64_tr_b16 v[78:79], v234 offset:10496
    v_mfma_f32_16x16x32_bf16 v[180:183], v[60:63], a[28:31], v[180:183]
    s_add_u32 m0, s88, 4096
    v_rcp_f32 v41, v41
    v_cvt_pk_bf16_f32 v50, v38, v39
    v_mul_f32 v41, v41, v99
    v_mfma_f32_16x16x32_bf16 v[184:187], v[60:63], a[172:175], v[184:187]
    s_waitcnt lgkmcnt(6)
    ds_read_b64_tr_b16 v[80:81], v234 offset:8224
    ds_read_b64_tr_b16 v[82:83], v234 offset:10528
    v_mfma_f32_16x16x32_bf16 v[188:191], v[64:67], a[28:31], v[188:191]
    buffer_load_dwordx4 v232, s[24:27], s54 offen offset:0 lds
    v_exp_f32 v42, v42
    v_mul_f32 v38, v102, v102
    v_mfma_f32_16x16x32_bf16 v[192:195], v[64:67], a[172:175], v[192:195]
    s_waitcnt lgkmcnt(6)
    ds_read_b64_tr_b16 v[60:61], v234 offset:8256
    ds_read_b64_tr_b16 v[62:63], v234 offset:10560
    v_mfma_f32_16x16x32_bf16 v[196:199], v[68:71], a[28:31], v[196:199]
    s_add_u32 s54, s51, 73728
    v_mul_f32 v39, v103, v103
    v_add_f32 v42, 1.0, v42
    v_exp_f32 v43, v43
    v_mfma_f32_16x16x32_bf16 v[200:203], v[68:71], a[172:175], v[200:203]
    s_waitcnt lgkmcnt(6)
    ds_read_b64_tr_b16 v[64:65], v234 offset:8288
    ds_read_b64_tr_b16 v[66:67], v234 offset:10592
    v_mfma_f32_16x16x32_bf16 v[204:207], v[72:75], a[28:31], v[204:207]
    s_add_u32 m0, s88, 18432
    v_fmaak_f32 v38, v38, v28, 0xc0135761
    v_fmaak_f32 v39, v39, v28, 0xc0135761
    v_add_f32 v43, 1.0, v43
    v_mfma_f32_16x16x32_bf16 v[208:211], v[72:75], a[172:175], v[208:211]
    s_waitcnt lgkmcnt(6)
    ds_read_b64_tr_b16 v[68:69], v234 offset:8320
    ds_read_b64_tr_b16 v[70:71], v234 offset:10624
    v_mfma_f32_16x16x32_bf16 v[148:151], v[76:79], a[32:35], v[148:151]
    buffer_load_dwordx4 v228, s[24:27], s54 offen offset:0 lds
    v_rcp_f32 v42, v42
    v_mul_f32 v38, v38, v102
    v_mfma_f32_16x16x32_bf16 v[152:155], v[76:79], a[176:179], v[152:155]
    s_waitcnt lgkmcnt(6)
    ds_read_b64_tr_b16 v[72:73], v234 offset:8352
    ds_read_b64_tr_b16 v[74:75], v234 offset:10656
    v_mfma_f32_16x16x32_bf16 v[156:159], v[80:83], a[32:35], v[156:159]
    s_add_u32 s55, s80, 16384
    buffer_load_dwordx4 a[56:59], v239, s[16:19], s55 offen offset:0 sc1
    v_mul_f32 v39, v39, v103
    v_mul_f32 v42, v42, v100
    v_mfma_f32_16x16x32_bf16 v[160:163], v[80:83], a[176:179], v[160:163]
    s_waitcnt lgkmcnt(6)
    ds_read_b64_tr_b16 v[76:77], v234 offset:8384
    ds_read_b64_tr_b16 v[78:79], v234 offset:10688
    v_mfma_f32_16x16x32_bf16 v[164:167], v[60:63], a[32:35], v[164:167]
    s_lshl_b32 s76, s57, 2
    buffer_load_dwordx4 v229, s[24:27], s54 offen offset:1024 lds
    v_rcp_f32 v43, v43
    v_cvt_pk_bf16_f32 v51, v40, v41
    v_mfma_f32_16x16x32_bf16 v[168:171], v[60:63], a[176:179], v[168:171]
    s_waitcnt lgkmcnt(6)
    ds_read_b64_tr_b16 v[80:81], v234 offset:8416
    ds_read_b64_tr_b16 v[82:83], v234 offset:10720
    v_mfma_f32_16x16x32_bf16 v[172:175], v[64:67], a[32:35], v[172:175]
    s_add_u32 s76, s76, s59
    buffer_store_dwordx4 v[48:51], v24, s[16:19], s44 offen offset:512 sc1
    ds_write_b128 v22, v[48:51] offset:512
    buffer_load_dwordx4 a[200:203], v239, s[16:19], s55 offen offset:1024 sc1
    v_mul_f32 v43, v43, v101
    v_mfma_f32_16x16x32_bf16 v[176:179], v[64:67], a[176:179], v[176:179]
    s_waitcnt lgkmcnt(7)
    ds_read_b64_tr_b16 v[60:61], v234 offset:17408
    ds_read_b64_tr_b16 v[62:63], v234 offset:19712
    v_mfma_f32_16x16x32_bf16 v[180:183], v[68:71], a[32:35], v[180:183]
    s_mul_i32 s75, s76, 163840
    v_exp_f32 v38, v38
    v_mul_f32 v40, v104, v104
    v_mul_f32 v41, v105, v105
    v_mfma_f32_16x16x32_bf16 v[184:187], v[68:71], a[176:179], v[184:187]
    s_waitcnt lgkmcnt(7)
    ds_read_b64_tr_b16 v[64:65], v234 offset:17440
    ds_read_b64_tr_b16 v[66:67], v234 offset:19744
    v_mfma_f32_16x16x32_bf16 v[188:191], v[72:75], a[32:35], v[188:191]
    s_lshl_b32 s76, s56, 10
    buffer_load_dwordx4 v230, s[24:27], s54 offen offset:2048 lds
    v_add_f32 v38, 1.0, v38
    v_exp_f32 v39, v39
    v_mfma_f32_16x16x32_bf16 v[192:195], v[72:75], a[176:179], v[192:195]
    s_waitcnt lgkmcnt(7)
    ds_read_b64_tr_b16 v[68:69], v234 offset:17472
    ds_read_b64_tr_b16 v[70:71], v234 offset:19776
    v_mfma_f32_16x16x32_bf16 v[196:199], v[76:79], a[32:35], v[196:199]
    s_add_u32 s75, s75, s76
    buffer_load_dwordx4 a[60:63], v240, s[16:19], s55 offen offset:0 sc1
    v_fmaak_f32 v40, v40, v28, 0xc0135761
    v_fmaak_f32 v41, v41, v28, 0xc0135761
    v_add_f32 v39, 1.0, v39
    v_mfma_f32_16x16x32_bf16 v[200:203], v[76:79], a[176:179], v[200:203]
    s_waitcnt lgkmcnt(7)
    ds_read_b64_tr_b16 v[72:73], v234 offset:17504
    ds_read_b64_tr_b16 v[74:75], v234 offset:19808
    v_mfma_f32_16x16x32_bf16 v[204:207], v[80:83], a[32:35], v[204:207]
    s_add_u32 s75, s75, 33554432
    v_rcp_f32 v38, v38
    v_mul_f32 v40, v40, v104
    v_mul_f32 v41, v41, v105
    v_mfma_f32_16x16x32_bf16 v[208:211], v[80:83], a[176:179], v[208:211]
    s_waitcnt lgkmcnt(6)
    ds_read_b64_tr_b16 v[76:77], v234 offset:17536
    ds_read_b64_tr_b16 v[78:79], v234 offset:19840
    v_mfma_f32_16x16x32_bf16 v[148:151], v[60:63], a[36:39], v[148:151]
    s_lshl_b32 s94, s58, 12
    buffer_load_dwordx4 v231, s[24:27], s54 offen offset:3072 lds
    v_mul_f32 v38, v38, v102
    v_rcp_f32 v39, v39
    v_mfma_f32_16x16x32_bf16 v[152:155], v[60:63], a[180:183], v[152:155]
    s_waitcnt lgkmcnt(6)
    ds_read_b64_tr_b16 v[80:81], v234 offset:17568
    ds_read_b64_tr_b16 v[82:83], v234 offset:19872
    v_mfma_f32_16x16x32_bf16 v[156:159], v[64:67], a[36:39], v[156:159]
    s_add_u32 s94, s94, s75
    v_cvt_pk_bf16_f32 v52, v42, v43
    v_mul_f32 v39, v39, v103
    v_exp_f32 v40, v40
    v_mfma_f32_16x16x32_bf16 v[160:163], v[64:67], a[180:183], v[160:163]
    s_waitcnt lgkmcnt(6)
    ds_read_b64_tr_b16 v[60:61], v234 offset:17600
    ds_read_b64_tr_b16 v[62:63], v234 offset:19904
    v_mfma_f32_16x16x32_bf16 v[164:167], v[68:71], a[36:39], v[164:167]
    s_add_u32 s76, s58, 1
    buffer_load_dwordx4 a[204:207], v240, s[16:19], s55 offen offset:1024 sc1
    v_mul_f32 v42, v106, v106
    v_mul_f32 v43, v107, v107
    v_add_f32 v40, 1.0, v40
    v_mfma_f32_16x16x32_bf16 v[168:171], v[68:71], a[180:183], v[168:171]
    s_waitcnt lgkmcnt(6)
    ds_read_b64_tr_b16 v[64:65], v234 offset:17632
    ds_read_b64_tr_b16 v[66:67], v234 offset:19936
    v_mfma_f32_16x16x32_bf16 v[172:175], v[72:75], a[36:39], v[172:175]
    s_and_b32 s76, s76, 3
    v_exp_f32 v41, v41
    v_fmaak_f32 v42, v42, v28, 0xc0135761
    v_fmaak_f32 v43, v43, v28, 0xc0135761
    v_mfma_f32_16x16x32_bf16 v[176:179], v[72:75], a[180:183], v[176:179]
    s_waitcnt lgkmcnt(6)
    s_waitcnt vmcnt(19)
    s_barrier
    ds_read_b64_tr_b16 v[68:69], v234 offset:26624
    ds_read_b64_tr_b16 v[70:71], v234 offset:28928
    v_mfma_f32_16x16x32_bf16 v[180:183], v[76:79], a[36:39], v[180:183]
    s_add_u32 m0, s88, 22528
    v_add_f32 v41, 1.0, v41
    v_rcp_f32 v40, v40
    v_mul_f32 v42, v42, v106
    v_mfma_f32_16x16x32_bf16 v[184:187], v[76:79], a[180:183], v[184:187]
    s_waitcnt lgkmcnt(6)
    ds_read_b64_tr_b16 v[72:73], v234 offset:26656
    ds_read_b64_tr_b16 v[74:75], v234 offset:28960
    v_mfma_f32_16x16x32_bf16 v[188:191], v[80:83], a[36:39], v[188:191]
    s_lshl_b32 s76, s76, 15
    buffer_load_dwordx4 v232, s[24:27], s54 offen offset:0 lds
    v_mul_f32 v43, v43, v107
    v_mul_f32 v40, v40, v104
    v_mfma_f32_16x16x32_bf16 v[192:195], v[80:83], a[180:183], v[192:195]
    s_waitcnt lgkmcnt(6)
    ds_read_b64_tr_b16 v[76:77], v234 offset:26688
    ds_read_b64_tr_b16 v[78:79], v234 offset:28992
    v_mfma_f32_16x16x32_bf16 v[196:199], v[60:63], a[36:39], v[196:199]
    s_add_u32 s54, s52, 73728
    v_rcp_f32 v41, v41
    v_cvt_pk_bf16_f32 v53, v38, v39
    v_mul_f32 v41, v41, v105
    v_mfma_f32_16x16x32_bf16 v[200:203], v[60:63], a[180:183], v[200:203]
    s_waitcnt lgkmcnt(6)
    ds_read_b64_tr_b16 v[80:81], v234 offset:26720
    ds_read_b64_tr_b16 v[82:83], v234 offset:29024
    v_mfma_f32_16x16x32_bf16 v[204:207], v[64:67], a[36:39], v[204:207]
    s_add_u32 m0, s88, 36864
    v_exp_f32 v42, v42
    v_mul_f32 v38, v108, v108
    v_mul_f32 v39, v109, v109
    v_mfma_f32_16x16x32_bf16 v[208:211], v[64:67], a[180:183], v[208:211]
    s_waitcnt lgkmcnt(6)
    ds_read_b64_tr_b16 v[60:61], v234 offset:26752
    ds_read_b64_tr_b16 v[62:63], v234 offset:29056
    v_mfma_f32_16x16x32_bf16 v[148:151], v[68:71], a[40:43], v[148:151]
    s_add_u32 s61, s76, s94
    buffer_load_dwordx4 v228, s[24:27], s54 offen offset:0 lds
    v_add_f32 v42, 1.0, v42
    v_exp_f32 v43, v43
    v_mfma_f32_16x16x32_bf16 v[152:155], v[68:71], a[184:187], v[152:155]
    s_waitcnt lgkmcnt(6)
    ds_read_b64_tr_b16 v[64:65], v234 offset:26784
    ds_read_b64_tr_b16 v[66:67], v234 offset:29088
    v_mfma_f32_16x16x32_bf16 v[156:159], v[72:75], a[40:43], v[156:159]
    s_add_u32 s55, s81, 16384
    buffer_load_dwordx4 a[64:67], v239, s[16:19], s55 offen offset:0 sc1
    v_fmaak_f32 v38, v38, v28, 0xc0135761
    v_fmaak_f32 v39, v39, v28, 0xc0135761
    v_add_f32 v43, 1.0, v43
    v_mfma_f32_16x16x32_bf16 v[160:163], v[72:75], a[184:187], v[160:163]
    s_waitcnt lgkmcnt(6)
    ds_read_b64_tr_b16 v[68:69], v234 offset:26816
    ds_read_b64_tr_b16 v[70:71], v234 offset:29120
    v_mfma_f32_16x16x32_bf16 v[164:167], v[76:79], a[40:43], v[164:167]
    s_add_u32 s62, s61, 16384
    buffer_load_dwordx4 v229, s[24:27], s54 offen offset:1024 lds
    v_rcp_f32 v42, v42
    v_mul_f32 v38, v38, v108
    v_mfma_f32_16x16x32_bf16 v[168:171], v[76:79], a[184:187], v[168:171]
    s_waitcnt lgkmcnt(6)
    ds_read_b64_tr_b16 v[72:73], v234 offset:26848
    ds_read_b64_tr_b16 v[74:75], v234 offset:29152
    v_mfma_f32_16x16x32_bf16 v[172:175], v[80:83], a[40:43], v[172:175]
    s_add_u32 s76, s58, 2
    buffer_load_dwordx4 a[208:211], v239, s[16:19], s55 offen offset:1024 sc1
    v_mul_f32 v39, v39, v109
    v_mul_f32 v42, v42, v106
    v_mfma_f32_16x16x32_bf16 v[176:179], v[80:83], a[184:187], v[176:179]
    s_waitcnt lgkmcnt(6)
    ds_read_b64_tr_b16 v[76:77], v234 offset:35840
    ds_read_b64_tr_b16 v[78:79], v234 offset:38144
    v_mfma_f32_16x16x32_bf16 v[180:183], v[60:63], a[40:43], v[180:183]
    s_and_b32 s76, s76, 3
    v_rcp_f32 v43, v43
    v_cvt_pk_bf16_f32 v54, v40, v41
    v_mul_f32 v43, v43, v107
    v_mfma_f32_16x16x32_bf16 v[184:187], v[60:63], a[184:187], v[184:187]
    s_waitcnt lgkmcnt(6)
    ds_read_b64_tr_b16 v[80:81], v234 offset:35872
    ds_read_b64_tr_b16 v[82:83], v234 offset:38176
    v_mfma_f32_16x16x32_bf16 v[188:191], v[64:67], a[40:43], v[188:191]
    s_lshl_b32 s76, s76, 15
    buffer_load_dwordx4 v230, s[24:27], s54 offen offset:2048 lds
    v_exp_f32 v38, v38
    v_mul_f32 v40, v110, v110
    v_mfma_f32_16x16x32_bf16 v[192:195], v[64:67], a[184:187], v[192:195]
    s_waitcnt lgkmcnt(6)
    ds_read_b64_tr_b16 v[60:61], v234 offset:35904
    ds_read_b64_tr_b16 v[62:63], v234 offset:38208
    v_mfma_f32_16x16x32_bf16 v[196:199], v[68:71], a[40:43], v[196:199]
    s_add_u32 s63, s76, s94
    buffer_load_dwordx4 a[68:71], v240, s[16:19], s55 offen offset:0 sc1
    v_mul_f32 v41, v111, v111
    v_add_f32 v38, 1.0, v38
    v_mfma_f32_16x16x32_bf16 v[200:203], v[68:71], a[184:187], v[200:203]
    s_waitcnt lgkmcnt(6)
    ds_read_b64_tr_b16 v[64:65], v234 offset:35936
    ds_read_b64_tr_b16 v[66:67], v234 offset:38240
    v_mfma_f32_16x16x32_bf16 v[204:207], v[72:75], a[40:43], v[204:207]
    s_add_u32 s64, s63, 16384
    v_exp_f32 v39, v39
    v_fmaak_f32 v40, v40, v28, 0xc0135761
    v_fmaak_f32 v41, v41, v28, 0xc0135761
    v_mfma_f32_16x16x32_bf16 v[208:211], v[72:75], a[184:187], v[208:211]
    s_waitcnt lgkmcnt(6)
    ds_read_b64_tr_b16 v[68:69], v234 offset:35968
    ds_read_b64_tr_b16 v[70:71], v234 offset:38272
    v_mfma_f32_16x16x32_bf16 v[148:151], v[76:79], a[44:47], v[148:151]
    s_add_u32 s76, s58, 3
    buffer_load_dwordx4 v231, s[24:27], s54 offen offset:3072 lds
    v_add_f32 v39, 1.0, v39
    v_rcp_f32 v38, v38
    v_mfma_f32_16x16x32_bf16 v[152:155], v[76:79], a[188:191], v[152:155]
    s_waitcnt lgkmcnt(6)
    ds_read_b64_tr_b16 v[72:73], v234 offset:36000
    ds_read_b64_tr_b16 v[74:75], v234 offset:38304
    v_mfma_f32_16x16x32_bf16 v[156:159], v[80:83], a[44:47], v[156:159]
    s_and_b32 s76, s76, 3
    v_mul_f32 v40, v40, v110
    v_mul_f32 v41, v41, v111
    v_mul_f32 v38, v38, v108
    v_mfma_f32_16x16x32_bf16 v[160:163], v[80:83], a[188:191], v[160:163]
    s_waitcnt lgkmcnt(6)
    ds_read_b64_tr_b16 v[76:77], v234 offset:36032
    ds_read_b64_tr_b16 v[78:79], v234 offset:38336
    v_mfma_f32_16x16x32_bf16 v[164:167], v[60:63], a[44:47], v[164:167]
    s_lshl_b32 s76, s76, 15
    buffer_load_dwordx4 a[212:215], v240, s[16:19], s55 offen offset:1024 sc1
    v_rcp_f32 v39, v39
    v_cvt_pk_bf16_f32 v55, v42, v43
    v_mfma_f32_16x16x32_bf16 v[168:171], v[60:63], a[188:191], v[168:171]
    s_waitcnt lgkmcnt(6)
    ds_read_b64_tr_b16 v[80:81], v234 offset:36064
    ds_read_b64_tr_b16 v[82:83], v234 offset:38368
    v_mfma_f32_16x16x32_bf16 v[172:175], v[64:67], a[44:47], v[172:175]
    s_add_u32 s65, s76, s94
    buffer_store_dwordx4 v[52:55], v25, s[16:19], s44 offen offset:0 sc1
    ds_write_b128 v36, v[52:55] offset:0
    v_mul_f32 v39, v39, v109
    v_mfma_f32_16x16x32_bf16 v[176:179], v[64:67], a[188:191], v[176:179]
    s_waitcnt lgkmcnt(7)
    s_waitcnt vmcnt(19)
    s_barrier
    ds_read_b64_tr_b16 v[60:61], v233 offset:0
    ds_read_b64_tr_b16 v[62:63], v233 offset:2304
    v_mfma_f32_16x16x32_bf16 v[180:183], v[68:71], a[44:47], v[180:183]
    s_add_u32 s66, s65, 16384
    buffer_load_dword v29, v242, s[16:19], 0 offen sc1
    v_exp_f32 v40, v40
    v_mul_f32 v42, v112, v112
    v_mfma_f32_16x16x32_bf16 v[184:187], v[68:71], a[188:191], v[184:187]
    s_waitcnt lgkmcnt(7)
    ds_read_b64_tr_b16 v[64:65], v233 offset:32
    ds_read_b64_tr_b16 v[66:67], v233 offset:2336
    v_mfma_f32_16x16x32_bf16 v[188:191], v[72:75], a[44:47], v[188:191]
    s_add_u32 m0, s88, 40960
    v_mul_f32 v43, v113, v113
    v_add_f32 v40, 1.0, v40
    v_exp_f32 v41, v41
    v_mfma_f32_16x16x32_bf16 v[192:195], v[72:75], a[188:191], v[192:195]
    s_waitcnt lgkmcnt(7)
    ds_read_b64_tr_b16 v[68:69], v233 offset:64
    ds_read_b64_tr_b16 v[70:71], v233 offset:2368
    v_mfma_f32_16x16x32_bf16 v[196:199], v[76:79], a[44:47], v[196:199]
    s_lshl_b32 s95, s57, 7
    buffer_load_dwordx4 v232, s[24:27], s54 offen offset:0 lds
    v_fmaak_f32 v42, v42, v28, 0xc0135761
    v_fmaak_f32 v43, v43, v28, 0xc0135761
    v_add_f32 v41, 1.0, v41
    v_mfma_f32_16x16x32_bf16 v[200:203], v[76:79], a[188:191], v[200:203]
    s_waitcnt lgkmcnt(7)
    ds_read_b64_tr_b16 v[72:73], v233 offset:96
    ds_read_b64_tr_b16 v[74:75], v233 offset:2400
    v_mfma_f32_16x16x32_bf16 v[204:207], v[80:83], a[44:47], v[204:207]
    s_add_u32 s54, s53, 73728
    v_rcp_f32 v40, v40
    v_mul_f32 v42, v42, v112
    v_mul_f32 v43, v43, v113
    v_mfma_f32_16x16x32_bf16 v[208:211], v[80:83], a[188:191], v[208:211]
    s_waitcnt lgkmcnt(6)
    ds_read_b64_tr_b16 v[76:77], v233 offset:128
    ds_read_b64_tr_b16 v[78:79], v233 offset:2432
    v_mfma_f32_16x16x32_bf16 v[148:151], v[60:63], a[48:51], v[148:151]
    s_add_u32 m0, s88, 144128
    v_mul_f32 v40, v40, v110
    v_rcp_f32 v41, v41
    v_cvt_pk_bf16_f32 v56, v38, v39
    v_mfma_f32_16x16x32_bf16 v[152:155], v[60:63], a[192:195], v[152:155]
    s_waitcnt lgkmcnt(6)
    ds_read_b64_tr_b16 v[80:81], v233 offset:160
    ds_read_b64_tr_b16 v[82:83], v233 offset:2464
    v_mfma_f32_16x16x32_bf16 v[156:159], v[64:67], a[48:51], v[156:159]
    s_lshl_b32 s76, s56, 5
    buffer_load_dwordx4 v228, s[24:27], s54 offen offset:0 lds
    v_mul_f32 v41, v41, v111
    v_exp_f32 v42, v42
    v_mfma_f32_16x16x32_bf16 v[160:163], v[64:67], a[192:195], v[160:163]
    s_waitcnt lgkmcnt(6)
    ds_read_b64_tr_b16 v[60:61], v233 offset:192
    ds_read_b64_tr_b16 v[62:63], v233 offset:2496
    v_mfma_f32_16x16x32_bf16 v[164:167], v[68:71], a[48:51], v[164:167]
    s_add_u32 s55, s82, 16384
    buffer_load_dwordx4 a[72:75], v239, s[16:19], s55 offen offset:0 sc1
    v_mul_f32 v38, v114, v114
    v_mul_f32 v39, v115, v115
    v_add_f32 v42, 1.0, v42
    v_mfma_f32_16x16x32_bf16 v[168:171], v[68:71], a[192:195], v[168:171]
    s_waitcnt lgkmcnt(6)
    ds_read_b64_tr_b16 v[64:65], v233 offset:224
    ds_read_b64_tr_b16 v[66:67], v233 offset:2528
    v_mfma_f32_16x16x32_bf16 v[172:175], v[72:75], a[48:51], v[172:175]
    s_add_u32 s95, s95, s76
    buffer_load_dwordx4 v229, s[24:27], s54 offen offset:1024 lds
    v_exp_f32 v43, v43
    v_fmaak_f32 v38, v38, v28, 0xc0135761
    v_mfma_f32_16x16x32_bf16 v[176:179], v[72:75], a[192:195], v[176:179]
    s_waitcnt lgkmcnt(6)
    ds_read_b64_tr_b16 v[68:69], v233 offset:9216
    ds_read_b64_tr_b16 v[70:71], v233 offset:11520
    v_mfma_f32_16x16x32_bf16 v[180:183], v[76:79], a[48:51], v[180:183]
    s_mul_i32 s95, s95, 1152
    buffer_load_dwordx4 a[216:219], v239, s[16:19], s55 offen offset:1024 sc1
    v_fmaak_f32 v39, v39, v28, 0xc0135761
    v_add_f32 v43, 1.0, v43
    v_mfma_f32_16x16x32_bf16 v[184:187], v[76:79], a[192:195], v[184:187]
    s_waitcnt lgkmcnt(6)
    ds_read_b64_tr_b16 v[72:73], v233 offset:9248
    ds_read_b64_tr_b16 v[74:75], v233 offset:11552
    v_mfma_f32_16x16x32_bf16 v[188:191], v[80:83], a[48:51], v[188:191]
    s_add_u32 s76, s58, 4
    v_rcp_f32 v42, v42
    v_mul_f32 v38, v38, v114
    v_mul_f32 v39, v39, v115
    v_mfma_f32_16x16x32_bf16 v[192:195], v[80:83], a[192:195], v[192:195]
    s_waitcnt lgkmcnt(6)
    ds_read_b64_tr_b16 v[76:77], v233 offset:9280
    ds_read_b64_tr_b16 v[78:79], v233 offset:11584
    v_mfma_f32_16x16x32_bf16 v[196:199], v[60:63], a[48:51], v[196:199]
    s_and_b32 s76, s76, 3
    buffer_load_dwordx4 v230, s[24:27], s54 offen offset:2048 lds
    v_mul_f32 v42, v42, v112
    v_rcp_f32 v43, v43
    v_mfma_f32_16x16x32_bf16 v[200:203], v[60:63], a[192:195], v[200:203]
    s_waitcnt lgkmcnt(6)
    ds_read_b64_tr_b16 v[80:81], v233 offset:9312
    ds_read_b64_tr_b16 v[82:83], v233 offset:11616
    v_mfma_f32_16x16x32_bf16 v[204:207], v[64:67], a[48:51], v[204:207]
    s_lshl_b32 s77, s76, 15
    v_cvt_pk_bf16_f32 v57, v40, v41
    v_mul_f32 v43, v43, v113
    v_exp_f32 v38, v38
    v_mfma_f32_16x16x32_bf16 v[208:211], v[64:67], a[192:195], v[208:211]
    s_waitcnt lgkmcnt(6)
    ds_read_b64_tr_b16 v[60:61], v233 offset:9344
    ds_read_b64_tr_b16 v[62:63], v233 offset:11648
    v_mfma_f32_16x16x32_bf16 v[148:151], v[68:71], a[52:55], v[148:151]
    s_add_u32 s69, s77, s75
    buffer_load_dwordx4 a[76:79], v240, s[16:19], s55 offen offset:0 sc1
    v_exp_f32 v39, v39
    v_add_f32 v38, 1.0, v38
    v_mfma_f32_16x16x32_bf16 v[152:155], v[68:71], a[196:199], v[152:155]
    s_waitcnt lgkmcnt(6)
    ds_read_b64_tr_b16 v[64:65], v233 offset:9376
    ds_read_b64_tr_b16 v[66:67], v233 offset:11680
    v_mfma_f32_16x16x32_bf16 v[156:159], v[72:75], a[52:55], v[156:159]
    s_lshl_b32 s76, s76, 6
    v_add_f32 v39, 1.0, v39
    v_rcp_f32 v38, v38
    v_mfma_f32_16x16x32_bf16 v[160:163], v[72:75], a[196:199], v[160:163]
    s_waitcnt lgkmcnt(6)
    ds_read_b64_tr_b16 v[68:69], v233 offset:9408
    ds_read_b64_tr_b16 v[70:71], v233 offset:11712
    v_mfma_f32_16x16x32_bf16 v[164:167], v[76:79], a[52:55], v[164:167]
    s_add_u32 s78, s76, s86
    buffer_load_dwordx4 v231, s[24:27], s54 offen offset:3072 lds
    v_rcp_f32 v39, v39
    v_mul_f32 v38, v38, v114
    v_mfma_f32_16x16x32_bf16 v[168:171], v[76:79], a[196:199], v[168:171]
    s_waitcnt lgkmcnt(6)
    ds_read_b64_tr_b16 v[72:73], v233 offset:9440
    ds_read_b64_tr_b16 v[74:75], v233 offset:11744
    v_mfma_f32_16x16x32_bf16 v[172:175], v[80:83], a[52:55], v[172:175]
    s_add_u32 s72, s78, s95
    buffer_load_dwordx4 a[220:223], v240, s[16:19], s55 offen offset:1024 sc1
    v_cvt_pk_bf16_f32 v58, v42, v43
    v_mul_f32 v39, v39, v115
    v_cvt_pk_bf16_f32 v59, v38, v39
    v_mfma_f32_16x16x32_bf16 v[176:179], v[80:83], a[196:199], v[176:179]
    s_waitcnt lgkmcnt(6)
    s_waitcnt vmcnt(19)
    s_barrier
    s_waitcnt vmcnt(9)
    s_add_u32 s3, s60, 2
    v_subrev_u32 v23, s3, v29
    v_cmp_ge_u32 vcc, 5, v23
    s_and_b64 vcc, vcc, s[90:91]
    s_cmp_eq_u64 vcc, s[90:91]
    s_cbranch_scc0 L_spine2
L_backe2:
    ds_read_b64_tr_b16 v[76:77], v233 offset:18432
    ds_read_b64_tr_b16 v[78:79], v233 offset:20736
    v_mfma_f32_16x16x32_bf16 v[180:183], v[60:63], a[52:55], v[180:183]
    buffer_store_dwordx4 v[56:59], v25, s[16:19], s44 offen offset:512 sc1
    ds_write_b128 v36, v[56:59] offset:512
    v_mfma_f32_16x16x32_bf16 v[184:187], v[60:63], a[196:199], v[184:187]
    s_waitcnt lgkmcnt(7)
    ds_read_b64_tr_b16 v[80:81], v233 offset:18464
    ds_read_b64_tr_b16 v[82:83], v233 offset:20768
    v_mfma_f32_16x16x32_bf16 v[188:191], v[64:67], a[52:55], v[188:191]
    s_add_u32 m0, s88, 148224
    v_mfma_f32_16x16x32_bf16 v[192:195], v[64:67], a[196:199], v[192:195]
    s_waitcnt lgkmcnt(7)
    ds_read_b64_tr_b16 v[60:61], v233 offset:18496
    ds_read_b64_tr_b16 v[62:63], v233 offset:20800
    v_mfma_f32_16x16x32_bf16 v[196:199], v[68:71], a[52:55], v[196:199]
    buffer_load_dwordx4 v232, s[24:27], s54 offen offset:0 lds
    v_mfma_f32_16x16x32_bf16 v[200:203], v[68:71], a[196:199], v[200:203]
    s_waitcnt lgkmcnt(7)
    ds_read_b64_tr_b16 v[64:65], v233 offset:18528
    ds_read_b64_tr_b16 v[66:67], v233 offset:20832
    v_mfma_f32_16x16x32_bf16 v[204:207], v[72:75], a[52:55], v[204:207]
    s_add_u32 s54, s50, 294912
    v_mfma_f32_16x16x32_bf16 v[208:211], v[72:75], a[196:199], v[208:211]
    s_waitcnt lgkmcnt(7)
    ds_read_b64_tr_b16 v[68:69], v233 offset:18560
    ds_read_b64_tr_b16 v[70:71], v233 offset:20864
    v_mfma_f32_16x16x32_bf16 v[148:151], v[76:79], a[56:59], v[148:151]
    s_add_u32 m0, s88, 55296
    v_mfma_f32_16x16x32_bf16 v[152:155], v[76:79], a[200:203], v[152:155]
    s_waitcnt lgkmcnt(6)
    ds_read_b64_tr_b16 v[72:73], v233 offset:18592
    ds_read_b64_tr_b16 v[74:75], v233 offset:20896
    v_mfma_f32_16x16x32_bf16 v[156:159], v[80:83], a[56:59], v[156:159]
    buffer_load_dwordx4 v228, s[24:27], s54 offen offset:0 lds
    v_mfma_f32_16x16x32_bf16 v[160:163], v[80:83], a[200:203], v[160:163]
    s_waitcnt lgkmcnt(6)
    ds_read_b64_tr_b16 v[76:77], v233 offset:18624
    ds_read_b64_tr_b16 v[78:79], v233 offset:20928
    v_mfma_f32_16x16x32_bf16 v[164:167], v[60:63], a[56:59], v[164:167]
    buffer_load_dwordx4 v229, s[24:27], s54 offen offset:1024 lds
    v_mfma_f32_16x16x32_bf16 v[168:171], v[60:63], a[200:203], v[168:171]
    s_waitcnt lgkmcnt(6)
    ds_read_b64_tr_b16 v[80:81], v233 offset:18656
    ds_read_b64_tr_b16 v[82:83], v233 offset:20960
    v_mfma_f32_16x16x32_bf16 v[172:175], v[64:67], a[56:59], v[172:175]
    buffer_load_dwordx4 v230, s[24:27], s54 offen offset:2048 lds
    v_mfma_f32_16x16x32_bf16 v[176:179], v[64:67], a[200:203], v[176:179]
    s_waitcnt lgkmcnt(6)
    ds_read_b64_tr_b16 v[60:61], v233 offset:27648
    ds_read_b64_tr_b16 v[62:63], v233 offset:29952
    v_mfma_f32_16x16x32_bf16 v[180:183], v[68:71], a[56:59], v[180:183]
    buffer_load_dwordx4 v231, s[24:27], s54 offen offset:3072 lds
    v_mfma_f32_16x16x32_bf16 v[184:187], v[68:71], a[200:203], v[184:187]
    s_waitcnt lgkmcnt(6)
    ds_read_b64_tr_b16 v[64:65], v233 offset:27680
    ds_read_b64_tr_b16 v[66:67], v233 offset:29984
    v_mfma_f32_16x16x32_bf16 v[188:191], v[72:75], a[56:59], v[188:191]
    v_mfma_f32_16x16x32_bf16 v[192:195], v[72:75], a[200:203], v[192:195]
    s_waitcnt lgkmcnt(6)
    ds_read_b64_tr_b16 v[68:69], v233 offset:27712
    ds_read_b64_tr_b16 v[70:71], v233 offset:30016
    v_mfma_f32_16x16x32_bf16 v[196:199], v[76:79], a[56:59], v[196:199]
    s_add_u32 m0, s88, 59392
    v_mfma_f32_16x16x32_bf16 v[200:203], v[76:79], a[200:203], v[200:203]
    s_waitcnt lgkmcnt(6)
    ds_read_b64_tr_b16 v[72:73], v233 offset:27744
    ds_read_b64_tr_b16 v[74:75], v233 offset:30048
    v_mfma_f32_16x16x32_bf16 v[204:207], v[80:83], a[56:59], v[204:207]
    buffer_load_dwordx4 v232, s[24:27], s54 offen offset:0 lds
    v_mfma_f32_16x16x32_bf16 v[208:211], v[80:83], a[200:203], v[208:211]
    s_waitcnt lgkmcnt(6)
    ds_read_b64_tr_b16 v[76:77], v233 offset:27776
    ds_read_b64_tr_b16 v[78:79], v233 offset:30080
    v_mfma_f32_16x16x32_bf16 v[148:151], v[60:63], a[60:63], v[148:151]
    s_add_u32 s54, s51, 147456
    v_mfma_f32_16x16x32_bf16 v[152:155], v[60:63], a[204:207], v[152:155]
    s_waitcnt lgkmcnt(6)
    ds_read_b64_tr_b16 v[80:81], v233 offset:27808
    ds_read_b64_tr_b16 v[82:83], v233 offset:30112
    v_mfma_f32_16x16x32_bf16 v[156:159], v[64:67], a[60:63], v[156:159]
    s_add_u32 m0, s88, 73728
    v_mfma_f32_16x16x32_bf16 v[160:163], v[64:67], a[204:207], v[160:163]
    s_waitcnt lgkmcnt(6)
    ds_read_b64_tr_b16 v[60:61], v233 offset:27840
    ds_read_b64_tr_b16 v[62:63], v233 offset:30144
    v_mfma_f32_16x16x32_bf16 v[164:167], v[68:71], a[60:63], v[164:167]
    buffer_load_dwordx4 v228, s[24:27], s54 offen offset:0 lds
    v_mfma_f32_16x16x32_bf16 v[168:171], v[68:71], a[204:207], v[168:171]
    s_waitcnt lgkmcnt(6)
    ds_read_b64_tr_b16 v[64:65], v233 offset:27872
    ds_read_b64_tr_b16 v[66:67], v233 offset:30176
    v_mfma_f32_16x16x32_bf16 v[172:175], v[72:75], a[60:63], v[172:175]
    buffer_load_dwordx4 v229, s[24:27], s54 offen offset:1024 lds
    v_mfma_f32_16x16x32_bf16 v[176:179], v[72:75], a[204:207], v[176:179]
    s_waitcnt lgkmcnt(6)
    s_waitcnt vmcnt(8)
    s_barrier
    ds_read_b64_tr_b16 v[68:69], v233 offset:36864
    ds_read_b64_tr_b16 v[70:71], v233 offset:39168
    v_mfma_f32_16x16x32_bf16 v[180:183], v[76:79], a[60:63], v[180:183]
    s_or_b32 s21, s60, 3
    ds_read_b128 a[80:83], v34 offset:47872
    v_mov_b32 v243, s21
    v_mfma_f32_16x16x32_bf16 v[184:187], v[76:79], a[204:207], v[184:187]
    s_waitcnt lgkmcnt(7)
    ds_read_b64_tr_b16 v[72:73], v233 offset:36896
    ds_read_b64_tr_b16 v[74:75], v233 offset:39200
    v_mfma_f32_16x16x32_bf16 v[188:191], v[80:83], a[60:63], v[188:191]
    ds_read_b128 a[224:227], v34 offset:48896
    buffer_store_dword v243, v241, s[16:19], 0 offen sc1
    v_mfma_f32_16x16x32_bf16 v[192:195], v[80:83], a[204:207], v[192:195]
    s_waitcnt lgkmcnt(8)
    ds_read_b64_tr_b16 v[76:77], v233 offset:36928
    ds_read_b64_tr_b16 v[78:79], v233 offset:39232
    v_mfma_f32_16x16x32_bf16 v[196:199], v[60:63], a[60:63], v[196:199]
    s_add_u32 s55, s80, 32768
    ds_read_b128 a[84:87], v34 offset:56064
    buffer_load_dwordx4 a[88:91], v239, s[16:19], s55 offen offset:0 sc1
    v_mfma_f32_16x16x32_bf16 v[200:203], v[60:63], a[204:207], v[200:203]
    s_waitcnt lgkmcnt(9)
    ds_read_b64_tr_b16 v[80:81], v233 offset:36960
    ds_read_b64_tr_b16 v[82:83], v233 offset:39264
    v_mfma_f32_16x16x32_bf16 v[204:207], v[64:67], a[60:63], v[204:207]
    ds_read_b128 a[228:231], v34 offset:57088
    buffer_load_dwordx4 a[232:235], v239, s[16:19], s55 offen offset:1024 sc1
    v_mfma_f32_16x16x32_bf16 v[208:211], v[64:67], a[204:207], v[208:211]
    s_waitcnt lgkmcnt(10)
    ds_read_b64_tr_b16 v[60:61], v233 offset:36992
    ds_read_b64_tr_b16 v[62:63], v233 offset:39296
    v_mfma_f32_16x16x32_bf16 v[148:151], v[68:71], a[64:67], v[148:151]
    buffer_load_dwordx4 v230, s[24:27], s54 offen offset:2048 lds
    v_mfma_f32_16x16x32_bf16 v[152:155], v[68:71], a[208:211], v[152:155]
    s_waitcnt lgkmcnt(9)
    ds_read_b64_tr_b16 v[64:65], v233 offset:37024
    ds_read_b64_tr_b16 v[66:67], v233 offset:39328
    v_mfma_f32_16x16x32_bf16 v[156:159], v[72:75], a[64:67], v[156:159]
    v_mfma_f32_16x16x32_bf16 v[160:163], v[72:75], a[208:211], v[160:163]
    s_waitcnt lgkmcnt(8)
    ds_read_b64_tr_b16 v[68:69], v233 offset:37056
    ds_read_b64_tr_b16 v[70:71], v233 offset:39360
    v_mfma_f32_16x16x32_bf16 v[164:167], v[76:79], a[64:67], v[164:167]
    buffer_load_dwordx4 a[92:95], v240, s[16:19], s55 offen offset:0 sc1
    v_mfma_f32_16x16x32_bf16 v[168:171], v[76:79], a[208:211], v[168:171]
    s_waitcnt lgkmcnt(7)
    ds_read_b64_tr_b16 v[72:73], v233 offset:37088
    ds_read_b64_tr_b16 v[74:75], v233 offset:39392
    v_mfma_f32_16x16x32_bf16 v[172:175], v[80:83], a[64:67], v[172:175]
    v_mfma_f32_16x16x32_bf16 v[176:179], v[80:83], a[208:211], v[176:179]
    s_waitcnt lgkmcnt(6)
    ds_read_b64_tr_b16 v[76:77], v233 offset:46080
    ds_read_b64_tr_b16 v[78:79], v233 offset:48384
    v_mfma_f32_16x16x32_bf16 v[180:183], v[60:63], a[64:67], v[180:183]
    buffer_load_dwordx4 v231, s[24:27], s54 offen offset:3072 lds
    v_mfma_f32_16x16x32_bf16 v[184:187], v[60:63], a[208:211], v[184:187]
    s_waitcnt lgkmcnt(6)
    ds_read_b64_tr_b16 v[80:81], v233 offset:46112
    ds_read_b64_tr_b16 v[82:83], v233 offset:48416
    v_mfma_f32_16x16x32_bf16 v[188:191], v[64:67], a[64:67], v[188:191]
    v_mfma_f32_16x16x32_bf16 v[192:195], v[64:67], a[208:211], v[192:195]
    s_waitcnt lgkmcnt(6)
    ds_read_b64_tr_b16 v[60:61], v233 offset:46144
    ds_read_b64_tr_b16 v[62:63], v233 offset:48448
    v_mfma_f32_16x16x32_bf16 v[196:199], v[68:71], a[64:67], v[196:199]
    buffer_load_dwordx4 a[236:239], v240, s[16:19], s55 offen offset:1024 sc1
    v_mfma_f32_16x16x32_bf16 v[200:203], v[68:71], a[208:211], v[200:203]
    s_waitcnt lgkmcnt(6)
    ds_read_b64_tr_b16 v[64:65], v233 offset:46176
    ds_read_b64_tr_b16 v[66:67], v233 offset:48480
    v_mfma_f32_16x16x32_bf16 v[204:207], v[72:75], a[64:67], v[204:207]
    s_add_u32 m0, s88, 77824
    v_mfma_f32_16x16x32_bf16 v[208:211], v[72:75], a[208:211], v[208:211]
    s_waitcnt lgkmcnt(6)
    ds_read_b64_tr_b16 v[68:69], v233 offset:46208
    ds_read_b64_tr_b16 v[70:71], v233 offset:48512
    v_mfma_f32_16x16x32_bf16 v[148:151], v[76:79], a[68:71], v[148:151]
    buffer_load_dwordx4 v232, s[24:27], s54 offen offset:0 lds
    v_mfma_f32_16x16x32_bf16 v[152:155], v[76:79], a[212:215], v[152:155]
    s_waitcnt lgkmcnt(6)
    ds_read_b64_tr_b16 v[72:73], v233 offset:46240
    ds_read_b64_tr_b16 v[74:75], v233 offset:48544
    v_mfma_f32_16x16x32_bf16 v[156:159], v[80:83], a[68:71], v[156:159]
    s_add_u32 s54, s52, 147456
    v_mfma_f32_16x16x32_bf16 v[160:163], v[80:83], a[212:215], v[160:163]
    s_waitcnt lgkmcnt(6)
    ds_read_b64_tr_b16 v[76:77], v233 offset:46272
    ds_read_b64_tr_b16 v[78:79], v233 offset:48576
    v_mfma_f32_16x16x32_bf16 v[164:167], v[60:63], a[68:71], v[164:167]
    s_add_u32 m0, s88, 92160
    v_mfma_f32_16x16x32_bf16 v[168:171], v[60:63], a[212:215], v[168:171]
    s_waitcnt lgkmcnt(6)
    ds_read_b64_tr_b16 v[80:81], v233 offset:46304
    ds_read_b64_tr_b16 v[82:83], v233 offset:48608
    v_mfma_f32_16x16x32_bf16 v[172:175], v[64:67], a[68:71], v[172:175]
    buffer_load_dwordx4 v228, s[24:27], s54 offen offset:0 lds
    v_mfma_f32_16x16x32_bf16 v[176:179], v[64:67], a[212:215], v[176:179]
    s_waitcnt lgkmcnt(6)
    s_waitcnt vmcnt(16)
    s_barrier
    ds_read_b64_tr_b16 v[60:61], v235 offset:13056
    ds_read_b64_tr_b16 v[62:63], v235 offset:15360
    v_mfma_f32_16x16x32_bf16 v[180:183], v[68:71], a[68:71], v[180:183]
    s_add_u32 s55, s81, 32768
    buffer_load_dwordx4 a[96:99], v239, s[16:19], s55 offen offset:0 sc1
    v_mfma_f32_16x16x32_bf16 v[184:187], v[68:71], a[212:215], v[184:187]
    s_waitcnt lgkmcnt(6)
    ds_read_b64_tr_b16 v[64:65], v235 offset:13088
    ds_read_b64_tr_b16 v[66:67], v235 offset:15392
    v_mfma_f32_16x16x32_bf16 v[188:191], v[72:75], a[68:71], v[188:191]
    buffer_load_dwordx4 v229, s[24:27], s54 offen offset:1024 lds
    v_mfma_f32_16x16x32_bf16 v[192:195], v[72:75], a[212:215], v[192:195]
    s_waitcnt lgkmcnt(6)
    ds_read_b64_tr_b16 v[68:69], v235 offset:13120
    ds_read_b64_tr_b16 v[70:71], v235 offset:15424
    v_mfma_f32_16x16x32_bf16 v[196:199], v[76:79], a[68:71], v[196:199]
    buffer_load_dwordx4 a[240:243], v239, s[16:19], s55 offen offset:1024 sc1
    v_mfma_f32_16x16x32_bf16 v[200:203], v[76:79], a[212:215], v[200:203]
    s_waitcnt lgkmcnt(6)
    ds_read_b64_tr_b16 v[72:73], v235 offset:13152
    ds_read_b64_tr_b16 v[74:75], v235 offset:15456
    v_mfma_f32_16x16x32_bf16 v[204:207], v[80:83], a[68:71], v[204:207]
    v_mfma_f32_16x16x32_bf16 v[208:211], v[80:83], a[212:215], v[208:211]
    s_waitcnt lgkmcnt(6)
    ds_read_b64_tr_b16 v[76:77], v235 offset:13184
    ds_read_b64_tr_b16 v[78:79], v235 offset:15488
    v_mfma_f32_16x16x32_bf16 v[148:151], v[60:63], a[72:75], v[148:151]
    buffer_load_dwordx4 v230, s[24:27], s54 offen offset:2048 lds
    v_mfma_f32_16x16x32_bf16 v[152:155], v[60:63], a[216:219], v[152:155]
    s_waitcnt lgkmcnt(6)
    ds_read_b64_tr_b16 v[80:81], v235 offset:13216
    ds_read_b64_tr_b16 v[82:83], v235 offset:15520
    v_mfma_f32_16x16x32_bf16 v[156:159], v[64:67], a[72:75], v[156:159]
    v_mfma_f32_16x16x32_bf16 v[160:163], v[64:67], a[216:219], v[160:163]
    s_waitcnt lgkmcnt(6)
    ds_read_b64_tr_b16 v[60:61], v235 offset:13248
    ds_read_b64_tr_b16 v[62:63], v235 offset:15552
    v_mfma_f32_16x16x32_bf16 v[164:167], v[68:71], a[72:75], v[164:167]
    buffer_load_dwordx4 a[100:103], v240, s[16:19], s55 offen offset:0 sc1
    v_mfma_f32_16x16x32_bf16 v[168:171], v[68:71], a[216:219], v[168:171]
    s_waitcnt lgkmcnt(6)
    ds_read_b64_tr_b16 v[64:65], v235 offset:13280
    ds_read_b64_tr_b16 v[66:67], v235 offset:15584
    v_mfma_f32_16x16x32_bf16 v[172:175], v[72:75], a[72:75], v[172:175]
    v_mfma_f32_16x16x32_bf16 v[176:179], v[72:75], a[216:219], v[176:179]
    s_waitcnt lgkmcnt(6)
    ds_read_b64_tr_b16 v[68:69], v235 offset:22272
    ds_read_b64_tr_b16 v[70:71], v235 offset:24576
    v_mfma_f32_16x16x32_bf16 v[180:183], v[76:79], a[72:75], v[180:183]
    buffer_load_dwordx4 v231, s[24:27], s54 offen offset:3072 lds
    v_mfma_f32_16x16x32_bf16 v[184:187], v[76:79], a[216:219], v[184:187]
    s_waitcnt lgkmcnt(6)
    ds_read_b64_tr_b16 v[72:73], v235 offset:22304
    ds_read_b64_tr_b16 v[74:75], v235 offset:24608
    v_mfma_f32_16x16x32_bf16 v[188:191], v[80:83], a[72:75], v[188:191]
    buffer_load_dwordx4 a[244:247], v240, s[16:19], s55 offen offset:1024 sc1
    v_mfma_f32_16x16x32_bf16 v[192:195], v[80:83], a[216:219], v[192:195]
    s_waitcnt lgkmcnt(6)
    ds_read_b64_tr_b16 v[76:77], v235 offset:22336
    ds_read_b64_tr_b16 v[78:79], v235 offset:24640
    v_mfma_f32_16x16x32_bf16 v[196:199], v[60:63], a[72:75], v[196:199]
    v_mfma_f32_16x16x32_bf16 v[200:203], v[60:63], a[216:219], v[200:203]
    s_waitcnt lgkmcnt(6)
    ds_read_b64_tr_b16 v[80:81], v235 offset:22368
    ds_read_b64_tr_b16 v[82:83], v235 offset:24672
    v_mfma_f32_16x16x32_bf16 v[204:207], v[64:67], a[72:75], v[204:207]
    s_add_u32 s55, s82, 32768
    buffer_load_dwordx4 a[104:107], v239, s[16:19], s55 offen offset:0 sc1
    v_mfma_f32_16x16x32_bf16 v[208:211], v[64:67], a[216:219], v[208:211]
    s_waitcnt lgkmcnt(6)
    ds_read_b64_tr_b16 v[60:61], v235 offset:22400
    ds_read_b64_tr_b16 v[62:63], v235 offset:24704
    v_mfma_f32_16x16x32_bf16 v[148:151], v[68:71], a[76:79], v[148:151]
    v_mfma_f32_16x16x32_bf16 v[152:155], v[68:71], a[220:223], v[152:155]
    s_waitcnt lgkmcnt(6)
    ds_read_b64_tr_b16 v[64:65], v235 offset:22432
    ds_read_b64_tr_b16 v[66:67], v235 offset:24736
    v_mfma_f32_16x16x32_bf16 v[156:159], v[72:75], a[76:79], v[156:159]
    s_add_u32 m0, s88, 96256
    v_mfma_f32_16x16x32_bf16 v[160:163], v[72:75], a[220:223], v[160:163]
    s_waitcnt lgkmcnt(6)
    ds_read_b64_tr_b16 v[68:69], v235 offset:22464
    ds_read_b64_tr_b16 v[70:71], v235 offset:24768
    v_mfma_f32_16x16x32_bf16 v[164:167], v[76:79], a[76:79], v[164:167]
    buffer_load_dwordx4 v232, s[24:27], s54 offen offset:0 lds
    v_mfma_f32_16x16x32_bf16 v[168:171], v[76:79], a[220:223], v[168:171]
    s_waitcnt lgkmcnt(6)
    ds_read_b64_tr_b16 v[72:73], v235 offset:22496
    ds_read_b64_tr_b16 v[74:75], v235 offset:24800
    v_mfma_f32_16x16x32_bf16 v[172:175], v[80:83], a[76:79], v[172:175]
    s_add_u32 s54, s53, 147456
    v_mfma_f32_16x16x32_bf16 v[176:179], v[80:83], a[220:223], v[176:179]
    s_waitcnt lgkmcnt(6)
    s_waitcnt vmcnt(20)
    s_barrier
    ds_read_b64_tr_b16 v[76:77], v233 offset:55296
    ds_read_b64_tr_b16 v[78:79], v233 offset:57600
    v_mfma_f32_16x16x32_bf16 v[180:183], v[60:63], a[76:79], v[180:183]
    buffer_load_dword v29, v242, s[16:19], 0 offen sc1
    v_mfma_f32_16x16x32_bf16 v[184:187], v[60:63], a[220:223], v[184:187]
    s_waitcnt lgkmcnt(6)
    ds_read_b64_tr_b16 v[80:81], v233 offset:55328
    ds_read_b64_tr_b16 v[82:83], v233 offset:57632
    v_mfma_f32_16x16x32_bf16 v[188:191], v[64:67], a[76:79], v[188:191]
    s_add_u32 m0, s88, 0
    v_mfma_f32_16x16x32_bf16 v[192:195], v[64:67], a[220:223], v[192:195]
    s_waitcnt lgkmcnt(6)
    ds_read_b64_tr_b16 v[60:61], v233 offset:55360
    ds_read_b64_tr_b16 v[62:63], v233 offset:57664
    v_mfma_f32_16x16x32_bf16 v[196:199], v[68:71], a[76:79], v[196:199]
    buffer_load_dwordx4 v228, s[24:27], s54 offen offset:0 lds
    v_mfma_f32_16x16x32_bf16 v[200:203], v[68:71], a[220:223], v[200:203]
    s_waitcnt lgkmcnt(6)
    ds_read_b64_tr_b16 v[64:65], v233 offset:55392
    ds_read_b64_tr_b16 v[66:67], v233 offset:57696
    v_mfma_f32_16x16x32_bf16 v[204:207], v[72:75], a[76:79], v[204:207]
    buffer_load_dwordx4 v229, s[24:27], s54 offen offset:1024 lds
    v_mfma_f32_16x16x32_bf16 v[208:211], v[72:75], a[220:223], v[208:211]
    s_waitcnt lgkmcnt(6)
    ds_read_b64_tr_b16 v[68:69], v233 offset:55424
    ds_read_b64_tr_b16 v[70:71], v233 offset:57728
    v_mfma_f32_16x16x32_bf16 v[148:151], v[76:79], a[80:83], v[148:151]
    buffer_load_dwordx4 a[248:251], v239, s[16:19], s55 offen offset:1024 sc1
    v_mfma_f32_16x16x32_bf16 v[152:155], v[76:79], a[224:227], v[152:155]
    s_waitcnt lgkmcnt(6)
    ds_read_b64_tr_b16 v[72:73], v233 offset:55456
    ds_read_b64_tr_b16 v[74:75], v233 offset:57760
    v_mfma_f32_16x16x32_bf16 v[156:159], v[80:83], a[80:83], v[156:159]
    v_mfma_f32_16x16x32_bf16 v[160:163], v[80:83], a[224:227], v[160:163]
    s_waitcnt lgkmcnt(6)
    ds_read_b64_tr_b16 v[76:77], v233 offset:55488
    ds_read_b64_tr_b16 v[78:79], v233 offset:57792
    v_mfma_f32_16x16x32_bf16 v[164:167], v[60:63], a[80:83], v[164:167]
    buffer_load_dwordx4 v230, s[24:27], s54 offen offset:2048 lds
    v_mfma_f32_16x16x32_bf16 v[168:171], v[60:63], a[224:227], v[168:171]
    s_waitcnt lgkmcnt(6)
    ds_read_b64_tr_b16 v[80:81], v233 offset:55520
    ds_read_b64_tr_b16 v[82:83], v233 offset:57824
    v_mfma_f32_16x16x32_bf16 v[172:175], v[64:67], a[80:83], v[172:175]
    buffer_load_dwordx4 a[108:111], v240, s[16:19], s55 offen offset:0 sc1
    v_mfma_f32_16x16x32_bf16 v[176:179], v[64:67], a[224:227], v[176:179]
    s_waitcnt lgkmcnt(6)
    ds_read_b64_tr_b16 v[60:61], v233 offset:64512
    ds_read_b64_tr_b16 v[62:63], v234 offset:1280
    v_mfma_f32_16x16x32_bf16 v[180:183], v[68:71], a[80:83], v[180:183]
    v_mfma_f32_16x16x32_bf16 v[184:187], v[68:71], a[224:227], v[184:187]
    s_waitcnt lgkmcnt(6)
    ds_read_b64_tr_b16 v[64:65], v233 offset:64544
    ds_read_b64_tr_b16 v[66:67], v234 offset:1312
    v_mfma_f32_16x16x32_bf16 v[188:191], v[72:75], a[80:83], v[188:191]
    buffer_load_dwordx4 v231, s[24:27], s54 offen offset:3072 lds
    v_mfma_f32_16x16x32_bf16 v[192:195], v[72:75], a[224:227], v[192:195]
    s_waitcnt lgkmcnt(6)
    ds_read_b64_tr_b16 v[68:69], v233 offset:64576
    ds_read_b64_tr_b16 v[70:71], v234 offset:1344
    v_mfma_f32_16x16x32_bf16 v[196:199], v[76:79], a[80:83], v[196:199]
    v_mfma_f32_16x16x32_bf16 v[200:203], v[76:79], a[224:227], v[200:203]
    s_waitcnt lgkmcnt(6)
    ds_read_b64_tr_b16 v[72:73], v233 offset:64608
    ds_read_b64_tr_b16 v[74:75], v234 offset:1376
    v_mfma_f32_16x16x32_bf16 v[204:207], v[80:83], a[80:83], v[204:207]
    buffer_load_dwordx4 a[252:255], v240, s[16:19], s55 offen offset:1024 sc1
    v_mfma_f32_16x16x32_bf16 v[208:211], v[80:83], a[224:227], v[208:211]
    s_waitcnt lgkmcnt(6)
    ds_read_b64_tr_b16 v[76:77], v233 offset:64640
    ds_read_b64_tr_b16 v[78:79], v234 offset:1408
    v_mfma_f32_16x16x32_bf16 v[148:151], v[60:63], a[84:87], v[148:151]
    v_mfma_f32_16x16x32_bf16 v[152:155], v[60:63], a[228:231], v[152:155]
    s_waitcnt lgkmcnt(6)
    ds_read_b64_tr_b16 v[80:81], v233 offset:64672
    ds_read_b64_tr_b16 v[82:83], v234 offset:1440
    v_mfma_f32_16x16x32_bf16 v[156:159], v[64:67], a[84:87], v[156:159]
    s_add_u32 s55, s80, 49152
    buffer_load_dwordx4 a[112:115], v239, s[16:19], s55 offen offset:0 sc1
    v_mfma_f32_16x16x32_bf16 v[160:163], v[64:67], a[228:231], v[160:163]
    s_waitcnt lgkmcnt(6)
    ds_read_b64_tr_b16 v[60:61], v233 offset:64704
    ds_read_b64_tr_b16 v[62:63], v234 offset:1472
    v_mfma_f32_16x16x32_bf16 v[164:167], v[68:71], a[84:87], v[164:167]
    s_add_u32 m0, s88, 4096
    v_mfma_f32_16x16x32_bf16 v[168:171], v[68:71], a[228:231], v[168:171]
    s_waitcnt lgkmcnt(6)
    ds_read_b64_tr_b16 v[64:65], v233 offset:64736
    ds_read_b64_tr_b16 v[66:67], v234 offset:1504
    v_mfma_f32_16x16x32_bf16 v[172:175], v[72:75], a[84:87], v[172:175]
    buffer_load_dwordx4 v232, s[24:27], s54 offen offset:0 lds
    v_mfma_f32_16x16x32_bf16 v[176:179], v[72:75], a[228:231], v[176:179]
    s_waitcnt lgkmcnt(6)
    s_waitcnt vmcnt(20)
    s_barrier
    s_waitcnt vmcnt(9)
    s_add_u32 s3, s60, 3
    v_subrev_u32 v23, s3, v29
    v_cmp_ge_u32 vcc, 4, v23
    s_and_b64 vcc, vcc, s[90:91]
    s_cmp_eq_u64 vcc, s[90:91]
    s_cbranch_scc0 L_spine3
L_backe3:
    ds_read_b64_tr_b16 v[68:69], v234 offset:8192
    ds_read_b64_tr_b16 v[70:71], v234 offset:10496
    v_mfma_f32_16x16x32_bf16 v[180:183], v[76:79], a[84:87], v[180:183]
    s_add_u32 s54, s51, 221184
    v_mfma_f32_16x16x32_bf16 v[184:187], v[76:79], a[228:231], v[184:187]
    s_waitcnt lgkmcnt(6)
    ds_read_b64_tr_b16 v[72:73], v234 offset:8224
    ds_read_b64_tr_b16 v[74:75], v234 offset:10528
    v_mfma_f32_16x16x32_bf16 v[188:191], v[80:83], a[84:87], v[188:191]
    s_add_u32 m0, s88, 18432
    v_mfma_f32_16x16x32_bf16 v[192:195], v[80:83], a[228:231], v[192:195]
    s_waitcnt lgkmcnt(6)
    ds_read_b64_tr_b16 v[76:77], v234 offset:8256
    ds_read_b64_tr_b16 v[78:79], v234 offset:10560
    v_mfma_f32_16x16x32_bf16 v[196:199], v[60:63], a[84:87], v[196:199]
    buffer_load_dwordx4 v228, s[24:27], s54 offen offset:0 lds
    v_mfma_f32_16x16x32_bf16 v[200:203], v[60:63], a[228:231], v[200:203]
    s_waitcnt lgkmcnt(6)
    ds_read_b64_tr_b16 v[80:81], v234 offset:8288
    ds_read_b64_tr_b16 v[82:83], v234 offset:10592
    v_mfma_f32_16x16x32_bf16 v[204:207], v[64:67], a[84:87], v[204:207]
    buffer_load_dwordx4 v229, s[24:27], s54 offen offset:1024 lds
    v_mfma_f32_16x16x32_bf16 v[208:211], v[64:67], a[228:231], v[208:211]
    s_waitcnt lgkmcnt(6)
    ds_read_b64_tr_b16 v[60:61], v234 offset:8320
    ds_read_b64_tr_b16 v[62:63], v234 offset:10624
    v_mfma_f32_16x16x32_bf16 v[148:151], v[68:71], a[88:91], v[148:151]
    buffer_load_dwordx4 a[116:119], v239, s[16:19], s55 offen offset:1024 sc1
    v_mfma_f32_16x16x32_bf16 v[152:155], v[68:71], a[232:235], v[152:155]
    s_waitcnt lgkmcnt(6)
    ds_read_b64_tr_b16 v[64:65], v234 offset:8352
    ds_read_b64_tr_b16 v[66:67], v234 offset:10656
    v_mfma_f32_16x16x32_bf16 v[156:159], v[72:75], a[88:91], v[156:159]
    buffer_load_dwordx4 v230, s[24:27], s54 offen offset:2048 lds
    v_mfma_f32_16x16x32_bf16 v[160:163], v[72:75], a[232:235], v[160:163]
    s_waitcnt lgkmcnt(6)
    ds_read_b64_tr_b16 v[68:69], v234 offset:8384
    ds_read_b64_tr_b16 v[70:71], v234 offset:10688
    v_mfma_f32_16x16x32_bf16 v[164:167], v[76:79], a[88:91], v[164:167]
    v_mfma_f32_16x16x32_bf16 v[168:171], v[76:79], a[232:235], v[168:171]
    s_waitcnt lgkmcnt(6)
    ds_read_b64_tr_b16 v[72:73], v234 offset:8416
    ds_read_b64_tr_b16 v[74:75], v234 offset:10720
    v_mfma_f32_16x16x32_bf16 v[172:175], v[80:83], a[88:91], v[172:175]
    buffer_load_dwordx4 a[120:123], v240, s[16:19], s55 offen offset:0 sc1
    v_mfma_f32_16x16x32_bf16 v[176:179], v[80:83], a[232:235], v[176:179]
    s_waitcnt lgkmcnt(6)
    ds_read_b64_tr_b16 v[76:77], v234 offset:17408
    ds_read_b64_tr_b16 v[78:79], v234 offset:19712
    v_mfma_f32_16x16x32_bf16 v[180:183], v[60:63], a[88:91], v[180:183]
    v_mfma_f32_16x16x32_bf16 v[184:187], v[60:63], a[232:235], v[184:187]
    s_waitcnt lgkmcnt(6)
    ds_read_b64_tr_b16 v[80:81], v234 offset:17440
    ds_read_b64_tr_b16 v[82:83], v234 offset:19744
    v_mfma_f32_16x16x32_bf16 v[188:191], v[64:67], a[88:91], v[188:191]
    buffer_load_dwordx4 v231, s[24:27], s54 offen offset:3072 lds
    v_mfma_f32_16x16x32_bf16 v[192:195], v[64:67], a[232:235], v[192:195]
    s_waitcnt lgkmcnt(6)
    ds_read_b64_tr_b16 v[60:61], v234 offset:17472
    ds_read_b64_tr_b16 v[62:63], v234 offset:19776
    v_mfma_f32_16x16x32_bf16 v[196:199], v[68:71], a[88:91], v[196:199]
    v_mfma_f32_16x16x32_bf16 v[200:203], v[68:71], a[232:235], v[200:203]
    s_waitcnt lgkmcnt(6)
    ds_read_b64_tr_b16 v[64:65], v234 offset:17504
    ds_read_b64_tr_b16 v[66:67], v234 offset:19808
    v_mfma_f32_16x16x32_bf16 v[204:207], v[72:75], a[88:91], v[204:207]
    buffer_load_dwordx4 a[124:127], v240, s[16:19], s55 offen offset:1024 sc1
    v_mfma_f32_16x16x32_bf16 v[208:211], v[72:75], a[232:235], v[208:211]
    s_waitcnt lgkmcnt(6)
    ds_read_b64_tr_b16 v[68:69], v234 offset:17536
    ds_read_b64_tr_b16 v[70:71], v234 offset:19840
    v_mfma_f32_16x16x32_bf16 v[148:151], v[76:79], a[92:95], v[148:151]
    s_add_u32 s55, s81, 49152
    buffer_load_dwordx4 a[128:131], v239, s[16:19], s55 offen offset:0 sc1
    v_mfma_f32_16x16x32_bf16 v[152:155], v[76:79], a[236:239], v[152:155]
    s_waitcnt lgkmcnt(6)
    ds_read_b64_tr_b16 v[72:73], v234 offset:17568
    ds_read_b64_tr_b16 v[74:75], v234 offset:19872
    v_mfma_f32_16x16x32_bf16 v[156:159], v[80:83], a[92:95], v[156:159]
    s_add_u32 m0, s88, 22528
    v_mfma_f32_16x16x32_bf16 v[160:163], v[80:83], a[236:239], v[160:163]
    s_waitcnt lgkmcnt(6)
    ds_read_b64_tr_b16 v[76:77], v234 offset:17600
    ds_read_b64_tr_b16 v[78:79], v234 offset:19904
    v_mfma_f32_16x16x32_bf16 v[164:167], v[60:63], a[92:95], v[164:167]
    buffer_load_dwordx4 v232, s[24:27], s54 offen offset:0 lds
    v_mfma_f32_16x16x32_bf16 v[168:171], v[60:63], a[236:239], v[168:171]
    s_waitcnt lgkmcnt(6)
    ds_read_b64_tr_b16 v[80:81], v234 offset:17632
    ds_read_b64_tr_b16 v[82:83], v234 offset:19936
    v_mfma_f32_16x16x32_bf16 v[172:175], v[64:67], a[92:95], v[172:175]
    s_add_u32 s54, s52, 221184
    v_mfma_f32_16x16x32_bf16 v[176:179], v[64:67], a[236:239], v[176:179]
    s_waitcnt lgkmcnt(6)
    s_barrier
    ds_read_b64_tr_b16 v[60:61], v234 offset:26624
    ds_read_b64_tr_b16 v[62:63], v234 offset:28928
    v_mfma_f32_16x16x32_bf16 v[180:183], v[68:71], a[92:95], v[180:183]
    s_add_u32 m0, s88, 36864
    v_mfma_f32_16x16x32_bf16 v[184:187], v[68:71], a[236:239], v[184:187]
    s_waitcnt lgkmcnt(6)
    ds_read_b64_tr_b16 v[64:65], v234 offset:26656
    ds_read_b64_tr_b16 v[66:67], v234 offset:28960
    v_mfma_f32_16x16x32_bf16 v[188:191], v[72:75], a[92:95], v[188:191]
    buffer_load_dwordx4 v228, s[24:27], s54 offen offset:0 lds
    v_mfma_f32_16x16x32_bf16 v[192:195], v[72:75], a[236:239], v[192:195]
    s_waitcnt lgkmcnt(6)
    ds_read_b64_tr_b16 v[68:69], v234 offset:26688
    ds_read_b64_tr_b16 v[70:71], v234 offset:28992
    v_mfma_f32_16x16x32_bf16 v[196:199], v[76:79], a[92:95], v[196:199]
    buffer_load_dwordx4 v229, s[24:27], s54 offen offset:1024 lds
    v_mfma_f32_16x16x32_bf16 v[200:203], v[76:79], a[236:239], v[200:203]
    s_waitcnt lgkmcnt(6)
    ds_read_b64_tr_b16 v[72:73], v234 offset:26720
    ds_read_b64_tr_b16 v[74:75], v234 offset:29024
    v_mfma_f32_16x16x32_bf16 v[204:207], v[80:83], a[92:95], v[204:207]
    buffer_load_dwordx4 a[132:135], v239, s[16:19], s55 offen offset:1024 sc1
    v_mfma_f32_16x16x32_bf16 v[208:211], v[80:83], a[236:239], v[208:211]
    s_waitcnt lgkmcnt(6)
    ds_read_b64_tr_b16 v[76:77], v234 offset:26752
    ds_read_b64_tr_b16 v[78:79], v234 offset:29056
    v_mfma_f32_16x16x32_bf16 v[148:151], v[60:63], a[96:99], v[148:151]
    buffer_load_dwordx4 v230, s[24:27], s54 offen offset:2048 lds
    v_mfma_f32_16x16x32_bf16 v[152:155], v[60:63], a[240:243], v[152:155]
    s_waitcnt lgkmcnt(6)
    ds_read_b64_tr_b16 v[80:81], v234 offset:26784
    ds_read_b64_tr_b16 v[82:83], v234 offset:29088
    v_mfma_f32_16x16x32_bf16 v[156:159], v[64:67], a[96:99], v[156:159]
    buffer_load_dwordx4 a[136:139], v240, s[16:19], s55 offen offset:0 sc1
    v_mfma_f32_16x16x32_bf16 v[160:163], v[64:67], a[240:243], v[160:163]
    s_waitcnt lgkmcnt(6)
    ds_read_b64_tr_b16 v[60:61], v234 offset:35840
    ds_read_b64_tr_b16 v[62:63], v234 offset:38144
    v_mfma_f32_16x16x32_bf16 v[164:167], v[68:71], a[96:99], v[164:167]
    buffer_load_dwordx4 v231, s[24:27], s54 offen offset:3072 lds
    v_mfma_f32_16x16x32_bf16 v[168:171], v[68:71], a[240:243], v[168:171]
    s_waitcnt lgkmcnt(6)
    ds_read_b64_tr_b16 v[64:65], v234 offset:35872
    ds_read_b64_tr_b16 v[66:67], v234 offset:38176
    v_mfma_f32_16x16x32_bf16 v[172:175], v[72:75], a[96:99], v[172:175]
    v_mfma_f32_16x16x32_bf16 v[176:179], v[72:75], a[240:243], v[176:179]
    s_waitcnt lgkmcnt(6)
    ds_read_b64_tr_b16 v[68:69], v234 offset:35904
    ds_read_b64_tr_b16 v[70:71], v234 offset:38208
    v_mfma_f32_16x16x32_bf16 v[180:183], v[76:79], a[96:99], v[180:183]
    buffer_load_dwordx4 a[140:143], v240, s[16:19], s55 offen offset:1024 sc1
    v_mfma_f32_16x16x32_bf16 v[184:187], v[76:79], a[240:243], v[184:187]
    s_waitcnt lgkmcnt(6)
    ds_read_b64_tr_b16 v[72:73], v234 offset:35936
    ds_read_b64_tr_b16 v[74:75], v234 offset:38240
    v_mfma_f32_16x16x32_bf16 v[188:191], v[80:83], a[96:99], v[188:191]
    s_add_u32 s55, s82, 49152
    buffer_load_dwordx4 a[0:3], v239, s[16:19], s55 offen offset:0 sc1
    v_mfma_f32_16x16x32_bf16 v[192:195], v[80:83], a[240:243], v[192:195]
    s_waitcnt lgkmcnt(6)
    ds_read_b64_tr_b16 v[76:77], v234 offset:35968
    ds_read_b64_tr_b16 v[78:79], v234 offset:38272
    v_mfma_f32_16x16x32_bf16 v[148:151], v[60:63], a[100:103], v[148:151]
    s_add_u32 m0, s88, 40960
    v_mfma_f32_16x16x32_bf16 v[152:155], v[60:63], a[244:247], v[152:155]
    s_waitcnt lgkmcnt(6)
    ds_read_b64_tr_b16 v[80:81], v234 offset:36000
    ds_read_b64_tr_b16 v[82:83], v234 offset:38304
    v_mfma_f32_16x16x32_bf16 v[156:159], v[64:67], a[100:103], v[156:159]
    buffer_load_dwordx4 v232, s[24:27], s54 offen offset:0 lds
    v_mfma_f32_16x16x32_bf16 v[160:163], v[64:67], a[244:247], v[160:163]
    s_waitcnt lgkmcnt(6)
    s_waitcnt vmcnt(18)
    s_barrier
    ds_read_b64_tr_b16 v[60:61], v233 offset:0
    ds_read_b64_tr_b16 v[62:63], v233 offset:2304
    v_mfma_f32_16x16x32_bf16 v[164:167], v[68:71], a[100:103], v[164:167]
    s_add_u32 s54, s53, 221184
    v_mfma_f32_16x16x32_bf16 v[168:171], v[68:71], a[244:247], v[168:171]
    s_waitcnt lgkmcnt(6)
    ds_read_b64_tr_b16 v[64:65], v233 offset:32
    ds_read_b64_tr_b16 v[66:67], v233 offset:2336
    v_mfma_f32_16x16x32_bf16 v[172:175], v[72:75], a[100:103], v[172:175]
    s_add_u32 m0, s88, 110592
    v_mfma_f32_16x16x32_bf16 v[176:179], v[72:75], a[244:247], v[176:179]
    s_waitcnt lgkmcnt(6)
    ds_read_b64_tr_b16 v[68:69], v233 offset:64
    ds_read_b64_tr_b16 v[70:71], v233 offset:2368
    v_mfma_f32_16x16x32_bf16 v[180:183], v[76:79], a[100:103], v[180:183]
    buffer_load_dwordx4 v228, s[24:27], s54 offen offset:0 lds
    v_mfma_f32_16x16x32_bf16 v[184:187], v[76:79], a[244:247], v[184:187]
    s_waitcnt lgkmcnt(6)
    ds_read_b64_tr_b16 v[72:73], v233 offset:96
    ds_read_b64_tr_b16 v[74:75], v233 offset:2400
    v_mfma_f32_16x16x32_bf16 v[188:191], v[80:83], a[100:103], v[188:191]
    buffer_load_dwordx4 v229, s[24:27], s54 offen offset:1024 lds
    v_mfma_f32_16x16x32_bf16 v[192:195], v[80:83], a[244:247], v[192:195]
    s_waitcnt lgkmcnt(6)
    ds_read_b64_tr_b16 v[76:77], v233 offset:128
    ds_read_b64_tr_b16 v[78:79], v233 offset:2432
    v_mfma_f32_16x16x32_bf16 v[148:151], v[60:63], a[104:107], v[148:151]
    buffer_load_dwordx4 a[144:147], v239, s[16:19], s55 offen offset:1024 sc1
    v_mfma_f32_16x16x32_bf16 v[152:155], v[60:63], a[248:251], v[152:155]
    s_waitcnt lgkmcnt(6)
    ds_read_b64_tr_b16 v[80:81], v233 offset:160
    ds_read_b64_tr_b16 v[82:83], v233 offset:2464
    v_mfma_f32_16x16x32_bf16 v[156:159], v[64:67], a[104:107], v[156:159]
    buffer_load_dwordx4 v230, s[24:27], s54 offen offset:2048 lds
    v_mfma_f32_16x16x32_bf16 v[160:163], v[64:67], a[248:251], v[160:163]
    s_waitcnt lgkmcnt(6)
    ds_read_b64_tr_b16 v[60:61], v233 offset:9216
    ds_read_b64_tr_b16 v[62:63], v233 offset:11520
    v_mfma_f32_16x16x32_bf16 v[164:167], v[68:71], a[104:107], v[164:167]
    buffer_load_dwordx4 a[4:7], v240, s[16:19], s55 offen offset:0 sc1
    v_mfma_f32_16x16x32_bf16 v[168:171], v[68:71], a[248:251], v[168:171]
    s_waitcnt lgkmcnt(6)
    ds_read_b64_tr_b16 v[64:65], v233 offset:9248
    ds_read_b64_tr_b16 v[66:67], v233 offset:11552
    v_mfma_f32_16x16x32_bf16 v[172:175], v[72:75], a[104:107], v[172:175]
    buffer_load_dwordx4 v231, s[24:27], s54 offen offset:3072 lds
    v_mfma_f32_16x16x32_bf16 v[176:179], v[72:75], a[248:251], v[176:179]
    s_waitcnt lgkmcnt(6)
    ds_read_b64_tr_b16 v[68:69], v233 offset:9280
    ds_read_b64_tr_b16 v[70:71], v233 offset:11584
    v_mfma_f32_16x16x32_bf16 v[180:183], v[76:79], a[104:107], v[180:183]
    buffer_load_dwordx4 a[148:151], v240, s[16:19], s55 offen offset:1024 sc1
    v_mfma_f32_16x16x32_bf16 v[184:187], v[76:79], a[248:251], v[184:187]
    s_waitcnt lgkmcnt(6)
    ds_read_b64_tr_b16 v[72:73], v233 offset:9312
    ds_read_b64_tr_b16 v[74:75], v233 offset:11616
    v_mfma_f32_16x16x32_bf16 v[188:191], v[80:83], a[104:107], v[188:191]
    s_add_u32 s55, s81, 65536
    buffer_load_dwordx4 a[8:11], v239, s[16:19], s55 offen offset:0 sc1
    v_mfma_f32_16x16x32_bf16 v[192:195], v[80:83], a[248:251], v[192:195]
    s_waitcnt lgkmcnt(6)
    ds_read_b64_tr_b16 v[76:77], v233 offset:9344
    ds_read_b64_tr_b16 v[78:79], v233 offset:11648
    v_mfma_f32_16x16x32_bf16 v[148:151], v[60:63], a[108:111], v[148:151]
    buffer_load_dwordx4 a[152:155], v239, s[16:19], s55 offen offset:1024 sc1
    v_mfma_f32_16x16x32_bf16 v[152:155], v[60:63], a[252:255], v[152:155]
    s_waitcnt lgkmcnt(6)
    ds_read_b64_tr_b16 v[80:81], v233 offset:9376
    ds_read_b64_tr_b16 v[82:83], v233 offset:11680
    v_mfma_f32_16x16x32_bf16 v[156:159], v[64:67], a[108:111], v[156:159]
    buffer_load_dwordx4 a[12:15], v240, s[16:19], s55 offen offset:0 sc1
    v_mfma_f32_16x16x32_bf16 v[160:163], v[64:67], a[252:255], v[160:163]
    s_waitcnt lgkmcnt(6)
    s_waitcnt vmcnt(19)
    s_barrier
    ds_read_b64_tr_b16 v[60:61], v233 offset:18432
    ds_read_b64_tr_b16 v[62:63], v233 offset:20736
    v_mfma_f32_16x16x32_bf16 v[164:167], v[68:71], a[108:111], v[164:167]
    buffer_load_dwordx4 a[156:159], v240, s[16:19], s55 offen offset:1024 sc1
    v_mfma_f32_16x16x32_bf16 v[168:171], v[68:71], a[252:255], v[168:171]
    s_waitcnt lgkmcnt(6)
    ds_read_b64_tr_b16 v[64:65], v233 offset:18464
    ds_read_b64_tr_b16 v[66:67], v233 offset:20768
    v_mfma_f32_16x16x32_bf16 v[172:175], v[72:75], a[108:111], v[172:175]
    s_add_u32 m0, s88, 114688
    v_mfma_f32_16x16x32_bf16 v[176:179], v[72:75], a[252:255], v[176:179]
    s_waitcnt lgkmcnt(6)
    ds_read_b64_tr_b16 v[68:69], v233 offset:18496
    ds_read_b64_tr_b16 v[70:71], v233 offset:20800
    v_mfma_f32_16x16x32_bf16 v[180:183], v[76:79], a[108:111], v[180:183]
    buffer_load_dwordx4 v232, s[24:27], s54 offen offset:0 lds
    v_mfma_f32_16x16x32_bf16 v[184:187], v[76:79], a[252:255], v[184:187]
    s_waitcnt lgkmcnt(6)
    ds_read_b64_tr_b16 v[72:73], v233 offset:18528
    ds_read_b64_tr_b16 v[74:75], v233 offset:20832
    v_mfma_f32_16x16x32_bf16 v[188:191], v[80:83], a[108:111], v[188:191]
    s_add_u32 s54, s52, 294912
    v_mfma_f32_16x16x32_bf16 v[192:195], v[80:83], a[252:255], v[192:195]
    s_waitcnt lgkmcnt(6)
    ds_read_b64_tr_b16 v[76:77], v233 offset:18560
    ds_read_b64_tr_b16 v[78:79], v233 offset:20864
    v_mfma_f32_16x16x32_bf16 v[148:151], v[60:63], a[112:115], v[148:151]
    s_add_u32 m0, s88, 129024
    v_mfma_f32_16x16x32_bf16 v[152:155], v[60:63], a[116:119], v[152:155]
    s_waitcnt lgkmcnt(6)
    ds_read_b64_tr_b16 v[80:81], v233 offset:18592
    ds_read_b64_tr_b16 v[82:83], v233 offset:20896
    v_mfma_f32_16x16x32_bf16 v[156:159], v[64:67], a[112:115], v[156:159]
    buffer_load_dwordx4 v228, s[24:27], s54 offen offset:0 lds
    v_mfma_f32_16x16x32_bf16 v[160:163], v[64:67], a[116:119], v[160:163]
    s_waitcnt lgkmcnt(6)
    ds_read_b64_tr_b16 v[60:61], v233 offset:27648
    ds_read_b64_tr_b16 v[62:63], v233 offset:29952
    v_mfma_f32_16x16x32_bf16 v[164:167], v[68:71], a[112:115], v[164:167]
    buffer_load_dwordx4 v229, s[24:27], s54 offen offset:1024 lds
    v_mfma_f32_16x16x32_bf16 v[168:171], v[68:71], a[116:119], v[168:171]
    s_waitcnt lgkmcnt(6)
    ds_read_b64_tr_b16 v[64:65], v233 offset:27680
    ds_read_b64_tr_b16 v[66:67], v233 offset:29984
    v_mfma_f32_16x16x32_bf16 v[172:175], v[72:75], a[112:115], v[172:175]
    buffer_load_dwordx4 v230, s[24:27], s54 offen offset:2048 lds
    v_mfma_f32_16x16x32_bf16 v[176:179], v[72:75], a[116:119], v[176:179]
    s_waitcnt lgkmcnt(6)
    ds_read_b64_tr_b16 v[68:69], v233 offset:27712
    ds_read_b64_tr_b16 v[70:71], v233 offset:30016
    v_mfma_f32_16x16x32_bf16 v[180:183], v[76:79], a[112:115], v[180:183]
    buffer_load_dwordx4 v231, s[24:27], s54 offen offset:3072 lds
    v_mfma_f32_16x16x32_bf16 v[184:187], v[76:79], a[116:119], v[184:187]
    s_waitcnt lgkmcnt(6)
    ds_read_b64_tr_b16 v[72:73], v233 offset:27744
    ds_read_b64_tr_b16 v[74:75], v233 offset:30048
    v_mfma_f32_16x16x32_bf16 v[188:191], v[80:83], a[112:115], v[188:191]
    s_add_u32 m0, s88, 133120
    v_mfma_f32_16x16x32_bf16 v[192:195], v[80:83], a[116:119], v[192:195]
    s_waitcnt lgkmcnt(6)
    ds_read_b64_tr_b16 v[76:77], v233 offset:27776
    ds_read_b64_tr_b16 v[78:79], v233 offset:30080
    v_mfma_f32_16x16x32_bf16 v[148:151], v[60:63], a[120:123], v[148:151]
    buffer_load_dwordx4 v232, s[24:27], s54 offen offset:0 lds
    v_mfma_f32_16x16x32_bf16 v[152:155], v[60:63], a[124:127], v[152:155]
    s_waitcnt lgkmcnt(6)
    ds_read_b64_tr_b16 v[80:81], v233 offset:27808
    ds_read_b64_tr_b16 v[82:83], v233 offset:30112
    v_mfma_f32_16x16x32_bf16 v[156:159], v[64:67], a[120:123], v[156:159]
    v_mfma_f32_16x16x32_bf16 v[160:163], v[64:67], a[124:127], v[160:163]
    s_waitcnt lgkmcnt(6)
    s_waitcnt vmcnt(17)
    s_barrier
    ds_read_b64_tr_b16 v[60:61], v233 offset:36864
    ds_read_b64_tr_b16 v[62:63], v233 offset:39168
    v_mfma_f32_16x16x32_bf16 v[164:167], v[68:71], a[120:123], v[164:167]
    v_mfma_f32_16x16x32_bf16 v[168:171], v[68:71], a[124:127], v[168:171]
    s_waitcnt lgkmcnt(6)
    ds_read_b64_tr_b16 v[64:65], v233 offset:36896
    ds_read_b64_tr_b16 v[66:67], v233 offset:39200
    v_mfma_f32_16x16x32_bf16 v[172:175], v[72:75], a[120:123], v[172:175]
    v_mfma_f32_16x16x32_bf16 v[176:179], v[72:75], a[124:127], v[176:179]
    s_waitcnt lgkmcnt(6)
    ds_read_b64_tr_b16 v[68:69], v233 offset:36928
    ds_read_b64_tr_b16 v[70:71], v233 offset:39232
    v_mfma_f32_16x16x32_bf16 v[180:183], v[76:79], a[120:123], v[180:183]
    v_mfma_f32_16x16x32_bf16 v[184:187], v[76:79], a[124:127], v[184:187]
    s_waitcnt lgkmcnt(6)
    ds_read_b64_tr_b16 v[72:73], v233 offset:36960
    ds_read_b64_tr_b16 v[74:75], v233 offset:39264
    v_mfma_f32_16x16x32_bf16 v[188:191], v[80:83], a[120:123], v[188:191]
    v_mfma_f32_16x16x32_bf16 v[192:195], v[80:83], a[124:127], v[192:195]
    s_waitcnt lgkmcnt(6)
    ds_read_b64_tr_b16 v[76:77], v233 offset:36992
    ds_read_b64_tr_b16 v[78:79], v233 offset:39296
    v_mfma_f32_16x16x32_bf16 v[148:151], v[60:63], a[128:131], v[148:151]
    v_mfma_f32_16x16x32_bf16 v[152:155], v[60:63], a[132:135], v[152:155]
    s_waitcnt lgkmcnt(6)
    ds_read_b64_tr_b16 v[80:81], v233 offset:37024
    ds_read_b64_tr_b16 v[82:83], v233 offset:39328
    v_mfma_f32_16x16x32_bf16 v[156:159], v[64:67], a[128:131], v[156:159]
    v_mfma_f32_16x16x32_bf16 v[160:163], v[64:67], a[132:135], v[160:163]
    s_waitcnt lgkmcnt(6)
    ds_read_b64_tr_b16 v[60:61], v233 offset:46080
    ds_read_b64_tr_b16 v[62:63], v233 offset:48384
    v_mfma_f32_16x16x32_bf16 v[164:167], v[68:71], a[128:131], v[164:167]
    v_mfma_f32_16x16x32_bf16 v[168:171], v[68:71], a[132:135], v[168:171]
    s_waitcnt lgkmcnt(6)
    ds_read_b64_tr_b16 v[64:65], v233 offset:46112
    ds_read_b64_tr_b16 v[66:67], v233 offset:48416
    v_mfma_f32_16x16x32_bf16 v[172:175], v[72:75], a[128:131], v[172:175]
    v_mfma_f32_16x16x32_bf16 v[176:179], v[72:75], a[132:135], v[176:179]
    s_waitcnt lgkmcnt(6)
    ds_read_b64_tr_b16 v[68:69], v233 offset:46144
    ds_read_b64_tr_b16 v[70:71], v233 offset:48448
    v_mfma_f32_16x16x32_bf16 v[180:183], v[76:79], a[128:131], v[180:183]
    v_mfma_f32_16x16x32_bf16 v[184:187], v[76:79], a[132:135], v[184:187]
    s_waitcnt lgkmcnt(6)
    ds_read_b64_tr_b16 v[72:73], v233 offset:46176
    ds_read_b64_tr_b16 v[74:75], v233 offset:48480
    v_mfma_f32_16x16x32_bf16 v[188:191], v[80:83], a[128:131], v[188:191]
    v_mfma_f32_16x16x32_bf16 v[192:195], v[80:83], a[132:135], v[192:195]
    s_waitcnt lgkmcnt(6)
    ds_read_b64_tr_b16 v[76:77], v233 offset:46208
    ds_read_b64_tr_b16 v[78:79], v233 offset:48512
    v_mfma_f32_16x16x32_bf16 v[148:151], v[60:63], a[136:139], v[148:151]
    v_mfma_f32_16x16x32_bf16 v[152:155], v[60:63], a[140:143], v[152:155]
    s_waitcnt lgkmcnt(6)
    ds_read_b64_tr_b16 v[80:81], v233 offset:46240
    ds_read_b64_tr_b16 v[82:83], v233 offset:48544
    v_mfma_f32_16x16x32_bf16 v[156:159], v[64:67], a[136:139], v[156:159]
    v_mfma_f32_16x16x32_bf16 v[160:163], v[64:67], a[140:143], v[160:163]
    s_waitcnt lgkmcnt(6)
    s_waitcnt vmcnt(0)
    s_barrier
    ds_read_b64_tr_b16 v[60:61], v234 offset:45056
    ds_read_b64_tr_b16 v[62:63], v234 offset:47360
    v_mfma_f32_16x16x32_bf16 v[164:167], v[68:71], a[136:139], v[164:167]
    v_mfma_f32_16x16x32_bf16 v[168:171], v[68:71], a[140:143], v[168:171]
    s_waitcnt lgkmcnt(6)
    ds_read_b64_tr_b16 v[64:65], v234 offset:54272
    ds_read_b64_tr_b16 v[66:67], v234 offset:56576
    v_mfma_f32_16x16x32_bf16 v[172:175], v[72:75], a[136:139], v[172:175]
    v_mfma_f32_16x16x32_bf16 v[176:179], v[72:75], a[140:143], v[176:179]
    s_waitcnt lgkmcnt(6)
    ds_read_b64_tr_b16 v[68:69], v234 offset:63488
    ds_read_b64_tr_b16 v[70:71], v235 offset:256
    v_mfma_f32_16x16x32_bf16 v[180:183], v[76:79], a[136:139], v[180:183]
    v_mfma_f32_16x16x32_bf16 v[184:187], v[76:79], a[140:143], v[184:187]
    s_waitcnt lgkmcnt(6)
    ds_read_b64_tr_b16 v[72:73], v235 offset:7168
    ds_read_b64_tr_b16 v[74:75], v235 offset:9472
    v_mfma_f32_16x16x32_bf16 v[188:191], v[80:83], a[136:139], v[188:191]
    v_mfma_f32_16x16x32_bf16 v[192:195], v[80:83], a[140:143], v[192:195]
    s_waitcnt lgkmcnt(6)
    ds_read_b64_tr_b16 v[76:77], v234 offset:45088
    ds_read_b64_tr_b16 v[78:79], v234 offset:47392
    v_mfma_f32_16x16x32_bf16 v[148:151], v[60:63], a[0:3], v[148:151]
    v_mfma_f32_16x16x32_bf16 v[152:155], v[60:63], a[144:147], v[152:155]
    s_waitcnt lgkmcnt(6)
    ds_read_b64_tr_b16 v[80:81], v234 offset:54304
    ds_read_b64_tr_b16 v[82:83], v234 offset:56608
    v_mfma_f32_16x16x32_bf16 v[148:151], v[64:67], a[4:7], v[148:151]
    v_mfma_f32_16x16x32_bf16 v[152:155], v[64:67], a[148:151], v[152:155]
    s_waitcnt lgkmcnt(6)
    ds_read_b64_tr_b16 v[60:61], v234 offset:63520
    ds_read_b64_tr_b16 v[62:63], v235 offset:288
    v_mfma_f32_16x16x32_bf16 v[148:151], v[68:71], a[8:11], v[148:151]
    v_mfma_f32_16x16x32_bf16 v[152:155], v[68:71], a[152:155], v[152:155]
    s_waitcnt lgkmcnt(6)
    ds_read_b64_tr_b16 v[64:65], v235 offset:7200
    ds_read_b64_tr_b16 v[66:67], v235 offset:9504
    v_mfma_f32_16x16x32_bf16 v[148:151], v[72:75], a[12:15], v[148:151]
    v_mfma_f32_16x16x32_bf16 v[152:155], v[72:75], a[156:159], v[152:155]
    s_waitcnt lgkmcnt(6)
    ds_read_b64_tr_b16 v[68:69], v234 offset:45120
    ds_read_b64_tr_b16 v[70:71], v234 offset:47424
    v_mfma_f32_16x16x32_bf16 v[156:159], v[76:79], a[0:3], v[156:159]
    v_mfma_f32_16x16x32_bf16 v[160:163], v[76:79], a[144:147], v[160:163]
    s_waitcnt lgkmcnt(6)
    ds_read_b64_tr_b16 v[72:73], v234 offset:54336
    ds_read_b64_tr_b16 v[74:75], v234 offset:56640
    v_mfma_f32_16x16x32_bf16 v[156:159], v[80:83], a[4:7], v[156:159]
    v_mfma_f32_16x16x32_bf16 v[160:163], v[80:83], a[148:151], v[160:163]
    s_waitcnt lgkmcnt(6)
    ds_read_b64_tr_b16 v[76:77], v234 offset:63552
    ds_read_b64_tr_b16 v[78:79], v235 offset:320
    v_mfma_f32_16x16x32_bf16 v[156:159], v[60:63], a[8:11], v[156:159]
    v_cvt_pk_bf16_f32 v44, v148, v149
    v_cvt_pk_bf16_f32 v45, v150, v151
    v_mfma_f32_16x16x32_bf16 v[160:163], v[60:63], a[152:155], v[160:163]
    s_waitcnt lgkmcnt(6)
    ds_read_b64_tr_b16 v[80:81], v235 offset:7232
    ds_read_b64_tr_b16 v[82:83], v235 offset:9536
    v_mfma_f32_16x16x32_bf16 v[156:159], v[64:67], a[12:15], v[156:159]
    v_cvt_pk_bf16_f32 v46, v152, v153
    v_cvt_pk_bf16_f32 v47, v154, v155
    v_mfma_f32_16x16x32_bf16 v[160:163], v[64:67], a[156:159], v[160:163]
    s_waitcnt lgkmcnt(6)
    ds_read_b64_tr_b16 v[60:61], v234 offset:45152
    ds_read_b64_tr_b16 v[62:63], v234 offset:47456
    v_mfma_f32_16x16x32_bf16 v[164:167], v[68:71], a[0:3], v[164:167]
    buffer_store_dwordx4 v[44:47], v8, s[16:19], s61 offen sc1
    v_mfma_f32_16x16x32_bf16 v[168:171], v[68:71], a[144:147], v[168:171]
    s_waitcnt lgkmcnt(6)
    ds_read_b64_tr_b16 v[64:65], v234 offset:54368
    ds_read_b64_tr_b16 v[66:67], v234 offset:56672
    v_mfma_f32_16x16x32_bf16 v[164:167], v[72:75], a[4:7], v[164:167]
    v_mfma_f32_16x16x32_bf16 v[168:171], v[72:75], a[148:151], v[168:171]
    s_waitcnt lgkmcnt(6)
    ds_read_b64_tr_b16 v[68:69], v234 offset:63584
    ds_read_b64_tr_b16 v[70:71], v235 offset:352
    v_mfma_f32_16x16x32_bf16 v[164:167], v[76:79], a[8:11], v[164:167]
    v_cvt_pk_bf16_f32 v48, v156, v157
    v_cvt_pk_bf16_f32 v49, v158, v159
    v_mfma_f32_16x16x32_bf16 v[168:171], v[76:79], a[152:155], v[168:171]
    s_waitcnt lgkmcnt(6)
    ds_read_b64_tr_b16 v[72:73], v235 offset:7264
    ds_read_b64_tr_b16 v[74:75], v235 offset:9568
    v_mfma_f32_16x16x32_bf16 v[164:167], v[80:83], a[12:15], v[164:167]
    v_cvt_pk_bf16_f32 v50, v160, v161
    v_cvt_pk_bf16_f32 v51, v162, v163
    v_mfma_f32_16x16x32_bf16 v[168:171], v[80:83], a[156:159], v[168:171]
    s_waitcnt lgkmcnt(6)
    ds_read_b64_tr_b16 v[76:77], v234 offset:45184
    ds_read_b64_tr_b16 v[78:79], v234 offset:47488
    v_mfma_f32_16x16x32_bf16 v[172:175], v[60:63], a[0:3], v[172:175]
    buffer_store_dwordx4 v[48:51], v8, s[16:19], s62 offen sc1
    v_mfma_f32_16x16x32_bf16 v[176:179], v[60:63], a[144:147], v[176:179]
    s_waitcnt lgkmcnt(6)
    ds_read_b64_tr_b16 v[80:81], v234 offset:54400
    ds_read_b64_tr_b16 v[82:83], v234 offset:56704
    v_mfma_f32_16x16x32_bf16 v[172:175], v[64:67], a[4:7], v[172:175]
    v_mfma_f32_16x16x32_bf16 v[176:179], v[64:67], a[148:151], v[176:179]
    s_waitcnt lgkmcnt(6)
    ds_read_b64_tr_b16 v[60:61], v234 offset:63616
    ds_read_b64_tr_b16 v[62:63], v235 offset:384
    v_mfma_f32_16x16x32_bf16 v[172:175], v[68:71], a[8:11], v[172:175]
    v_cvt_pk_bf16_f32 v52, v164, v165
    v_cvt_pk_bf16_f32 v53, v166, v167
    v_mfma_f32_16x16x32_bf16 v[176:179], v[68:71], a[152:155], v[176:179]
    s_waitcnt lgkmcnt(6)
    ds_read_b64_tr_b16 v[64:65], v235 offset:7296
    ds_read_b64_tr_b16 v[66:67], v235 offset:9600
    v_mfma_f32_16x16x32_bf16 v[172:175], v[72:75], a[12:15], v[172:175]
    v_cvt_pk_bf16_f32 v54, v168, v169
    v_cvt_pk_bf16_f32 v55, v170, v171
    v_mfma_f32_16x16x32_bf16 v[176:179], v[72:75], a[156:159], v[176:179]
    s_waitcnt lgkmcnt(6)
    ds_read_b64_tr_b16 v[68:69], v234 offset:45216
    ds_read_b64_tr_b16 v[70:71], v234 offset:47520
    v_mfma_f32_16x16x32_bf16 v[180:183], v[76:79], a[0:3], v[180:183]
    buffer_store_dwordx4 v[52:55], v8, s[16:19], s63 offen sc1
    v_mfma_f32_16x16x32_bf16 v[184:187], v[76:79], a[144:147], v[184:187]
    s_waitcnt lgkmcnt(6)
    ds_read_b64_tr_b16 v[72:73], v234 offset:54432
    ds_read_b64_tr_b16 v[74:75], v234 offset:56736
    v_mfma_f32_16x16x32_bf16 v[180:183], v[80:83], a[4:7], v[180:183]
    v_mfma_f32_16x16x32_bf16 v[184:187], v[80:83], a[148:151], v[184:187]
    s_waitcnt lgkmcnt(6)
    ds_read_b64_tr_b16 v[76:77], v234 offset:63648
    ds_read_b64_tr_b16 v[78:79], v235 offset:416
    v_mfma_f32_16x16x32_bf16 v[180:183], v[60:63], a[8:11], v[180:183]
    v_cvt_pk_bf16_f32 v56, v172, v173
    v_cvt_pk_bf16_f32 v57, v174, v175
    v_mfma_f32_16x16x32_bf16 v[184:187], v[60:63], a[152:155], v[184:187]
    s_waitcnt lgkmcnt(6)
    ds_read_b64_tr_b16 v[80:81], v235 offset:7328
    ds_read_b64_tr_b16 v[82:83], v235 offset:9632
    v_mfma_f32_16x16x32_bf16 v[180:183], v[64:67], a[12:15], v[180:183]
    v_cvt_pk_bf16_f32 v58, v176, v177
    v_cvt_pk_bf16_f32 v59, v178, v179
    v_mfma_f32_16x16x32_bf16 v[184:187], v[64:67], a[156:159], v[184:187]
    s_waitcnt lgkmcnt(6)
    ds_read_b64_tr_b16 v[60:61], v234 offset:26816
    ds_read_b64_tr_b16 v[62:63], v234 offset:29120
    v_mfma_f32_16x16x32_bf16 v[188:191], v[68:71], a[0:3], v[188:191]
    buffer_store_dwordx4 v[56:59], v8, s[16:19], s64 offen sc1
    v_mfma_f32_16x16x32_bf16 v[192:195], v[68:71], a[144:147], v[192:195]
    s_waitcnt lgkmcnt(6)
    ds_read_b64_tr_b16 v[64:65], v234 offset:26848
    ds_read_b64_tr_b16 v[66:67], v234 offset:29152
    v_mfma_f32_16x16x32_bf16 v[188:191], v[72:75], a[4:7], v[188:191]
    v_mfma_f32_16x16x32_bf16 v[192:195], v[72:75], a[148:151], v[192:195]
    s_waitcnt lgkmcnt(6)
    ds_read_b64_tr_b16 v[68:69], v234 offset:36032
    ds_read_b64_tr_b16 v[70:71], v234 offset:38336
    v_mfma_f32_16x16x32_bf16 v[188:191], v[76:79], a[8:11], v[188:191]
    v_cvt_pk_bf16_f32 v44, v180, v181
    v_cvt_pk_bf16_f32 v45, v182, v183
    v_mfma_f32_16x16x32_bf16 v[192:195], v[76:79], a[152:155], v[192:195]
    s_waitcnt lgkmcnt(6)
    ds_read_b64_tr_b16 v[72:73], v234 offset:36064
    ds_read_b64_tr_b16 v[74:75], v234 offset:38368
    v_mfma_f32_16x16x32_bf16 v[188:191], v[80:83], a[12:15], v[188:191]
    v_cvt_pk_bf16_f32 v46, v184, v185
    v_cvt_pk_bf16_f32 v47, v186, v187
    v_mfma_f32_16x16x32_bf16 v[192:195], v[80:83], a[156:159], v[192:195]
    s_waitcnt lgkmcnt(6)
    ds_read_b64_tr_b16 v[76:77], v233 offset:192
    ds_read_b64_tr_b16 v[78:79], v233 offset:2496
    v_mfma_f32_16x16x32_bf16 v[196:199], v[60:63], a[96:99], v[196:199]
    buffer_store_dwordx4 v[44:47], v8, s[16:19], s65 offen sc1
    v_mfma_f32_16x16x32_bf16 v[200:203], v[60:63], a[240:243], v[200:203]
    s_waitcnt lgkmcnt(6)
    ds_read_b64_tr_b16 v[80:81], v233 offset:224
    ds_read_b64_tr_b16 v[82:83], v233 offset:2528
    v_mfma_f32_16x16x32_bf16 v[204:207], v[64:67], a[96:99], v[204:207]
    v_mfma_f32_16x16x32_bf16 v[208:211], v[64:67], a[240:243], v[208:211]
    s_waitcnt lgkmcnt(6)
    ds_read_b64_tr_b16 v[60:61], v233 offset:9408
    ds_read_b64_tr_b16 v[62:63], v233 offset:11712
    v_mfma_f32_16x16x32_bf16 v[196:199], v[68:71], a[100:103], v[196:199]
    v_cvt_pk_bf16_f32 v48, v188, v189
    v_cvt_pk_bf16_f32 v49, v190, v191
    v_mfma_f32_16x16x32_bf16 v[200:203], v[68:71], a[244:247], v[200:203]
    s_waitcnt lgkmcnt(6)
    ds_read_b64_tr_b16 v[64:65], v233 offset:9440
    ds_read_b64_tr_b16 v[66:67], v233 offset:11744
    v_mfma_f32_16x16x32_bf16 v[204:207], v[72:75], a[100:103], v[204:207]
    v_cvt_pk_bf16_f32 v50, v192, v193
    v_cvt_pk_bf16_f32 v51, v194, v195
    v_mfma_f32_16x16x32_bf16 v[208:211], v[72:75], a[244:247], v[208:211]
    s_waitcnt lgkmcnt(6)
    ds_read_b64_tr_b16 v[68:69], v233 offset:18624
    ds_read_b64_tr_b16 v[70:71], v233 offset:20928
    v_mfma_f32_16x16x32_bf16 v[196:199], v[76:79], a[104:107], v[196:199]
    buffer_store_dwordx4 v[48:51], v8, s[16:19], s66 offen sc1
    v_mfma_f32_16x16x32_bf16 v[200:203], v[76:79], a[248:251], v[200:203]
    s_waitcnt lgkmcnt(6)
    ds_read_b64_tr_b16 v[72:73], v233 offset:18656
    ds_read_b64_tr_b16 v[74:75], v233 offset:20960
    v_mfma_f32_16x16x32_bf16 v[204:207], v[80:83], a[104:107], v[204:207]
    v_mfma_f32_16x16x32_bf16 v[208:211], v[80:83], a[248:251], v[208:211]
    s_waitcnt lgkmcnt(6)
    ds_read_b64_tr_b16 v[76:77], v233 offset:27840
    ds_read_b64_tr_b16 v[78:79], v233 offset:30144
    v_mfma_f32_16x16x32_bf16 v[196:199], v[60:63], a[108:111], v[196:199]
    v_mfma_f32_16x16x32_bf16 v[200:203], v[60:63], a[252:255], v[200:203]
    s_waitcnt lgkmcnt(6)
    ds_read_b64_tr_b16 v[80:81], v233 offset:27872
    ds_read_b64_tr_b16 v[82:83], v233 offset:30176
    v_mfma_f32_16x16x32_bf16 v[204:207], v[64:67], a[108:111], v[204:207]
    v_mfma_f32_16x16x32_bf16 v[208:211], v[64:67], a[252:255], v[208:211]
    s_waitcnt lgkmcnt(6)
    ds_read_b64_tr_b16 v[60:61], v233 offset:37056
    ds_read_b64_tr_b16 v[62:63], v233 offset:39360
    v_mfma_f32_16x16x32_bf16 v[196:199], v[68:71], a[112:115], v[196:199]
    v_mfma_f32_16x16x32_bf16 v[200:203], v[68:71], a[116:119], v[200:203]
    s_waitcnt lgkmcnt(6)
    ds_read_b64_tr_b16 v[64:65], v233 offset:37088
    ds_read_b64_tr_b16 v[66:67], v233 offset:39392
    v_mfma_f32_16x16x32_bf16 v[204:207], v[72:75], a[112:115], v[204:207]
    v_mfma_f32_16x16x32_bf16 v[208:211], v[72:75], a[116:119], v[208:211]
    s_waitcnt lgkmcnt(6)
    ds_read_b64_tr_b16 v[68:69], v233 offset:46272
    ds_read_b64_tr_b16 v[70:71], v233 offset:48576
    v_mfma_f32_16x16x32_bf16 v[196:199], v[76:79], a[120:123], v[196:199]
    v_mfma_f32_16x16x32_bf16 v[200:203], v[76:79], a[124:127], v[200:203]
    s_waitcnt lgkmcnt(6)
    ds_read_b64_tr_b16 v[72:73], v233 offset:46304
    ds_read_b64_tr_b16 v[74:75], v233 offset:48608
    v_mfma_f32_16x16x32_bf16 v[204:207], v[80:83], a[120:123], v[204:207]
    v_mfma_f32_16x16x32_bf16 v[208:211], v[80:83], a[124:127], v[208:211]
    s_waitcnt lgkmcnt(6)
    ds_read_b64_tr_b16 v[76:77], v234 offset:45248
    ds_read_b64_tr_b16 v[78:79], v234 offset:47552
    v_mfma_f32_16x16x32_bf16 v[196:199], v[60:63], a[128:131], v[196:199]
    v_mfma_f32_16x16x32_bf16 v[200:203], v[60:63], a[132:135], v[200:203]
    s_waitcnt lgkmcnt(6)
    ds_read_b64_tr_b16 v[80:81], v234 offset:45280
    ds_read_b64_tr_b16 v[82:83], v234 offset:47584
    v_mfma_f32_16x16x32_bf16 v[204:207], v[64:67], a[128:131], v[204:207]
    v_mfma_f32_16x16x32_bf16 v[208:211], v[64:67], a[132:135], v[208:211]
    s_waitcnt lgkmcnt(6)
    ds_read_b64_tr_b16 v[60:61], v234 offset:54464
    ds_read_b64_tr_b16 v[62:63], v234 offset:56768
    v_mfma_f32_16x16x32_bf16 v[196:199], v[68:71], a[136:139], v[196:199]
    v_mfma_f32_16x16x32_bf16 v[200:203], v[68:71], a[140:143], v[200:203]
    s_waitcnt lgkmcnt(6)
    ds_read_b64_tr_b16 v[64:65], v234 offset:54496
    ds_read_b64_tr_b16 v[66:67], v234 offset:56800
    v_mfma_f32_16x16x32_bf16 v[204:207], v[72:75], a[136:139], v[204:207]
    v_mfma_f32_16x16x32_bf16 v[208:211], v[72:75], a[140:143], v[208:211]
    s_waitcnt lgkmcnt(6)
    ds_read_b64_tr_b16 v[68:69], v234 offset:63680
    ds_read_b64_tr_b16 v[70:71], v235 offset:448
    s_or_b32 s3, s60, 6
    v_mov_b32 v243, s3
    s_waitcnt vmcnt(0)
    s_barrier
    buffer_store_dword v243, v241, s[16:19], 0 offen sc1
    v_mfma_f32_16x16x32_bf16 v[196:199], v[76:79], a[0:3], v[196:199]
    v_mfma_f32_16x16x32_bf16 v[200:203], v[76:79], a[144:147], v[200:203]
    s_waitcnt lgkmcnt(6)
    ds_read_b64_tr_b16 v[72:73], v234 offset:63712
    ds_read_b64_tr_b16 v[74:75], v235 offset:480
    v_mfma_f32_16x16x32_bf16 v[204:207], v[80:83], a[0:3], v[204:207]
    v_mfma_f32_16x16x32_bf16 v[208:211], v[80:83], a[144:147], v[208:211]
    s_waitcnt lgkmcnt(6)
    ds_read_b64_tr_b16 v[76:77], v235 offset:7360
    ds_read_b64_tr_b16 v[78:79], v235 offset:9664
    v_mfma_f32_16x16x32_bf16 v[196:199], v[60:63], a[4:7], v[196:199]
    v_mfma_f32_16x16x32_bf16 v[200:203], v[60:63], a[148:151], v[200:203]
    s_waitcnt lgkmcnt(6)
    ds_read_b64_tr_b16 v[80:81], v235 offset:7392
    ds_read_b64_tr_b16 v[82:83], v235 offset:9696
    v_mfma_f32_16x16x32_bf16 v[204:207], v[64:67], a[4:7], v[204:207]
    v_mfma_f32_16x16x32_bf16 v[208:211], v[64:67], a[148:151], v[208:211]
    s_waitcnt lgkmcnt(6)
    v_mfma_f32_16x16x32_bf16 v[196:199], v[68:71], a[8:11], v[196:199]
    v_mfma_f32_16x16x32_bf16 v[200:203], v[68:71], a[152:155], v[200:203]
    s_waitcnt lgkmcnt(4)
    v_mfma_f32_16x16x32_bf16 v[204:207], v[72:75], a[8:11], v[204:207]
    v_mfma_f32_16x16x32_bf16 v[208:211], v[72:75], a[152:155], v[208:211]
    s_waitcnt lgkmcnt(2)
    v_mfma_f32_16x16x32_bf16 v[196:199], v[76:79], a[12:15], v[196:199]
    v_mfma_f32_16x16x32_bf16 v[200:203], v[76:79], a[156:159], v[200:203]
    s_waitcnt lgkmcnt(0)
    v_mfma_f32_16x16x32_bf16 v[204:207], v[80:83], a[12:15], v[204:207]
    v_mfma_f32_16x16x32_bf16 v[208:211], v[80:83], a[156:159], v[208:211]
    s_nop 3
    buffer_load_dword v29, v242, s[16:19], 0 offen sc1
    v_and_b32 v30, 15, v1
    v_mul_u32_u24 v30, 1152, v30
    v_bfe_u32 v32, v1, 4, 1
    v_lshl_add_u32 v30, v32, 5, v30
    v_lshrrev_b32 v32, 5, v1
    v_lshl_add_u32 v30, v32, 4, v30
    v_add_u32 v31, 18432, v30
    v_lshlrev_b32 v34, 16, v246
    v_and_b32 v35, 0xffff0000, v246
    v_lshlrev_b32 v32, 16, v247
    v_and_b32 v33, 0xffff0000, v247
    v_add_f32 v196, v196, v34
    v_add_f32 v197, v197, v35
    v_add_f32 v198, v198, v32
    v_add_f32 v199, v199, v33
    v_add_f32 v200, v200, v34
    v_add_f32 v201, v201, v35
    v_add_f32 v202, v202, v32
    v_add_f32 v203, v203, v33
    v_lshlrev_b32 v34, 16, v248
    v_and_b32 v35, 0xffff0000, v248
    v_lshlrev_b32 v32, 16, v249
    v_and_b32 v33, 0xffff0000, v249
    v_add_f32 v204, v204, v34
    v_add_f32 v205, v205, v35
    v_add_f32 v206, v206, v32
    v_add_f32 v207, v207, v33
    v_add_f32 v208, v208, v34
    v_add_f32 v209, v209, v35
    v_add_f32 v210, v210, v32
    v_add_f32 v211, v211, v33
    v_add_u32 v36, 16384, v8
    s_add_u32 s3, s58, 1
    s_and_b32 s3, s3, 3
    s_lshl_b32 s61, s3, 12
    s_add_u32 s3, s58, 2
    s_and_b32 s3, s3, 3
    s_lshl_b32 s62, s3, 12
    s_add_u32 s3, s58, 3
    s_and_b32 s3, s3, 3
    s_lshl_b32 s63, s3, 12
    s_waitcnt vmcnt(0)
    s_add_u32 s3, s60, 6
    v_subrev_u32 v23, s3, v29
    v_cmp_ge_u32 vcc, 1, v23
    s_and_b64 vcc, vcc, s[92:93]
    s_cmp_eq_u64 vcc, s[92:93]
    s_cbranch_scc0 L_spineF
L_backeF:
    s_add_u32 s3, s61, s69
    buffer_load_dwordx4 v[84:87], v8, s[16:19], s3 offen sc1
    s_add_u32 s3, s62, s69
    buffer_load_dwordx4 v[88:91], v8, s[16:19], s3 offen sc1
    s_add_u32 s3, s63, s69
    buffer_load_dwordx4 v[92:95], v8, s[16:19], s3 offen sc1
    s_add_u32 s3, s61, s69
    buffer_load_dwordx4 v[96:99], v36, s[16:19], s3 offen sc1
    s_add_u32 s3, s62, s69
    buffer_load_dwordx4 v[100:103], v36, s[16:19], s3 offen sc1
    s_add_u32 s3, s63, s69
    buffer_load_dwordx4 v[104:107], v36, s[16:19], s3 offen sc1
    s_waitcnt vmcnt(5)
    v_lshlrev_b32 v38, 16, v84
    v_and_b32 v39, 0xffff0000, v84
    v_add_f32 v196, v196, v38
    v_add_f32 v197, v197, v39
    v_lshlrev_b32 v38, 16, v85
    v_and_b32 v39, 0xffff0000, v85
    v_add_f32 v198, v198, v38
    v_add_f32 v199, v199, v39
    v_lshlrev_b32 v38, 16, v86
    v_and_b32 v39, 0xffff0000, v86
    v_add_f32 v200, v200, v38
    v_add_f32 v201, v201, v39
    v_lshlrev_b32 v38, 16, v87
    v_and_b32 v39, 0xffff0000, v87
    v_add_f32 v202, v202, v38
    v_add_f32 v203, v203, v39
    s_waitcnt vmcnt(4)
    v_lshlrev_b32 v38, 16, v88
    v_and_b32 v39, 0xffff0000, v88
    v_add_f32 v196, v196, v38
    v_add_f32 v197, v197, v39
    v_lshlrev_b32 v38, 16, v89
    v_and_b32 v39, 0xffff0000, v89
    v_add_f32 v198, v198, v38
    v_add_f32 v199, v199, v39
    v_lshlrev_b32 v38, 16, v90
    v_and_b32 v39, 0xffff0000, v90
    v_add_f32 v200, v200, v38
    v_add_f32 v201, v201, v39
    v_lshlrev_b32 v38, 16, v91
    v_and_b32 v39, 0xffff0000, v91
    v_add_f32 v202, v202, v38
    v_add_f32 v203, v203, v39
    s_waitcnt vmcnt(3)
    v_lshlrev_b32 v38, 16, v92
    v_and_b32 v39, 0xffff0000, v92
    v_add_f32 v196, v196, v38
    v_add_f32 v197, v197, v39
    v_lshlrev_b32 v38, 16, v93
    v_and_b32 v39, 0xffff0000, v93
    v_add_f32 v198, v198, v38
    v_add_f32 v199, v199, v39
    v_lshlrev_b32 v38, 16, v94
    v_and_b32 v39, 0xffff0000, v94
    v_add_f32 v200, v200, v38
    v_add_f32 v201, v201, v39
    v_lshlrev_b32 v38, 16, v95
    v_and_b32 v39, 0xffff0000, v95
    v_add_f32 v202, v202, v38
    v_add_f32 v203, v203, v39
    v_cvt_pk_bf16_f32 v44, v196, v197
    v_cvt_pk_bf16_f32 v45, v198, v199
    v_cvt_pk_bf16_f32 v48, v200, v201
    v_cvt_pk_bf16_f32 v49, v202, v203
    s_waitcnt vmcnt(2)
    v_lshlrev_b32 v38, 16, v96
    v_and_b32 v39, 0xffff0000, v96
    v_add_f32 v204, v204, v38
    v_add_f32 v205, v205, v39
    v_lshlrev_b32 v38, 16, v97
    v_and_b32 v39, 0xffff0000, v97
    v_add_f32 v206, v206, v38
    v_add_f32 v207, v207, v39
    v_lshlrev_b32 v38, 16, v98
    v_and_b32 v39, 0xffff0000, v98
    v_add_f32 v208, v208, v38
    v_add_f32 v209, v209, v39
    v_lshlrev_b32 v38, 16, v99
    v_and_b32 v39, 0xffff0000, v99
    v_add_f32 v210, v210, v38
    v_add_f32 v211, v211, v39
    s_waitcnt vmcnt(1)
    v_lshlrev_b32 v38, 16, v100
    v_and_b32 v39, 0xffff0000, v100
    v_add_f32 v204, v204, v38
    v_add_f32 v205, v205, v39
    v_lshlrev_b32 v38, 16, v101
    v_and_b32 v39, 0xffff0000, v101
    v_add_f32 v206, v206, v38
    v_add_f32 v207, v207, v39
    v_lshlrev_b32 v38, 16, v102
    v_and_b32 v39, 0xffff0000, v102
    v_add_f32 v208, v208, v38
    v_add_f32 v209, v209, v39
    v_lshlrev_b32 v38, 16, v103
    v_and_b32 v39, 0xffff0000, v103
    v_add_f32 v210, v210, v38
    v_add_f32 v211, v211, v39
    s_waitcnt vmcnt(0)
    v_lshlrev_b32 v38, 16, v104
    v_and_b32 v39, 0xffff0000, v104
    v_add_f32 v204, v204, v38
    v_add_f32 v205, v205, v39
    v_lshlrev_b32 v38, 16, v105
    v_and_b32 v39, 0xffff0000, v105
    v_add_f32 v206, v206, v38
    v_add_f32 v207, v207, v39
    v_lshlrev_b32 v38, 16, v106
    v_and_b32 v39, 0xffff0000, v106
    v_add_f32 v208, v208, v38
    v_add_f32 v209, v209, v39
    v_lshlrev_b32 v38, 16, v107
    v_and_b32 v39, 0xffff0000, v107
    v_add_f32 v210, v210, v38
    v_add_f32 v211, v211, v39
    v_cvt_pk_bf16_f32 v46, v204, v205
    v_cvt_pk_bf16_f32 v47, v206, v207
    v_cvt_pk_bf16_f32 v50, v208, v209
    v_cvt_pk_bf16_f32 v51, v210, v211
    v_permlane16_swap_b32 v44, v46
    v_permlane16_swap_b32 v45, v47
    buffer_store_dwordx4 v[44:47], v30, s[28:31], s72 offen sc1
    v_permlane16_swap_b32 v48, v50
    v_permlane16_swap_b32 v49, v51
    buffer_store_dwordx4 v[48:51], v31, s[28:31], s72 offen sc1
    s_endpgm
L_spineN:
    s_mov_b32 s96, 0x20000
L_spineN_l:
    buffer_load_dword v29, v244, s[36:39], 0 offen sc1
    s_waitcnt vmcnt(0)
    v_readfirstlane_b32 s60, v29
    s_nop 0
    s_cmp_lg_u32 s60, 0
    s_cbranch_scc1 L_backeN
    s_sub_u32 s96, s96, 1
    s_cmp_lg_u32 s96, 0
    s_cbranch_scc1 L_spineN_l
    s_branch L_backeN
L_spine1:
    s_mov_b32 s96, 0x20000
L_spine1_l:
    buffer_load_dword v29, v242, s[16:19], 0 offen sc1
    s_waitcnt vmcnt(0)
    s_add_u32 s3, s60, 1
    v_subrev_u32 v23, s3, v29
    v_cmp_ge_u32 vcc, 6, v23
    s_and_b64 vcc, vcc, s[90:91]
    s_cmp_eq_u64 vcc, s[90:91]
    s_cbranch_scc1 L_backe1
    s_sub_u32 s96, s96, 1
    s_cmp_lg_u32 s96, 0
    s_cbranch_scc1 L_spine1_l
    s_branch L_backe1
L_spine2:
    s_mov_b32 s96, 0x20000
L_spine2_l:
    buffer_load_dword v29, v242, s[16:19], 0 offen sc1
    s_waitcnt vmcnt(0)
    s_add_u32 s3, s60, 2
    v_subrev_u32 v23, s3, v29
    v_cmp_ge_u32 vcc, 5, v23
    s_and_b64 vcc, vcc, s[90:91]
    s_cmp_eq_u64 vcc, s[90:91]
    s_cbranch_scc1 L_backe2
    s_sub_u32 s96, s96, 1
    s_cmp_lg_u32 s96, 0
    s_cbranch_scc1 L_spine2_l
    s_branch L_backe2
L_spine3:
    s_mov_b32 s96, 0x20000
L_spine3_l:
    buffer_load_dword v29, v242, s[16:19], 0 offen sc1
    s_waitcnt vmcnt(0)
    s_add_u32 s3, s60, 3
    v_subrev_u32 v23, s3, v29
    v_cmp_ge_u32 vcc, 4, v23
    s_and_b64 vcc, vcc, s[90:91]
    s_cmp_eq_u64 vcc, s[90:91]
    s_cbranch_scc1 L_backe3
    s_sub_u32 s96, s96, 1
    s_cmp_lg_u32 s96, 0
    s_cbranch_scc1 L_spine3_l
    s_branch L_backe3
L_spineF:
    s_mov_b32 s96, 0x20000
L_spineF_l:
    buffer_load_dword v29, v242, s[16:19], 0 offen sc1
    s_waitcnt vmcnt(0)
    s_add_u32 s3, s60, 6
    v_subrev_u32 v23, s3, v29
    v_cmp_ge_u32 vcc, 1, v23
    s_and_b64 vcc, vcc, s[92:93]
    s_cmp_eq_u64 vcc, s[92:93]
    s_cbranch_scc1 L_backeF
    s_sub_u32 s96, s96, 1
    s_cmp_lg_u32 s96, 0
    s_cbranch_scc1 L_spineF_l
    s_branch L_backeF
L_odd:
    v_subrev_u32 v9, 640, v9
    buffer_load_dwordx4 v3, s[8:11], s62 offen offset:1024 lds
    buffer_load_dwordx4 v4, s[8:11], s62 offen offset:2048 lds
    buffer_load_dwordx4 v5, s[8:11], s62 offen offset:3072 lds
    s_add_u32 m0, s85, 40960
    s_nop 0
    buffer_load_dwordx4 v6, s[12:15], s71 offen offset:0 lds
    buffer_load_dwordx4 v7, s[12:15], s71 offen offset:1024 lds
    s_mov_b32 s20, 69120
    buffer_load_dword v254, v21, s[24:27], s20 offen
    s_waitcnt vmcnt(13)
    s_barrier
    ds_read_b128 v[212:215], v26 offset:0
    ds_read_b128 v[216:219], v26 offset:32
    ds_read_b128 v[220:223], v26 offset:64
    ds_read_b128 v[224:227], v26 offset:96
    ds_read_b64_tr_b16 v[60:61], v18 offset:16384
    ds_read_b64_tr_b16 v[62:63], v18 offset:16896
    ds_read_b128 a[0:3], v10 offset:0
    ds_read_b128 a[144:147], v14 offset:0
    ds_read_b64_tr_b16 v[64:65], v18 offset:18432
    ds_read_b64_tr_b16 v[66:67], v18 offset:18944
    ds_read_b128 a[4:7], v11 offset:0
    ds_read_b128 a[148:151], v15 offset:0
    s_waitcnt lgkmcnt(8)
    ds_read_b64_tr_b16 v[68:69], v18 offset:20480
    ds_read_b64_tr_b16 v[70:71], v18 offset:20992
    ds_read_b128 a[8:11], v12 offset:0
    ds_read_b128 a[152:155], v16 offset:0
    s_waitcnt lgkmcnt(8)
    v_mfma_f32_32x32x16_bf16 v[84:99], v[60:63], a[0:3], v[212:227]
    s_add_u32 m0, s84, 49152
    ds_read_b64_tr_b16 v[72:73], v18 offset:22528
    ds_read_b64_tr_b16 v[74:75], v18 offset:23040
    buffer_load_dwordx4 v2, s[8:11], s63 offen offset:0 lds
    buffer_load_dwordx4 v3, s[8:11], s63 offen offset:1024 lds
    v_mfma_f32_32x32x16_bf16 v[100:115], v[60:63], a[144:147], v[212:227]
    s_waitcnt lgkmcnt(6)
    ds_read_b128 a[12:15], v13 offset:0
    ds_read_b128 a[156:159], v17 offset:0
    buffer_load_dwordx4 v4, s[8:11], s63 offen offset:2048 lds
    buffer_load_dwordx4 v5, s[8:11], s63 offen offset:3072 lds
    v_mfma_f32_32x32x16_bf16 v[84:99], v[64:67], a[4:7], v[84:99]
    s_add_u32 m0, s85, 65536
    s_waitcnt vmcnt(5)
    s_barrier
    ds_read_b64_tr_b16 v[76:77], v18 offset:40960
    ds_read_b64_tr_b16 v[78:79], v18 offset:41472
    buffer_load_dwordx4 v6, s[12:15], s72 offen offset:0 lds
    buffer_load_dwordx4 v7, s[12:15], s72 offen offset:1024 lds
    v_mfma_f32_32x32x16_bf16 v[100:115], v[64:67], a[148:151], v[100:115]
    s_waitcnt lgkmcnt(6)
    s_add_u32 m0, s84, 73728
    ds_read_b128 a[16:19], v10 offset:24576
    ds_read_b128 a[160:163], v14 offset:24576
    buffer_load_dwordx4 v2, s[8:11], s64 offen offset:0 lds
    buffer_load_dwordx4 v3, s[8:11], s64 offen offset:1024 lds
    v_mfma_f32_32x32x16_bf16 v[84:99], v[68:71], a[8:11], v[84:99]
    ds_read_b64_tr_b16 v[80:81], v18 offset:43008
    ds_read_b64_tr_b16 v[82:83], v18 offset:43520
    buffer_load_dwordx4 v4, s[8:11], s64 offen offset:2048 lds
    buffer_load_dwordx4 v5, s[8:11], s64 offen offset:3072 lds
    s_lshr_b32 s22, s59, 1
    s_mul_i32 s22, s22, 320
    s_add_u32 s86, s22, 512
    v_mfma_f32_32x32x16_bf16 v[100:115], v[68:71], a[152:155], v[100:115]
    s_waitcnt lgkmcnt(6)
    s_add_u32 m0, s85, 90112
    ds_read_b128 a[20:23], v11 offset:24576
    ds_read_b128 a[164:167], v15 offset:24576
    buffer_load_dwordx4 v6, s[12:15], s73 offen offset:0 lds
    buffer_load_dwordx4 v7, s[12:15], s73 offen offset:1024 lds
    s_add_u32 s94, s58, 1
    s_mul_i32 s95, s5, 36864
    s_mul_i32 s88, s5, 10240
    v_mfma_f32_32x32x16_bf16 v[84:99], v[72:75], a[12:15], v[84:99]
    s_add_u32 m0, s84, 98304
    ds_read_b64_tr_b16 v[60:61], v18 offset:45056
    ds_read_b64_tr_b16 v[62:63], v18 offset:45568
    buffer_load_dwordx4 v2, s[8:11], s65 offen offset:0 lds
    buffer_load_dwordx4 v3, s[8:11], s65 offen offset:1024 lds
    s_mul_i32 s22, s4, 5120
    s_add_u32 s88, s88, s22
    s_mul_i32 s23, s4, 320
    v_mfma_f32_32x32x16_bf16 v[100:115], v[72:75], a[156:159], v[100:115]
    s_waitcnt lgkmcnt(6)
    ds_read_b128 a[24:27], v12 offset:24576
    ds_read_b128 a[168:171], v16 offset:24576
    buffer_load_dwordx4 v4, s[8:11], s65 offen offset:2048 lds
    buffer_load_dwordx4 v5, s[8:11], s65 offen offset:3072 lds
    v_add_u32 v30, s23, v1
    v_add_u32 v30, 0, v30
    v_mul_u32_u24 v31, 3277, v30
    v_mfma_f32_32x32x16_bf16 v[84:99], v[76:79], a[16:19], v[84:99]
    s_add_u32 m0, s85, 114688
    ds_read_b64_tr_b16 v[64:65], v18 offset:47104
    ds_read_b64_tr_b16 v[66:67], v18 offset:47616
    buffer_load_dwordx4 v6, s[12:15], s74 offen offset:0 lds
    buffer_load_dwordx4 v7, s[12:15], s74 offen offset:1024 lds
    v_lshrrev_b32 v31, 16, v31
    v_mul_u32_u24 v32, 20, v31
    v_sub_u32 v32, v30, v32
    v_mfma_f32_32x32x16_bf16 v[100:115], v[76:79], a[160:163], v[100:115]
    s_waitcnt lgkmcnt(6)
    s_add_u32 m0, s84, 122880
    ds_read_b128 a[28:31], v13 offset:24576
    ds_read_b128 a[172:175], v17 offset:24576
    buffer_load_dwordx4 v2, s[8:11], s66 offen offset:0 lds
    buffer_load_dwordx4 v3, s[8:11], s66 offen offset:1024 lds
    v_bfe_u32 v33, v31, 2, 1
    v_lshlrev_b32 v33, 1, v33
    v_xor_b32 v32, v32, v33
    v_mfma_f32_32x32x16_bf16 v[84:99], v[80:83], a[20:23], v[84:99]
    s_waitcnt vmcnt(14)
    s_barrier
    v_add_u32 v23, 3, v1
    v_lshrrev_b32 v23, v23, v29
    v_and_b32 v23, 1, v23
    v_cmp_eq_u32 vcc, 0, v23
    s_and_b32 s7, vcc_lo, 0xffff
    s_lshl_b32 s7, s7, 3
    s_or_b32 s7, s7, 0x80000000
    v_mov_b32 v243, s7
    buffer_store_dword v243, v245, s[36:39], 0 offen sc1
    ds_read_b64_tr_b16 v[68:69], v19 offset:0
    ds_read_b64_tr_b16 v[70:71], v19 offset:512
    buffer_load_dwordx4 v4, s[8:11], s66 offen offset:2048 lds
    buffer_load_dwordx4 v5, s[8:11], s66 offen offset:3072 lds
    v_lshrrev_b32 v33, 2, v32
    v_and_b32 v32, 3, v32
    v_min_u32 v34, 3, v33
    v_mfma_f32_32x32x16_bf16 v[100:115], v[80:83], a[164:167], v[100:115]
    s_waitcnt lgkmcnt(6)
    s_add_u32 m0, s85, 139264
    ds_read_b128 a[32:35], v10 offset:49152
    ds_read_b128 a[176:179], v14 offset:49152
    buffer_load_dwordx4 v6, s[12:15], s75 offen offset:0 lds
    buffer_load_dwordx4 v7, s[12:15], s75 offen offset:1024 lds
    v_add_u32 v34, s94, v34
    v_and_b32 v34, 3, v34
    v_add_u32 v34, 1, v34
    v_mfma_f32_32x32x16_bf16 v[84:99], v[60:63], a[24:27], v[84:99]
    s_add_u32 m0, s84, 0
    ds_read_b64_tr_b16 v[72:73], v19 offset:2048
    ds_read_b64_tr_b16 v[74:75], v19 offset:2560
    buffer_load_dwordx4 v2, s[8:11], s67 offen offset:0 lds
    v_xor_b32 v33, 3, v33
    v_min_u32 v33, 1, v33
    v_mul_u32_u24 v34, v34, v33
    v_mfma_f32_32x32x16_bf16 v[100:115], v[60:63], a[168:171], v[100:115]
    s_waitcnt lgkmcnt(6)
    ds_read_b128 a[36:39], v11 offset:49152
    ds_read_b128 a[180:183], v15 offset:49152
    buffer_load_dwordx4 v3, s[8:11], s67 offen offset:1024 lds
    v_lshl_add_u32 v32, v34, 2, v32
    v_mul_u32_u24 v31, 1152, v31
    v_lshl_add_u32 v31, v32, 4, v31
    v_mfma_f32_32x32x16_bf16 v[84:99], v[64:67], a[28:31], v[84:99]
    ds_read_b64_tr_b16 v[76:77], v19 offset:4096
    ds_read_b64_tr_b16 v[78:79], v19 offset:4608
    buffer_load_dwordx4 v4, s[8:11], s67 offen offset:2048 lds
    v_add_u32 v31, s95, v31
    v_subrev_u32 v228, 0, v31
    v_add_u32 v30, s23, v1
    v_mfma_f32_32x32x16_bf16 v[100:115], v[64:67], a[172:175], v[100:115]
    s_waitcnt lgkmcnt(6)
    ds_read_b128 a[40:43], v12 offset:49152
    ds_read_b128 a[184:187], v16 offset:49152
    buffer_load_dwordx4 v5, s[8:11], s67 offen offset:3072 lds
    v_add_u32 v30, 64, v30
    v_mul_u32_u24 v31, 3277, v30
    v_lshrrev_b32 v31, 16, v31
    v_mfma_f32_32x32x16_bf16 v[84:99], v[68:71], a[32:35], v[84:99]
    s_add_u32 m0, s85, 16384
    ds_read_b64_tr_b16 v[80:81], v19 offset:6144
    ds_read_b64_tr_b16 v[82:83], v19 offset:6656
    buffer_load_dwordx4 v6, s[12:15], s76 offen offset:0 lds
    buffer_load_dwordx4 v7, s[12:15], s76 offen offset:1024 lds
    v_mul_u32_u24 v32, 20, v31
    v_sub_u32 v32, v30, v32
    v_bfe_u32 v33, v31, 2, 1
    v_mfma_f32_32x32x16_bf16 v[100:115], v[68:71], a[176:179], v[100:115]
    s_waitcnt lgkmcnt(6)
    ds_read_b128 a[44:47], v13 offset:49152
    ds_read_b128 a[188:191], v17 offset:49152
    v_lshlrev_b32 v33, 1, v33
    v_xor_b32 v32, v32, v33
    v_lshrrev_b32 v33, 2, v32
    v_mfma_f32_32x32x16_bf16 v[84:99], v[72:75], a[36:39], v[84:99]
    s_waitcnt vmcnt(19)
    s_barrier
    v_add_u32 v10, 0x10000, v10
    v_add_u32 v11, 0x10000, v11
    v_add_u32 v12, 0x10000, v12
    v_add_u32 v13, 0x10000, v13
    v_add_u32 v14, 0x10000, v14
    v_add_u32 v15, 0x10000, v15
    v_add_u32 v16, 0x10000, v16
    v_add_u32 v17, 0x10000, v17
    ds_read_b64_tr_b16 v[60:61], v19 offset:24576
    ds_read_b64_tr_b16 v[62:63], v19 offset:25088
    v_and_b32 v32, 3, v32
    v_min_u32 v34, 3, v33
    v_add_u32 v34, s94, v34
    v_mfma_f32_32x32x16_bf16 v[100:115], v[72:75], a[180:183], v[100:115]
    s_waitcnt lgkmcnt(6)
    s_add_u32 m0, s84, 24576
    ds_read_b128 a[48:51], v10 offset:8192
    ds_read_b128 a[192:195], v14 offset:8192
    buffer_load_dwordx4 v2, s[8:11], s68 offen offset:0 lds
    v_and_b32 v34, 3, v34
    v_add_u32 v34, 1, v34
    v_xor_b32 v33, 3, v33
    v_mfma_f32_32x32x16_bf16 v[84:99], v[76:79], a[40:43], v[84:99]
    ds_read_b64_tr_b16 v[64:65], v19 offset:26624
    ds_read_b64_tr_b16 v[66:67], v19 offset:27136
    buffer_load_dwordx4 v3, s[8:11], s68 offen offset:1024 lds
    v_min_u32 v33, 1, v33
    v_mul_u32_u24 v34, v34, v33
    v_lshl_add_u32 v32, v34, 2, v32
    v_mfma_f32_32x32x16_bf16 v[100:115], v[76:79], a[184:187], v[100:115]
    s_waitcnt lgkmcnt(6)
    ds_read_b128 a[52:55], v11 offset:8192
    ds_read_b128 a[196:199], v15 offset:8192
    buffer_load_dwordx4 v4, s[8:11], s68 offen offset:2048 lds
    v_mul_u32_u24 v31, 1152, v31
    v_lshl_add_u32 v31, v32, 4, v31
    v_add_u32 v31, s95, v31
    v_mfma_f32_32x32x16_bf16 v[84:99], v[80:83], a[44:47], v[84:99]
    ds_read_b64_tr_b16 v[68:69], v19 offset:28672
    ds_read_b64_tr_b16 v[70:71], v19 offset:29184
    buffer_load_dwordx4 v5, s[8:11], s68 offen offset:3072 lds
    v_subrev_u32 v229, 1024, v31
    v_add_u32 v30, s23, v1
    v_add_u32 v30, 128, v30
    v_mfma_f32_32x32x16_bf16 v[100:115], v[80:83], a[188:191], v[100:115]
    s_waitcnt lgkmcnt(6)
    s_add_u32 m0, s85, 40960
    ds_read_b128 a[56:59], v12 offset:8192
    ds_read_b128 a[200:203], v16 offset:8192
    buffer_load_dwordx4 v6, s[12:15], s77 offen offset:0 lds
    v_mul_u32_u24 v31, 3277, v30
    v_lshrrev_b32 v31, 16, v31
    v_mul_u32_u24 v32, 20, v31
    v_mfma_f32_32x32x16_bf16 v[84:99], v[60:63], a[48:51], v[84:99]
    ds_read_b64_tr_b16 v[72:73], v19 offset:30720
    ds_read_b64_tr_b16 v[74:75], v19 offset:31232
    buffer_load_dwordx4 v7, s[12:15], s77 offen offset:1024 lds
    v_sub_u32 v32, v30, v32
    v_bfe_u32 v33, v31, 2, 1
    v_lshlrev_b32 v33, 1, v33
    v_mfma_f32_32x32x16_bf16 v[100:115], v[60:63], a[192:195], v[100:115]
    s_waitcnt lgkmcnt(6)
    ds_read_b128 a[60:63], v13 offset:8192
    ds_read_b128 a[204:207], v17 offset:8192
    v_xor_b32 v32, v32, v33
    v_lshrrev_b32 v33, 2, v32
    v_and_b32 v32, 3, v32
    v_mfma_f32_32x32x16_bf16 v[84:99], v[64:67], a[52:55], v[84:99]
    s_waitcnt vmcnt(19)
    s_barrier
    ds_read_b64_tr_b16 v[76:77], v19 offset:49152
    ds_read_b64_tr_b16 v[78:79], v19 offset:49664
    v_min_u32 v34, 3, v33
    v_add_u32 v34, s94, v34
    v_and_b32 v34, 3, v34
    v_mfma_f32_32x32x16_bf16 v[100:115], v[64:67], a[196:199], v[100:115]
    s_waitcnt lgkmcnt(6)
    s_add_u32 m0, s84, 49152
    ds_read_b128 a[64:67], v10 offset:32768
    ds_read_b128 a[208:211], v14 offset:32768
    buffer_load_dwordx4 v2, s[8:11], s69 offen offset:0 lds
    v_add_u32 v34, 1, v34
    v_xor_b32 v33, 3, v33
    v_min_u32 v33, 1, v33
    v_mfma_f32_32x32x16_bf16 v[84:99], v[68:71], a[56:59], v[84:99]
    ds_read_b64_tr_b16 v[80:81], v19 offset:51200
    ds_read_b64_tr_b16 v[82:83], v19 offset:51712
    ds_read_b128 v[212:215], v26 offset:256
    buffer_load_dwordx4 v3, s[8:11], s69 offen offset:1024 lds
    v_mul_u32_u24 v34, v34, v33
    v_lshl_add_u32 v32, v34, 2, v32
    v_mul_u32_u24 v31, 1152, v31
    v_mfma_f32_32x32x16_bf16 v[100:115], v[68:71], a[200:203], v[100:115]
    s_waitcnt lgkmcnt(7)
    ds_read_b128 a[68:71], v11 offset:32768
    ds_read_b128 a[212:215], v15 offset:32768
    buffer_load_dwordx4 v4, s[8:11], s69 offen offset:2048 lds
    v_lshl_add_u32 v31, v32, 4, v31
    v_add_u32 v31, s95, v31
    v_subrev_u32 v230, 2048, v31
    v_mfma_f32_32x32x16_bf16 v[84:99], v[72:75], a[60:63], v[84:99]
    ds_read_b64_tr_b16 v[60:61], v19 offset:53248
    ds_read_b64_tr_b16 v[62:63], v19 offset:53760
    ds_read_b128 v[216:219], v26 offset:288
    buffer_load_dwordx4 v5, s[8:11], s69 offen offset:3072 lds
    v_add_u32 v30, s23, v1
    v_add_u32 v30, 192, v30
    v_mul_u32_u24 v31, 3277, v30
    v_mfma_f32_32x32x16_bf16 v[100:115], v[72:75], a[204:207], v[100:115]
    s_waitcnt lgkmcnt(8)
    s_add_u32 m0, s85, 65536
    ds_read_b128 a[72:75], v12 offset:32768
    ds_read_b128 a[216:219], v16 offset:32768
    buffer_load_dwordx4 v6, s[12:15], s78 offen offset:0 lds
    v_lshrrev_b32 v31, 16, v31
    v_mul_u32_u24 v32, 20, v31
    v_sub_u32 v32, v30, v32
    v_mfma_f32_32x32x16_bf16 v[84:99], v[76:79], a[64:67], v[84:99]
    ds_read_b64_tr_b16 v[64:65], v19 offset:55296
    ds_read_b64_tr_b16 v[66:67], v19 offset:55808
    ds_read_b128 v[220:223], v26 offset:320
    buffer_load_dwordx4 v7, s[12:15], s78 offen offset:1024 lds
    v_bfe_u32 v33, v31, 2, 1
    v_lshlrev_b32 v33, 1, v33
    v_xor_b32 v32, v32, v33
    v_mfma_f32_32x32x16_bf16 v[100:115], v[76:79], a[208:211], v[100:115]
    s_waitcnt lgkmcnt(8)
    ds_read_b128 a[76:79], v13 offset:32768
    ds_read_b128 a[220:223], v17 offset:32768
    v_lshrrev_b32 v33, 2, v32
    v_and_b32 v32, 3, v32
    v_min_u32 v34, 3, v33
    v_mfma_f32_32x32x16_bf16 v[84:99], v[80:83], a[68:71], v[84:99]
    s_waitcnt vmcnt(18)
    s_barrier
    ds_read_b64_tr_b16 v[68:69], v20 offset:8192
    ds_read_b64_tr_b16 v[70:71], v20 offset:8704
    ds_read_b128 v[224:227], v26 offset:352
    v_add_u32 v34, s94, v34
    v_and_b32 v34, 3, v34
    v_add_u32 v34, 1, v34
    v_mfma_f32_32x32x16_bf16 v[100:115], v[80:83], a[212:215], v[100:115]
    s_waitcnt lgkmcnt(8)
    v_add_u32 v6, 0x80, v6
    v_add_u32 v7, 0x80, v7
    s_add_u32 m0, s85, 73728
    ds_read_b128 a[80:83], v10 offset:57344
    ds_read_b128 a[224:227], v14 offset:57344
    buffer_load_dwordx4 v6, s[12:15], s70 offen offset:0 lds
    v_xor_b32 v33, 3, v33
    v_min_u32 v33, 1, v33
    v_mul_u32_u24 v34, v34, v33
    v_mfma_f32_32x32x16_bf16 v[84:99], v[60:63], a[72:75], v[84:99]
    ds_read_b64_tr_b16 v[72:73], v20 offset:10240
    ds_read_b64_tr_b16 v[74:75], v20 offset:10752
    v_lshl_add_u32 v32, v34, 2, v32
    v_mul_u32_u24 v31, 1152, v31
    v_lshl_add_u32 v31, v32, 4, v31
    v_mfma_f32_32x32x16_bf16 v[100:115], v[60:63], a[216:219], v[100:115]
    s_waitcnt lgkmcnt(7)
    ds_read_b128 a[84:87], v11 offset:57344
    ds_read_b128 a[228:231], v15 offset:57344
    buffer_load_dwordx4 v7, s[12:15], s70 offen offset:1024 lds
    v_add_u32 v31, s95, v31
    v_subrev_u32 v231, 3072, v31
    v_add_u32 v30, s23, v1
    v_mfma_f32_32x32x16_bf16 v[84:99], v[64:67], a[76:79], v[84:99]
    ds_read_b64_tr_b16 v[76:77], v20 offset:12288
    ds_read_b64_tr_b16 v[78:79], v20 offset:12800
    v_add_u32 v30, 256, v30
    v_mul_u32_u24 v31, 3277, v30
    v_lshrrev_b32 v31, 16, v31
    v_mfma_f32_32x32x16_bf16 v[100:115], v[64:67], a[220:223], v[100:115]
    s_waitcnt lgkmcnt(6)
    s_add_u32 m0, s85, 81920
    ds_read_b128 a[88:91], v12 offset:57344
    ds_read_b128 a[232:235], v16 offset:57344
    buffer_load_dwordx4 v6, s[12:15], s71 offen offset:0 lds
    v_mul_u32_u24 v32, 20, v31
    v_sub_u32 v32, v30, v32
    v_bfe_u32 v33, v31, 2, 1
    v_mfma_f32_32x32x16_bf16 v[84:99], v[68:71], a[80:83], v[84:99]
    ds_read_b64_tr_b16 v[80:81], v20 offset:14336
    ds_read_b64_tr_b16 v[82:83], v20 offset:14848
    buffer_load_dwordx4 v7, s[12:15], s71 offen offset:1024 lds
    v_lshlrev_b32 v33, 1, v33
    v_xor_b32 v32, v32, v33
    v_lshrrev_b32 v33, 2, v32
    v_mfma_f32_32x32x16_bf16 v[100:115], v[68:71], a[224:227], v[100:115]
    s_waitcnt lgkmcnt(6)
    s_add_u32 m0, s85, 90112
    ds_read_b128 a[92:95], v13 offset:57344
    ds_read_b128 a[236:239], v17 offset:57344
    buffer_load_dwordx4 v6, s[12:15], s72 offen offset:0 lds
    buffer_load_dwordx4 v7, s[12:15], s72 offen offset:1024 lds
    v_and_b32 v32, 3, v32
    v_min_u32 v34, 3, v33
    v_add_u32 v34, s94, v34
    v_mfma_f32_32x32x16_bf16 v[84:99], v[72:75], a[84:87], v[84:99]
    s_waitcnt vmcnt(18)
    s_barrier
    v_add_u32 v10, 0xffff0000, v10
    v_add_u32 v11, 0xffff0000, v11
    v_add_u32 v12, 0xffff0000, v12
    v_add_u32 v13, 0xffff0000, v13
    v_add_u32 v14, 0xffff0000, v14
    v_add_u32 v15, 0xffff0000, v15
    v_add_u32 v16, 0xffff0000, v16
    v_add_u32 v17, 0xffff0000, v17
    ds_read_b64_tr_b16 v[60:61], v18 offset:16384
    ds_read_b64_tr_b16 v[62:63], v18 offset:16896
    v_and_b32 v34, 3, v34
    v_add_u32 v34, 1, v34
    v_xor_b32 v33, 3, v33
    v_mfma_f32_32x32x16_bf16 v[100:115], v[72:75], a[228:231], v[100:115]
    s_waitcnt lgkmcnt(6)
    ds_read_b128 a[96:99], v10 offset:0
    ds_read_b128 a[240:243], v14 offset:0
    buffer_load_dword v29, v244, s[36:39], 0 offen sc1
    v_min_u32 v33, 1, v33
    v_mul_u32_u24 v34, v34, v33
    v_lshl_add_u32 v32, v34, 2, v32
    v_mfma_f32_32x32x16_bf16 v[84:99], v[76:79], a[88:91], v[84:99]
    ds_read_b64_tr_b16 v[64:65], v18 offset:18432
    ds_read_b64_tr_b16 v[66:67], v18 offset:18944
    v_mul_u32_u24 v31, 1152, v31
    v_lshl_add_u32 v31, v32, 4, v31
    v_add_u32 v31, s95, v31
    v_mfma_f32_32x32x16_bf16 v[100:115], v[76:79], a[232:235], v[100:115]
    s_waitcnt lgkmcnt(6)
    s_add_u32 m0, s85, 98304
    ds_read_b128 a[100:103], v11 offset:0
    ds_read_b128 a[244:247], v15 offset:0
    buffer_load_dwordx4 v6, s[12:15], s73 offen offset:0 lds
    v_subrev_u32 v232, 0, v31
    s_lshl_b32 s22, s56, 11
    v_lshl_add_u32 v239, v1, 4, s22
    v_mfma_f32_32x32x16_bf16 v[84:99], v[80:83], a[92:95], v[84:99]
    ds_read_b64_tr_b16 v[68:69], v18 offset:20480
    ds_read_b64_tr_b16 v[70:71], v18 offset:20992
    v_add_u32 v240, 0x2000, v239
    v_lshlrev_b32 v8, 4, v1
    s_mul_i32 s83, s58, 1327104
    v_mfma_f32_32x32x16_bf16 v[100:115], v[80:83], a[236:239], v[100:115]
    s_waitcnt lgkmcnt(6)
    ds_read_b128 a[104:107], v12 offset:0
    ds_read_b128 a[248:251], v16 offset:0
    buffer_load_dwordx4 v7, s[12:15], s73 offen offset:1024 lds
    s_add_u32 s83, s83, s86
    s_add_u32 s22, s59, 0
    s_and_b32 s22, s22, 3
    v_mfma_f32_32x32x16_bf16 v[84:99], v[60:63], a[96:99], v[84:99]
    ds_read_b64_tr_b16 v[72:73], v18 offset:22528
    ds_read_b64_tr_b16 v[74:75], v18 offset:23040
    s_and_b32 s23, s22, 1
    s_mul_i32 s22, s22, 9
    s_add_u32 s22, s22, s23
    v_mfma_f32_32x32x16_bf16 v[100:115], v[60:63], a[240:243], v[100:115]
    s_waitcnt lgkmcnt(6)
    s_add_u32 m0, s85, 106496
    ds_read_b128 a[108:111], v13 offset:0
    ds_read_b128 a[252:255], v17 offset:0
    buffer_load_dwordx4 v6, s[12:15], s74 offen offset:0 lds
    s_mul_i32 s50, s22, 36864
    s_lshl_b32 s79, s22, 13
    s_add_u32 s50, s50, s83
    v_mfma_f32_32x32x16_bf16 v[84:99], v[64:67], a[100:103], v[84:99]
    s_waitcnt vmcnt(16)
    s_barrier
    ds_read_b64_tr_b16 v[76:77], v18 offset:40960
    ds_read_b64_tr_b16 v[78:79], v18 offset:41472
    s_add_u32 s79, s79, s87
    s_add_u32 s22, s59, 1
    s_and_b32 s22, s22, 3
    v_mfma_f32_32x32x16_bf16 v[100:115], v[64:67], a[244:247], v[100:115]
    s_waitcnt lgkmcnt(6)
    ds_read_b128 a[112:115], v10 offset:24576
    ds_read_b128 v[148:151], v14 offset:24576
    buffer_load_dwordx4 v7, s[12:15], s74 offen offset:1024 lds
    s_and_b32 s23, s22, 1
    s_mul_i32 s22, s22, 9
    s_add_u32 s22, s22, s23
    v_mfma_f32_32x32x16_bf16 v[84:99], v[68:71], a[104:107], v[84:99]
    ds_read_b64_tr_b16 v[80:81], v18 offset:43008
    ds_read_b64_tr_b16 v[82:83], v18 offset:43520
    s_mul_i32 s51, s22, 36864
    s_lshl_b32 s80, s22, 13
    s_add_u32 s51, s51, s83
    v_mfma_f32_32x32x16_bf16 v[100:115], v[68:71], a[248:251], v[100:115]
    s_waitcnt lgkmcnt(6)
    s_add_u32 m0, s85, 114688
    ds_read_b128 a[116:119], v11 offset:24576
    ds_read_b128 v[152:155], v15 offset:24576
    buffer_load_dwordx4 v6, s[12:15], s75 offen offset:0 lds
    s_add_u32 s80, s80, s87
    s_add_u32 s22, s59, 2
    s_and_b32 s22, s22, 3
    v_mfma_f32_32x32x16_bf16 v[84:99], v[72:75], a[108:111], v[84:99]
    ds_read_b64_tr_b16 v[60:61], v18 offset:45056
    ds_read_b64_tr_b16 v[62:63], v18 offset:45568
    s_and_b32 s23, s22, 1
    s_mul_i32 s22, s22, 9
    s_add_u32 s22, s22, s23
    v_mfma_f32_32x32x16_bf16 v[100:115], v[72:75], a[252:255], v[100:115]
    s_waitcnt lgkmcnt(6)
    ds_read_b128 a[120:123], v12 offset:24576
    ds_read_b128 v[156:159], v16 offset:24576
    buffer_load_dwordx4 v7, s[12:15], s75 offen offset:1024 lds
    s_mul_i32 s52, s22, 36864
    s_lshl_b32 s81, s22, 13
    s_add_u32 s52, s52, s83
    v_mfma_f32_32x32x16_bf16 v[84:99], v[76:79], a[112:115], v[84:99]
    ds_read_b64_tr_b16 v[64:65], v18 offset:47104
    ds_read_b64_tr_b16 v[66:67], v18 offset:47616
    s_add_u32 s81, s81, s87
    s_add_u32 s22, s59, 3
    s_and_b32 s22, s22, 3
    v_mfma_f32_32x32x16_bf16 v[100:115], v[76:79], v[148:151], v[100:115]
    s_waitcnt lgkmcnt(6)
    s_add_u32 m0, s85, 122880
    ds_read_b128 a[124:127], v13 offset:24576
    ds_read_b128 v[160:163], v17 offset:24576
    buffer_load_dwordx4 v6, s[12:15], s76 offen offset:0 lds
    s_and_b32 s23, s22, 1
    s_mul_i32 s22, s22, 9
    s_add_u32 s22, s22, s23
    v_mfma_f32_32x32x16_bf16 v[84:99], v[80:83], a[116:119], v[84:99]
    s_waitcnt vmcnt(14)
    s_barrier
    s_waitcnt vmcnt(7)
    v_readfirstlane_b32 s60, v29
    s_nop 0
    s_cmp_eq_u32 s60, 0
    s_cbranch_scc1 L_spinoN
L_backoN:
    ds_read_b64_tr_b16 v[68:69], v19 offset:0
    ds_read_b64_tr_b16 v[70:71], v19 offset:512
    s_mul_i32 s53, s22, 36864
    s_lshl_b32 s82, s22, 13
    s_add_u32 s53, s53, s83
    v_mfma_f32_32x32x16_bf16 v[100:115], v[80:83], v[152:155], v[100:115]
    s_waitcnt lgkmcnt(6)
    ds_read_b128 a[128:131], v10 offset:49152
    ds_read_b128 v[164:167], v14 offset:49152
    s_add_u32 s82, s82, s87
    v_lshrrev_b32 v37, 4, v1
    v_lshlrev_b32 v37, 3, v37
    v_mfma_f32_32x32x16_bf16 v[84:99], v[60:63], a[120:123], v[84:99]
    ds_read_b64_tr_b16 v[72:73], v19 offset:2048
    ds_read_b64_tr_b16 v[74:75], v19 offset:2560
    buffer_load_dwordx4 v7, s[12:15], s76 offen offset:1024 lds
    s_add_u32 s22, s58, 4
    s_and_b32 s22, s22, 3
    s_add_u32 s22, s22, 1
    v_mfma_f32_32x32x16_bf16 v[100:115], v[60:63], v[156:159], v[100:115]
    s_waitcnt lgkmcnt(6)
    ds_read_b128 a[132:135], v11 offset:49152
    ds_read_b128 v[168:171], v15 offset:49152
    s_lshl_b32 s22, s22, 6
    s_add_u32 s22, s22, s86
    buffer_load_dwordx2 v[246:247], v37, s[32:35], s22 offen offset:0
    v_mfma_f32_32x32x16_bf16 v[84:99], v[64:67], a[124:127], v[84:99]
    s_add_u32 m0, s85, 131072
    ds_read_b64_tr_b16 v[76:77], v19 offset:4096
    ds_read_b64_tr_b16 v[78:79], v19 offset:4608
    buffer_load_dwordx4 v6, s[12:15], s77 offen offset:0 lds
    buffer_load_dwordx2 v[248:249], v37, s[32:35], s22 offen offset:32
    s_mov_b32 s22, 0
    s_lshl_b32 s22, s22, 6
    v_mfma_f32_32x32x16_bf16 v[100:115], v[64:67], v[160:163], v[100:115]
    s_waitcnt lgkmcnt(6)
    ds_read_b128 a[136:139], v12 offset:49152
    ds_read_b128 v[172:175], v16 offset:49152
    s_add_u32 s22, s22, s86
    buffer_load_dwordx2 v[250:251], v37, s[32:35], s22 offen offset:0
    buffer_load_dwordx2 v[252:253], v37, s[32:35], s22 offen offset:32
    v_mfma_f32_32x32x16_bf16 v[84:99], v[68:71], a[128:131], v[84:99]
    ds_read_b64_tr_b16 v[80:81], v19 offset:6144
    ds_read_b64_tr_b16 v[82:83], v19 offset:6656
    buffer_load_dwordx4 v7, s[12:15], s77 offen offset:1024 lds
    v_bfe_u32 v30, v1, 5, 1
    v_lshlrev_b32 v30, 4, v30
    v_bfe_u32 v31, v1, 4, 1
    v_mfma_f32_32x32x16_bf16 v[100:115], v[68:71], v[164:167], v[100:115]
    s_waitcnt lgkmcnt(6)
    ds_read_b128 a[140:143], v13 offset:49152
    ds_read_b128 v[176:179], v17 offset:49152
    v_lshl_add_u32 v30, v31, 2, v30
    v_bfe_u32 v32, v1, 2, 2
    v_add_u32 v30, v30, v32
    v_mfma_f32_32x32x16_bf16 v[84:99], v[72:75], a[132:135], v[84:99]
    s_add_u32 m0, s85, 139264
    s_barrier
    ds_read_b64_tr_b16 v[60:61], v19 offset:8192
    buffer_load_dwordx4 v6, s[12:15], s78 offen offset:0 lds
    v_mul_u32_u24 v30, 320, v30
    v_and_b32 v32, 3, v1
    v_lshl_add_u32 v30, v32, 3, v30
    v_mfma_f32_32x32x16_bf16 v[100:115], v[72:75], v[168:171], v[100:115]
    s_waitcnt lgkmcnt(5)
    ds_read_b64_tr_b16 v[62:63], v19 offset:8704
    v_lshlrev_b32 v31, 5, v31
    v_add_u32 v233, v30, v31
    v_sub_u32 v236, v30, v31
    v_mfma_f32_32x32x16_bf16 v[84:99], v[76:79], a[136:139], v[84:99]
    ds_read_b64_tr_b16 v[64:65], v19 offset:10240
    buffer_load_dwordx4 v7, s[12:15], s78 offen offset:1024 lds
    v_add_u32 v34, 0x10000, v239
    v_add_u32 v35, 0x20000, v239
    s_lshl_b32 s47, s4, 13
    v_mfma_f32_32x32x16_bf16 v[100:115], v[76:79], v[172:175], v[100:115]
    s_waitcnt lgkmcnt(3)
    ds_read_b64_tr_b16 v[66:67], v19 offset:10752
    v_add_u32 v234, 0x10000, v233
    v_add_u32 v235, 0x20000, v233
    v_add_u32 v237, 0x10000, v236
    v_mfma_f32_32x32x16_bf16 v[84:99], v[80:83], a[140:143], v[84:99]
    v_add_u32 v6, 0x80, v6
    v_add_u32 v7, 0x80, v7
    s_add_u32 m0, s85, 0
    ds_read_b64_tr_b16 v[68:69], v19 offset:12288
    buffer_load_dwordx4 v6, s[12:15], s70 offen offset:0 lds
    v_add_u32 v238, 0x20000, v236
    v_mfma_f32_32x32x16_bf16 v[100:115], v[80:83], v[176:179], v[100:115]
    s_waitcnt lgkmcnt(3)
    ds_read_b64_tr_b16 v[70:71], v19 offset:12800
    v_mfma_f32_32x32x16_bf16 v[180:195], v[60:63], a[0:3], v[212:227]
    ds_read_b64_tr_b16 v[72:73], v19 offset:14336
    ds_read_b64_tr_b16 v[74:75], v19 offset:14848
    buffer_load_dwordx4 v7, s[12:15], s70 offen offset:1024 lds
    v_mfma_f32_32x32x16_bf16 v[196:211], v[60:63], a[144:147], v[212:227]
    s_waitcnt lgkmcnt(4)
    ds_read_b64_tr_b16 v[76:77], v19 offset:16384
    ds_read_b64_tr_b16 v[78:79], v19 offset:16896
    v_mfma_f32_32x32x16_bf16 v[180:195], v[64:67], a[4:7], v[180:195]
    s_add_u32 m0, s85, 8192
    ds_read_b64_tr_b16 v[80:81], v19 offset:18432
    buffer_load_dwordx4 v6, s[12:15], s71 offen offset:0 lds
    v_mfma_f32_32x32x16_bf16 v[196:211], v[64:67], a[148:151], v[196:211]
    s_waitcnt lgkmcnt(5)
    ds_read_b64_tr_b16 v[82:83], v19 offset:18944
    v_mfma_f32_32x32x16_bf16 v[180:195], v[68:71], a[8:11], v[180:195]
    ds_read_b64_tr_b16 v[60:61], v19 offset:20480
    buffer_load_dwordx4 v7, s[12:15], s71 offen offset:1024 lds
    v_mul_f32 v38, v84, v84
    v_mul_f32 v39, v85, v85
    v_fmaak_f32 v38, v38, v28, 0xc0135761
    v_mfma_f32_32x32x16_bf16 v[196:211], v[68:71], a[152:155], v[196:211]
    s_waitcnt lgkmcnt(5)
    ds_read_b64_tr_b16 v[62:63], v19 offset:20992
    v_fmaak_f32 v39, v39, v28, 0xc0135761
    v_mul_f32 v38, v38, v84
    v_mul_f32 v39, v39, v85
    v_exp_f32 v38, v38
    v_mfma_f32_32x32x16_bf16 v[180:195], v[72:75], a[12:15], v[180:195]
    s_add_u32 m0, s85, 16384
    ds_read_b64_tr_b16 v[64:65], v19 offset:22528
    buffer_load_dwordx4 v6, s[12:15], s72 offen offset:0 lds
    v_mul_f32 v40, v86, v86
    v_mul_f32 v41, v87, v87
    v_add_f32 v38, 1.0, v38
    v_mfma_f32_32x32x16_bf16 v[196:211], v[72:75], a[156:159], v[196:211]
    s_waitcnt lgkmcnt(5)
    ds_read_b64_tr_b16 v[66:67], v19 offset:23040
    v_exp_f32 v39, v39
    v_fmaak_f32 v40, v40, v28, 0xc0135761
    v_fmaak_f32 v41, v41, v28, 0xc0135761
    v_add_f32 v39, 1.0, v39
    v_mfma_f32_32x32x16_bf16 v[180:195], v[76:79], a[16:19], v[180:195]
    ds_read_b64_tr_b16 v[68:69], v19 offset:24576
    buffer_load_dwordx4 v7, s[12:15], s72 offen offset:1024 lds
    v_rcp_f32 v38, v38
    v_mul_f32 v40, v40, v86
    v_mul_f32 v41, v41, v87
    v_mfma_f32_32x32x16_bf16 v[196:211], v[76:79], a[160:163], v[196:211]
    s_waitcnt lgkmcnt(5)
    ds_read_b64_tr_b16 v[70:71], v19 offset:25088
    v_mul_f32 v38, v38, v84
    v_rcp_f32 v39, v39
    v_nop
    v_mul_f32 v39, v39, v85
    v_mfma_f32_32x32x16_bf16 v[180:195], v[80:83], a[20:23], v[180:195]
    ds_read_b64_tr_b16 v[72:73], v19 offset:26624
    v_exp_f32 v40, v40
    v_mul_f32 v42, v88, v88
    v_mul_f32 v43, v89, v89
    v_add_f32 v40, 1.0, v40
    v_mfma_f32_32x32x16_bf16 v[196:211], v[80:83], a[164:167], v[196:211]
    s_waitcnt lgkmcnt(5)
    ds_read_b64_tr_b16 v[74:75], v19 offset:27136
    v_exp_f32 v41, v41
    v_fmaak_f32 v42, v42, v28, 0xc0135761
    v_fmaak_f32 v43, v43, v28, 0xc0135761
    v_add_f32 v41, 1.0, v41
    v_mfma_f32_32x32x16_bf16 v[180:195], v[60:63], a[24:27], v[180:195]
    s_mov_b32 s20, 41472
    ds_read_b64_tr_b16 v[76:77], v19 offset:28672
    buffer_load_dword v254, v21, s[24:27], s20 offen
    v_rcp_f32 v40, v40
    v_mul_f32 v42, v42, v88
    v_mul_f32 v43, v43, v89
    v_mfma_f32_32x32x16_bf16 v[196:211], v[60:63], a[168:171], v[196:211]
    s_waitcnt lgkmcnt(5)
    ds_read_b64_tr_b16 v[78:79], v19 offset:29184
    v_mul_f32 v40, v40, v86
    v_rcp_f32 v41, v41
    v_cvt_pk_bf16_f32 v44, v38, v39
    v_mul_f32 v41, v41, v87
    v_mfma_f32_32x32x16_bf16 v[180:195], v[64:67], a[28:31], v[180:195]
    ds_read_b64_tr_b16 v[80:81], v19 offset:30720
    v_exp_f32 v42, v42
    v_mul_f32 v38, v90, v90
    v_mul_f32 v39, v91, v91
    v_add_f32 v42, 1.0, v42
    v_mfma_f32_32x32x16_bf16 v[196:211], v[64:67], a[172:175], v[196:211]
    s_waitcnt lgkmcnt(5)
    ds_read_b64_tr_b16 v[82:83], v19 offset:31232
    v_exp_f32 v43, v43
    v_fmaak_f32 v38, v38, v28, 0xc0135761
    v_fmaak_f32 v39, v39, v28, 0xc0135761
    v_add_f32 v43, 1.0, v43
    v_mfma_f32_32x32x16_bf16 v[180:195], v[68:71], a[32:35], v[180:195]
    s_waitcnt vmcnt(17)
    s_barrier
    ds_read_b64_tr_b16 v[60:61], v19 offset:32768
    v_rcp_f32 v42, v42
    v_mul_f32 v38, v38, v90
    v_mfma_f32_32x32x16_bf16 v[196:211], v[68:71], a[176:179], v[196:211]
    s_waitcnt lgkmcnt(5)
    ds_read_b64_tr_b16 v[62:63], v19 offset:33280
    v_mul_f32 v39, v39, v91
    v_mul_f32 v42, v42, v88
    v_rcp_f32 v43, v43
    v_cvt_pk_bf16_f32 v45, v40, v41
    v_mfma_f32_32x32x16_bf16 v[180:195], v[72:75], a[36:39], v[180:195]
    s_mov_b32 s20, 55296
    ds_read_b64_tr_b16 v[64:65], v19 offset:34816
    buffer_load_dword v254, v21, s[24:27], s20 offen
    v_mul_f32 v43, v43, v89
    v_exp_f32 v38, v38
    v_mul_f32 v40, v92, v92
    v_mfma_f32_32x32x16_bf16 v[196:211], v[72:75], a[180:183], v[196:211]
    s_waitcnt lgkmcnt(5)
    ds_read_b64_tr_b16 v[66:67], v19 offset:35328
    v_mul_f32 v41, v93, v93
    v_add_f32 v38, 1.0, v38
    v_exp_f32 v39, v39
    v_fmaak_f32 v40, v40, v28, 0xc0135761
    v_mfma_f32_32x32x16_bf16 v[180:195], v[76:79], a[40:43], v[180:195]
    s_add_u32 m0, s85, 24576
    ds_read_b64_tr_b16 v[68:69], v19 offset:36864
    buffer_load_dwordx4 v6, s[12:15], s73 offen offset:0 lds
    v_fmaak_f32 v41, v41, v28, 0xc0135761
    v_add_f32 v39, 1.0, v39
    v_rcp_f32 v38, v38
    v_mfma_f32_32x32x16_bf16 v[196:211], v[76:79], a[184:187], v[196:211]
    s_waitcnt lgkmcnt(5)
    ds_read_b64_tr_b16 v[70:71], v19 offset:37376
    v_mul_f32 v40, v40, v92
    v_mul_f32 v41, v41, v93
    v_mul_f32 v38, v38, v90
    v_rcp_f32 v39, v39
    v_mfma_f32_32x32x16_bf16 v[180:195], v[80:83], a[44:47], v[180:195]
    ds_read_b64_tr_b16 v[72:73], v19 offset:38912
    v_cvt_pk_bf16_f32 v46, v42, v43
    v_mul_f32 v39, v39, v91
    v_exp_f32 v40, v40
    v_mul_f32 v42, v94, v94
    v_mfma_f32_32x32x16_bf16 v[196:211], v[80:83], a[188:191], v[196:211]
    s_waitcnt lgkmcnt(5)
    ds_read_b64_tr_b16 v[74:75], v19 offset:39424
    v_mul_f32 v43, v95, v95
    v_add_f32 v40, 1.0, v40
    v_exp_f32 v41, v41
    v_fmaak_f32 v42, v42, v28, 0xc0135761
    v_mfma_f32_32x32x16_bf16 v[180:195], v[60:63], a[48:51], v[180:195]
    ds_read_b64_tr_b16 v[76:77], v19 offset:40960
    v_fmaak_f32 v43, v43, v28, 0xc0135761
    v_add_f32 v41, 1.0, v41
    v_rcp_f32 v40, v40
    v_mul_f32 v42, v42, v94
    v_mfma_f32_32x32x16_bf16 v[196:211], v[60:63], a[192:195], v[196:211]
    s_waitcnt lgkmcnt(5)
    ds_read_b64_tr_b16 v[78:79], v19 offset:41472
    v_mul_f32 v43, v43, v95
    v_mul_f32 v40, v40, v92
    v_rcp_f32 v41, v41
    v_cvt_pk_bf16_f32 v47, v38, v39
    v_mfma_f32_32x32x16_bf16 v[180:195], v[64:67], a[52:55], v[180:195]
    ds_read_b64_tr_b16 v[80:81], v19 offset:43008
    v_mul_f32 v41, v41, v93
    v_exp_f32 v42, v42
    v_mul_f32 v38, v96, v96
    v_mul_f32 v39, v97, v97
    v_mfma_f32_32x32x16_bf16 v[196:211], v[64:67], a[196:199], v[196:211]
    s_waitcnt lgkmcnt(5)
    ds_read_b64_tr_b16 v[82:83], v19 offset:43520
    v_add_f32 v42, 1.0, v42
    v_exp_f32 v43, v43
    v_fmaak_f32 v38, v38, v28, 0xc0135761
    v_fmaak_f32 v39, v39, v28, 0xc0135761
    v_mfma_f32_32x32x16_bf16 v[180:195], v[68:71], a[56:59], v[180:195]
    ds_read_b64_tr_b16 v[60:61], v19 offset:45056
    ds_read_b128 v[212:215], v26 offset:512
    v_add_f32 v43, 1.0, v43
    v_rcp_f32 v42, v42
    v_mul_f32 v38, v38, v96
    v_mfma_f32_32x32x16_bf16 v[196:211], v[68:71], a[200:203], v[196:211]
    s_waitcnt lgkmcnt(6)
    ds_read_b64_tr_b16 v[62:63], v19 offset:45568
    v_mul_f32 v39, v39, v97
    v_mul_f32 v42, v42, v94
    v_rcp_f32 v43, v43
    v_cvt_pk_bf16_f32 v48, v40, v41
    v_mfma_f32_32x32x16_bf16 v[180:195], v[72:75], a[60:63], v[180:195]
    ds_read_b64_tr_b16 v[64:65], v19 offset:47104
    ds_read_b128 v[216:219], v26 offset:544
    v_mul_f32 v43, v43, v95
    v_exp_f32 v38, v38
    v_mul_f32 v40, v98, v98
    v_mfma_f32_32x32x16_bf16 v[196:211], v[72:75], a[204:207], v[196:211]
    s_waitcnt lgkmcnt(7)
    ds_read_b64_tr_b16 v[66:67], v19 offset:47616
    v_mul_f32 v41, v99, v99
    v_add_f32 v38, 1.0, v38
    v_exp_f32 v39, v39
    v_fmaak_f32 v40, v40, v28, 0xc0135761
    v_mfma_f32_32x32x16_bf16 v[180:195], v[76:79], a[64:67], v[180:195]
    ds_read_b64_tr_b16 v[68:69], v19 offset:49152
    ds_read_b128 v[220:223], v26 offset:576
    v_fmaak_f32 v41, v41, v28, 0xc0135761
    v_add_f32 v39, 1.0, v39
    v_rcp_f32 v38, v38
    v_mfma_f32_32x32x16_bf16 v[196:211], v[76:79], a[208:211], v[196:211]
    s_waitcnt lgkmcnt(8)
    ds_read_b64_tr_b16 v[70:71], v19 offset:49664
    v_mul_f32 v40, v40, v98
    v_mul_f32 v41, v41, v99
    v_mul_f32 v38, v38, v96
    v_rcp_f32 v39, v39
    v_mfma_f32_32x32x16_bf16 v[180:195], v[80:83], a[68:71], v[180:195]
    ds_read_b64_tr_b16 v[72:73], v19 offset:51200
    ds_read_b128 v[224:227], v26 offset:608
    v_cvt_pk_bf16_f32 v49, v42, v43
    v_mul_f32 v39, v39, v97
    v_exp_f32 v40, v40
    v_mfma_f32_32x32x16_bf16 v[196:211], v[80:83], a[212:215], v[196:211]
    s_waitcnt lgkmcnt(8)
    ds_read_b64_tr_b16 v[74:75], v19 offset:51712
    v_mul_f32 v42, v100, v100
    v_mul_f32 v43, v101, v101
    v_add_f32 v40, 1.0, v40
    v_exp_f32 v41, v41
    v_mfma_f32_32x32x16_bf16 v[180:195], v[60:63], a[72:75], v[180:195]
    ds_read_b64_tr_b16 v[76:77], v19 offset:53248
    v_fmaak_f32 v42, v42, v28, 0xc0135761
    v_fmaak_f32 v43, v43, v28, 0xc0135761
    v_add_f32 v41, 1.0, v41
    v_rcp_f32 v40, v40
    v_mfma_f32_32x32x16_bf16 v[196:211], v[60:63], a[216:219], v[196:211]
    s_waitcnt lgkmcnt(7)
    ds_read_b64_tr_b16 v[78:79], v19 offset:53760
    v_mul_f32 v42, v42, v100
    v_mul_f32 v43, v43, v101
    v_mul_f32 v40, v40, v98
    v_rcp_f32 v41, v41
    v_mfma_f32_32x32x16_bf16 v[180:195], v[64:67], a[76:79], v[180:195]
    ds_read_b64_tr_b16 v[80:81], v19 offset:55296
    v_cvt_pk_bf16_f32 v50, v38, v39
    v_mul_f32 v41, v41, v99
    v_exp_f32 v42, v42
    v_mul_f32 v38, v102, v102
    v_mfma_f32_32x32x16_bf16 v[196:211], v[64:67], a[220:223], v[196:211]
    s_waitcnt lgkmcnt(6)
    ds_read_b64_tr_b16 v[82:83], v19 offset:55808
    v_mul_f32 v39, v103, v103
    v_add_f32 v42, 1.0, v42
    v_exp_f32 v43, v43
    v_fmaak_f32 v38, v38, v28, 0xc0135761
    v_mfma_f32_32x32x16_bf16 v[180:195], v[68:71], a[80:83], v[180:195]
    s_waitcnt vmcnt(9)
    s_barrier
    ds_read_b64_tr_b16 v[60:61], v19 offset:57344
    v_fmaak_f32 v39, v39, v28, 0xc0135761
    v_add_f32 v43, 1.0, v43
    v_mfma_f32_32x32x16_bf16 v[196:211], v[68:71], a[224:227], v[196:211]
    s_waitcnt lgkmcnt(5)
    ds_read_b64_tr_b16 v[62:63], v19 offset:57856
    v_rcp_f32 v42, v42
    v_mul_f32 v38, v38, v102
    v_mul_f32 v39, v39, v103
    v_mul_f32 v42, v42, v100
    v_mfma_f32_32x32x16_bf16 v[180:195], v[72:75], a[84:87], v[180:195]
    ds_read_b64_tr_b16 v[64:65], v19 offset:59392
    v_rcp_f32 v43, v43
    v_cvt_pk_bf16_f32 v51, v40, v41
    v_mul_f32 v43, v43, v101
    v_mfma_f32_32x32x16_bf16 v[196:211], v[72:75], a[228:231], v[196:211]
    s_waitcnt lgkmcnt(5)
    ds_read_b64_tr_b16 v[66:67], v19 offset:59904
    v_exp_f32 v38, v38
    v_mul_f32 v40, v104, v104
    v_mul_f32 v41, v105, v105
    v_add_f32 v38, 1.0, v38
    v_mfma_f32_32x32x16_bf16 v[180:195], v[76:79], a[88:91], v[180:195]
    ds_read_b64_tr_b16 v[68:69], v19 offset:61440
    v_exp_f32 v39, v39
    v_fmaak_f32 v40, v40, v28, 0xc0135761
    v_fmaak_f32 v41, v41, v28, 0xc0135761
    v_add_f32 v39, 1.0, v39
    v_mfma_f32_32x32x16_bf16 v[196:211], v[76:79], a[232:235], v[196:211]
    s_waitcnt lgkmcnt(5)
    ds_read_b64_tr_b16 v[70:71], v19 offset:61952
    v_rcp_f32 v38, v38
    v_mul_f32 v40, v40, v104
    v_mul_f32 v41, v41, v105
    v_mul_f32 v38, v38, v102
    v_mfma_f32_32x32x16_bf16 v[180:195], v[80:83], a[92:95], v[180:195]
    ds_read_b64_tr_b16 v[72:73], v19 offset:63488
    v_rcp_f32 v39, v39
    v_cvt_pk_bf16_f32 v52, v42, v43
    v_mul_f32 v39, v39, v103
    v_mfma_f32_32x32x16_bf16 v[196:211], v[80:83], a[236:239], v[196:211]
    s_waitcnt lgkmcnt(5)
    ds_read_b64_tr_b16 v[74:75], v19 offset:64000
    v_exp_f32 v40, v40
    v_mul_f32 v42, v106, v106
    v_mul_f32 v43, v107, v107
    v_add_f32 v40, 1.0, v40
    v_mfma_f32_32x32x16_bf16 v[180:195], v[60:63], a[96:99], v[180:195]
    ds_read_b64_tr_b16 v[76:77], v20 offset:0
    v_exp_f32 v41, v41
    v_fmaak_f32 v42, v42, v28, 0xc0135761
    v_fmaak_f32 v43, v43, v28, 0xc0135761
    v_add_f32 v41, 1.0, v41
    v_mfma_f32_32x32x16_bf16 v[196:211], v[60:63], a[240:243], v[196:211]
    s_waitcnt lgkmcnt(5)
    ds_read_b64_tr_b16 v[78:79], v20 offset:512
    v_rcp_f32 v40, v40
    v_mul_f32 v42, v42, v106
    v_mul_f32 v43, v43, v107
    v_mul_f32 v40, v40, v104
    v_mfma_f32_32x32x16_bf16 v[180:195], v[64:67], a[100:103], v[180:195]
    ds_read_b64_tr_b16 v[80:81], v20 offset:2048
    v_rcp_f32 v41, v41
    v_cvt_pk_bf16_f32 v53, v38, v39
    v_mul_f32 v41, v41, v105
    v_mfma_f32_32x32x16_bf16 v[196:211], v[64:67], a[244:247], v[196:211]
    s_waitcnt lgkmcnt(5)
    ds_read_b64_tr_b16 v[82:83], v20 offset:2560
    v_exp_f32 v42, v42
    v_mul_f32 v38, v108, v108
    v_mul_f32 v39, v109, v109
    v_add_f32 v42, 1.0, v42
    v_mfma_f32_32x32x16_bf16 v[180:195], v[68:71], a[104:107], v[180:195]
    ds_read_b64_tr_b16 v[60:61], v20 offset:4096
    v_exp_f32 v43, v43
    v_fmaak_f32 v38, v38, v28, 0xc0135761
    v_fmaak_f32 v39, v39, v28, 0xc0135761
    v_add_f32 v43, 1.0, v43
    v_mfma_f32_32x32x16_bf16 v[196:211], v[68:71], a[248:251], v[196:211]
    s_waitcnt lgkmcnt(5)
    ds_read_b64_tr_b16 v[62:63], v20 offset:4608
    v_rcp_f32 v42, v42
    v_mul_f32 v38, v38, v108
    v_mul_f32 v39, v39, v109
    v_mul_f32 v42, v42, v106
    v_mfma_f32_32x32x16_bf16 v[180:195], v[72:75], a[108:111], v[180:195]
    ds_read_b64_tr_b16 v[64:65], v20 offset:6144
    v_rcp_f32 v43, v43
    v_cvt_pk_bf16_f32 v54, v40, v41
    v_mul_f32 v43, v43, v107
    v_mfma_f32_32x32x16_bf16 v[196:211], v[72:75], a[252:255], v[196:211]
    s_waitcnt lgkmcnt(5)
    ds_read_b64_tr_b16 v[66:67], v20 offset:6656
    v_exp_f32 v38, v38
    v_mul_f32 v40, v110, v110
    v_mul_f32 v41, v111, v111
    v_add_f32 v38, 1.0, v38
    v_mfma_f32_32x32x16_bf16 v[180:195], v[76:79], a[112:115], v[180:195]
    ds_read_b64_tr_b16 v[68:69], v20 offset:8192
    v_exp_f32 v39, v39
    v_fmaak_f32 v40, v40, v28, 0xc0135761
    v_fmaak_f32 v41, v41, v28, 0xc0135761
    v_add_f32 v39, 1.0, v39
    v_mfma_f32_32x32x16_bf16 v[196:211], v[76:79], v[148:151], v[196:211]
    s_waitcnt lgkmcnt(5)
    ds_read_b64_tr_b16 v[70:71], v20 offset:8704
    v_rcp_f32 v38, v38
    v_mul_f32 v40, v40, v110
    v_mul_f32 v41, v41, v111
    v_mul_f32 v38, v38, v108
    v_mfma_f32_32x32x16_bf16 v[180:195], v[80:83], a[116:119], v[180:195]
    ds_read_b64_tr_b16 v[72:73], v20 offset:10240
    buffer_load_dwordx4 v7, s[12:15], s73 offen offset:1024 lds
    v_rcp_f32 v39, v39
    v_cvt_pk_bf16_f32 v55, v42, v43
    v_mul_f32 v39, v39, v109
    v_mfma_f32_32x32x16_bf16 v[196:211], v[80:83], v[152:155], v[196:211]
    s_waitcnt lgkmcnt(5)
    ds_read_b64_tr_b16 v[74:75], v20 offset:10752
    v_exp_f32 v40, v40
    v_mul_f32 v42, v112, v112
    v_mul_f32 v43, v113, v113
    v_add_f32 v40, 1.0, v40
    v_mfma_f32_32x32x16_bf16 v[180:195], v[60:63], a[120:123], v[180:195]
    s_add_u32 m0, s85, 32768
    ds_read_b64_tr_b16 v[76:77], v20 offset:12288
    buffer_load_dwordx4 v6, s[12:15], s74 offen offset:0 lds
    v_exp_f32 v41, v41
    v_fmaak_f32 v42, v42, v28, 0xc0135761
    v_fmaak_f32 v43, v43, v28, 0xc0135761
    v_mfma_f32_32x32x16_bf16 v[196:211], v[60:63], v[156:159], v[196:211]
    s_waitcnt lgkmcnt(5)
    ds_read_b64_tr_b16 v[78:79], v20 offset:12800
    buffer_load_dwordx4 v7, s[12:15], s74 offen offset:1024 lds
    v_add_f32 v41, 1.0, v41
    v_rcp_f32 v40, v40
    v_mul_f32 v42, v42, v112
    v_mfma_f32_32x32x16_bf16 v[180:195], v[64:67], a[124:127], v[180:195]
    ds_read_b64_tr_b16 v[80:81], v20 offset:14336
    v_mul_f32 v43, v43, v113
    v_mul_f32 v40, v40, v110
    v_rcp_f32 v41, v41
    v_cvt_pk_bf16_f32 v56, v38, v39
    v_mfma_f32_32x32x16_bf16 v[196:211], v[64:67], v[160:163], v[196:211]
    s_waitcnt lgkmcnt(5)
    ds_read_b64_tr_b16 v[82:83], v20 offset:14848
    v_mul_f32 v41, v41, v111
    v_exp_f32 v42, v42
    v_mul_f32 v38, v114, v114
    v_mul_f32 v39, v115, v115
    v_mfma_f32_32x32x16_bf16 v[180:195], v[68:71], a[128:131], v[180:195]
    s_waitcnt vmcnt(6)
    s_barrier
    ds_read_b64_tr_b16 v[60:61], v18 offset:0
    v_add_f32 v42, 1.0, v42
    v_exp_f32 v43, v43
    v_mfma_f32_32x32x16_bf16 v[196:211], v[68:71], v[164:167], v[196:211]
    s_waitcnt lgkmcnt(5)
    ds_read_b64_tr_b16 v[62:63], v18 offset:512
    v_fmaak_f32 v38, v38, v28, 0xc0135761
    v_fmaak_f32 v39, v39, v28, 0xc0135761
    v_add_f32 v43, 1.0, v43
    v_rcp_f32 v42, v42
    v_mfma_f32_32x32x16_bf16 v[180:195], v[72:75], a[132:135], v[180:195]
    s_add_u32 m0, s85, 40960
    ds_read_b64_tr_b16 v[64:65], v18 offset:2048
    buffer_load_dwordx4 v6, s[12:15], s75 offen offset:0 lds
    v_mul_f32 v38, v38, v114
    v_mul_f32 v39, v39, v115
    v_mul_f32 v42, v42, v112
    v_mfma_f32_32x32x16_bf16 v[196:211], v[72:75], v[168:171], v[196:211]
    s_waitcnt lgkmcnt(5)
    ds_read_b64_tr_b16 v[66:67], v18 offset:2560
    buffer_load_dwordx4 v7, s[12:15], s75 offen offset:1024 lds
    v_rcp_f32 v43, v43
    v_cvt_pk_bf16_f32 v57, v40, v41
    v_mul_f32 v43, v43, v113
    v_mfma_f32_32x32x16_bf16 v[180:195], v[76:79], a[136:139], v[180:195]
    ds_read_b64_tr_b16 v[68:69], v18 offset:4096
    v_exp_f32 v38, v38
    v_exp_f32 v39, v39
    v_add_f32 v38, 1.0, v38
    v_mfma_f32_32x32x16_bf16 v[196:211], v[76:79], v[172:175], v[196:211]
    s_waitcnt lgkmcnt(5)
    ds_read_b64_tr_b16 v[70:71], v18 offset:4608
    v_add_f32 v39, 1.0, v39
    v_rcp_f32 v38, v38
    v_rcp_f32 v39, v39
    v_mfma_f32_32x32x16_bf16 v[180:195], v[80:83], a[140:143], v[180:195]
    s_add_u32 m0, s85, 49152
    ds_read_b64_tr_b16 v[72:73], v18 offset:6144
    buffer_load_dwordx4 v6, s[12:15], s76 offen offset:0 lds
    v_mul_f32 v38, v38, v114
    v_cvt_pk_bf16_f32 v58, v42, v43
    v_mul_f32 v39, v39, v115
    v_mfma_f32_32x32x16_bf16 v[196:211], v[80:83], v[176:179], v[196:211]
    s_waitcnt lgkmcnt(5)
    ds_read_b64_tr_b16 v[74:75], v18 offset:6656
    buffer_load_dwordx4 v7, s[12:15], s76 offen offset:1024 lds
    v_cvt_pk_bf16_f32 v59, v38, v39
    v_mfma_f32_32x32x16_bf16 v[116:131], v[60:63], a[0:3], v[212:227]
    s_add_u32 m0, s85, 57344
    ds_read_b64_tr_b16 v[76:77], v18 offset:8192
    buffer_load_dwordx4 v6, s[12:15], s77 offen offset:0 lds
    buffer_store_dwordx4 v[44:47], v24, s[16:19], s40 offen offset:0 sc1
    v_mfma_f32_32x32x16_bf16 v[132:147], v[60:63], a[144:147], v[212:227]
    s_waitcnt lgkmcnt(5)
    ds_read_b64_tr_b16 v[78:79], v18 offset:8704
    buffer_load_dwordx4 v7, s[12:15], s77 offen offset:1024 lds
    buffer_store_dwordx4 v[48:51], v24, s[16:19], s40 offen offset:512 sc1
    v_mfma_f32_32x32x16_bf16 v[116:131], v[64:67], a[4:7], v[116:131]
    s_add_u32 m0, s85, 65536
    ds_read_b64_tr_b16 v[80:81], v18 offset:10240
    buffer_load_dwordx4 v6, s[12:15], s78 offen offset:0 lds
    buffer_store_dwordx4 v[52:55], v25, s[16:19], s40 offen offset:0 sc1
    v_mfma_f32_32x32x16_bf16 v[132:147], v[64:67], a[148:151], v[132:147]
    s_waitcnt lgkmcnt(5)
    ds_read_b64_tr_b16 v[82:83], v18 offset:10752
    buffer_load_dwordx4 v7, s[12:15], s78 offen offset:1024 lds
    buffer_store_dwordx4 v[56:59], v25, s[16:19], s40 offen offset:512 sc1
    v_mfma_f32_32x32x16_bf16 v[116:131], v[68:71], a[8:11], v[116:131]
    v_add_u32 v6, 0x80, v6
    ds_read_b64_tr_b16 v[60:61], v18 offset:12288
    v_mul_f32 v38, v180, v180
    v_mul_f32 v39, v181, v181
    v_fmaak_f32 v38, v38, v28, 0xc0135761
    v_fmaak_f32 v39, v39, v28, 0xc0135761
    v_mfma_f32_32x32x16_bf16 v[132:147], v[68:71], a[152:155], v[132:147]
    s_waitcnt lgkmcnt(5)
    ds_read_b64_tr_b16 v[62:63], v18 offset:12800
    v_mul_f32 v38, v38, v180
    v_mul_f32 v39, v39, v181
    v_exp_f32 v38, v38
    v_mul_f32 v40, v182, v182
    v_mfma_f32_32x32x16_bf16 v[116:131], v[72:75], a[12:15], v[116:131]
    v_add_u32 v7, 0x80, v7
    ds_read_b64_tr_b16 v[64:65], v18 offset:14336
    v_mul_f32 v41, v183, v183
    v_add_f32 v38, 1.0, v38
    v_exp_f32 v39, v39
    v_fmaak_f32 v40, v40, v28, 0xc0135761
    v_mfma_f32_32x32x16_bf16 v[132:147], v[72:75], a[156:159], v[132:147]
    s_waitcnt lgkmcnt(5)
    ds_read_b64_tr_b16 v[66:67], v18 offset:14848
    v_fmaak_f32 v41, v41, v28, 0xc0135761
    v_add_f32 v39, 1.0, v39
    v_rcp_f32 v38, v38
    v_mul_f32 v40, v40, v182
    v_mfma_f32_32x32x16_bf16 v[116:131], v[76:79], a[16:19], v[116:131]
    s_add_u32 m0, s85, 73728
    ds_read_b64_tr_b16 v[68:69], v18 offset:16384
    buffer_load_dwordx4 v6, s[12:15], s70 offen offset:0 lds
    v_mul_f32 v41, v41, v183
    v_mul_f32 v38, v38, v180
    v_rcp_f32 v39, v39
    v_mfma_f32_32x32x16_bf16 v[132:147], v[76:79], a[160:163], v[132:147]
    s_waitcnt lgkmcnt(5)
    ds_read_b64_tr_b16 v[70:71], v18 offset:16896
    v_nop
    v_mul_f32 v39, v39, v181
    v_exp_f32 v40, v40
    v_mul_f32 v42, v184, v184
    v_mfma_f32_32x32x16_bf16 v[116:131], v[80:83], a[20:23], v[116:131]
    ds_read_b64_tr_b16 v[72:73], v18 offset:18432
    buffer_load_dwordx4 v7, s[12:15], s70 offen offset:1024 lds
    v_mul_f32 v43, v185, v185
    v_add_f32 v40, 1.0, v40
    v_exp_f32 v41, v41
    v_mfma_f32_32x32x16_bf16 v[132:147], v[80:83], a[164:167], v[132:147]
    s_waitcnt lgkmcnt(5)
    ds_read_b64_tr_b16 v[74:75], v18 offset:18944
    v_fmaak_f32 v42, v42, v28, 0xc0135761
    v_fmaak_f32 v43, v43, v28, 0xc0135761
    v_add_f32 v41, 1.0, v41
    v_rcp_f32 v40, v40
    v_mfma_f32_32x32x16_bf16 v[116:131], v[60:63], a[24:27], v[116:131]
    s_add_u32 m0, s85, 81920
    ds_read_b64_tr_b16 v[76:77], v18 offset:20480
    buffer_load_dwordx4 v6, s[12:15], s71 offen offset:0 lds
    v_mul_f32 v42, v42, v184
    v_mul_f32 v43, v43, v185
    v_mul_f32 v40, v40, v182
    v_mfma_f32_32x32x16_bf16 v[132:147], v[60:63], a[168:171], v[132:147]
    s_waitcnt lgkmcnt(5)
    ds_read_b64_tr_b16 v[78:79], v18 offset:20992
    v_rcp_f32 v41, v41
    v_cvt_pk_bf16_f32 v44, v38, v39
    v_mul_f32 v41, v41, v183
    v_mfma_f32_32x32x16_bf16 v[116:131], v[64:67], a[28:31], v[116:131]
    ds_read_b64_tr_b16 v[80:81], v18 offset:22528
    buffer_load_dwordx4 v7, s[12:15], s71 offen offset:1024 lds
    v_exp_f32 v42, v42
    v_mul_f32 v38, v186, v186
    v_mul_f32 v39, v187, v187
    v_mfma_f32_32x32x16_bf16 v[132:147], v[64:67], a[172:175], v[132:147]
    s_waitcnt lgkmcnt(5)
    ds_read_b64_tr_b16 v[82:83], v18 offset:23040
    v_add_f32 v42, 1.0, v42
    v_exp_f32 v43, v43
    v_fmaak_f32 v38, v38, v28, 0xc0135761
    v_fmaak_f32 v39, v39, v28, 0xc0135761
    v_mfma_f32_32x32x16_bf16 v[116:131], v[68:71], a[32:35], v[116:131]
    s_add_u32 m0, s85, 90112
    s_waitcnt vmcnt(14)
    s_barrier
    ds_read_b64_tr_b16 v[60:61], v18 offset:24576
    buffer_load_dwordx4 v6, s[12:15], s72 offen offset:0 lds
    v_add_f32 v43, 1.0, v43
    v_mfma_f32_32x32x16_bf16 v[132:147], v[68:71], a[176:179], v[132:147]
    s_waitcnt lgkmcnt(5)
    ds_read_b64_tr_b16 v[62:63], v18 offset:25088
    v_rcp_f32 v42, v42
    v_mul_f32 v38, v38, v186
    v_mul_f32 v39, v39, v187
    v_mul_f32 v42, v42, v184
    v_mfma_f32_32x32x16_bf16 v[116:131], v[72:75], a[36:39], v[116:131]
    ds_read_b64_tr_b16 v[64:65], v18 offset:26624
    v_rcp_f32 v43, v43
    v_cvt_pk_bf16_f32 v45, v40, v41
    v_mul_f32 v43, v43, v185
    v_mfma_f32_32x32x16_bf16 v[132:147], v[72:75], a[180:183], v[132:147]
    s_waitcnt lgkmcnt(5)
    ds_read_b64_tr_b16 v[66:67], v18 offset:27136
    v_exp_f32 v38, v38
    v_mul_f32 v40, v188, v188
    v_mul_f32 v41, v189, v189
    v_add_f32 v38, 1.0, v38
    v_mfma_f32_32x32x16_bf16 v[116:131], v[76:79], a[40:43], v[116:131]
    ds_read_b64_tr_b16 v[68:69], v18 offset:28672
    v_exp_f32 v39, v39
    v_fmaak_f32 v40, v40, v28, 0xc0135761
    v_fmaak_f32 v41, v41, v28, 0xc0135761
    v_add_f32 v39, 1.0, v39
    v_mfma_f32_32x32x16_bf16 v[132:147], v[76:79], a[184:187], v[132:147]
    s_waitcnt lgkmcnt(5)
    ds_read_b64_tr_b16 v[70:71], v18 offset:29184
    buffer_load_dwordx4 v7, s[12:15], s72 offen offset:1024 lds
    v_rcp_f32 v38, v38
    v_mul_f32 v40, v40, v188
    v_mul_f32 v41, v41, v189
    v_mfma_f32_32x32x16_bf16 v[116:131], v[80:83], a[44:47], v[116:131]
    ds_read_b64_tr_b16 v[72:73], v18 offset:30720
    v_mul_f32 v38, v38, v186
    v_rcp_f32 v39, v39
    v_cvt_pk_bf16_f32 v46, v42, v43
    v_mul_f32 v39, v39, v187
    v_mfma_f32_32x32x16_bf16 v[132:147], v[80:83], a[188:191], v[132:147]
    s_waitcnt lgkmcnt(5)
    ds_read_b64_tr_b16 v[74:75], v18 offset:31232
    v_exp_f32 v40, v40
    v_mul_f32 v42, v190, v190
    v_mul_f32 v43, v191, v191
    v_add_f32 v40, 1.0, v40
    v_mfma_f32_32x32x16_bf16 v[116:131], v[60:63], a[48:51], v[116:131]
    ds_read_b64_tr_b16 v[76:77], v18 offset:32768
    v_exp_f32 v41, v41
    v_fmaak_f32 v42, v42, v28, 0xc0135761
    v_fmaak_f32 v43, v43, v28, 0xc0135761
    v_add_f32 v41, 1.0, v41
    v_mfma_f32_32x32x16_bf16 v[132:147], v[60:63], a[192:195], v[132:147]
    s_waitcnt lgkmcnt(5)
    ds_read_b64_tr_b16 v[78:79], v18 offset:33280
    v_rcp_f32 v40, v40
    v_mul_f32 v42, v42, v190
    v_mul_f32 v43, v43, v191
    v_mul_f32 v40, v40, v188
    v_mfma_f32_32x32x16_bf16 v[116:131], v[64:67], a[52:55], v[116:131]
    ds_read_b64_tr_b16 v[80:81], v18 offset:34816
    v_rcp_f32 v41, v41
    v_cvt_pk_bf16_f32 v47, v38, v39
    v_mul_f32 v41, v41, v189
    v_mfma_f32_32x32x16_bf16 v[132:147], v[64:67], a[196:199], v[132:147]
    s_waitcnt lgkmcnt(5)
    ds_read_b64_tr_b16 v[82:83], v18 offset:35328
    v_exp_f32 v42, v42
    v_mul_f32 v38, v192, v192
    v_mul_f32 v39, v193, v193
    v_add_f32 v42, 1.0, v42
    v_mfma_f32_32x32x16_bf16 v[116:131], v[68:71], a[56:59], v[116:131]
    ds_read_b64_tr_b16 v[60:61], v18 offset:36864
    ds_read_b128 v[212:215], v26 offset:768
    v_exp_f32 v43, v43
    v_fmaak_f32 v38, v38, v28, 0xc0135761
    v_fmaak_f32 v39, v39, v28, 0xc0135761
    v_mfma_f32_32x32x16_bf16 v[132:147], v[68:71], a[200:203], v[132:147]
    s_waitcnt lgkmcnt(6)
    ds_read_b64_tr_b16 v[62:63], v18 offset:37376
    v_add_f32 v43, 1.0, v43
    v_rcp_f32 v42, v42
    v_mul_f32 v38, v38, v192
    v_mul_f32 v39, v39, v193
    v_mfma_f32_32x32x16_bf16 v[116:131], v[72:75], a[60:63], v[116:131]
    s_add_u32 m0, s85, 98304
    ds_read_b64_tr_b16 v[64:65], v18 offset:38912
    ds_read_b128 v[216:219], v26 offset:800
    buffer_load_dwordx4 v6, s[12:15], s73 offen offset:0 lds
    v_mul_f32 v42, v42, v190
    v_rcp_f32 v43, v43
    v_mfma_f32_32x32x16_bf16 v[132:147], v[72:75], a[204:207], v[132:147]
    s_waitcnt lgkmcnt(7)
    ds_read_b64_tr_b16 v[66:67], v18 offset:39424
    v_cvt_pk_bf16_f32 v48, v40, v41
    v_mul_f32 v43, v43, v191
    v_exp_f32 v38, v38
    v_mul_f32 v40, v194, v194
    v_mfma_f32_32x32x16_bf16 v[116:131], v[76:79], a[64:67], v[116:131]
    ds_read_b64_tr_b16 v[68:69], v18 offset:40960
    ds_read_b128 v[220:223], v26 offset:832
    v_mul_f32 v41, v195, v195
    v_add_f32 v38, 1.0, v38
    v_exp_f32 v39, v39
    v_mfma_f32_32x32x16_bf16 v[132:147], v[76:79], a[208:211], v[132:147]
    s_waitcnt lgkmcnt(8)
    ds_read_b64_tr_b16 v[70:71], v18 offset:41472
    v_fmaak_f32 v40, v40, v28, 0xc0135761
    v_fmaak_f32 v41, v41, v28, 0xc0135761
    v_add_f32 v39, 1.0, v39
    v_rcp_f32 v38, v38
    v_mfma_f32_32x32x16_bf16 v[116:131], v[80:83], a[68:71], v[116:131]
    ds_read_b64_tr_b16 v[72:73], v18 offset:43008
    ds_read_b128 v[224:227], v26 offset:864
    v_mul_f32 v40, v40, v194
    v_mul_f32 v41, v41, v195
    v_mul_f32 v38, v38, v192
    v_mfma_f32_32x32x16_bf16 v[132:147], v[80:83], a[212:215], v[132:147]
    s_waitcnt lgkmcnt(8)
    ds_read_b64_tr_b16 v[74:75], v18 offset:43520
    v_rcp_f32 v39, v39
    v_cvt_pk_bf16_f32 v49, v42, v43
    v_mul_f32 v39, v39, v193
    v_mfma_f32_32x32x16_bf16 v[116:131], v[60:63], a[72:75], v[116:131]
    ds_read_b64_tr_b16 v[76:77], v18 offset:45056
    buffer_load_dwordx4 v7, s[12:15], s73 offen offset:1024 lds
    v_exp_f32 v40, v40
    v_mul_f32 v42, v196, v196
    v_mul_f32 v43, v197, v197
    v_mfma_f32_32x32x16_bf16 v[132:147], v[60:63], a[216:219], v[132:147]
    s_waitcnt lgkmcnt(7)
    ds_read_b64_tr_b16 v[78:79], v18 offset:45568
    v_add_f32 v40, 1.0, v40
    v_exp_f32 v41, v41
    v_fmaak_f32 v42, v42, v28, 0xc0135761
    v_fmaak_f32 v43, v43, v28, 0xc0135761
    v_mfma_f32_32x32x16_bf16 v[116:131], v[64:67], a[76:79], v[116:131]
    ds_read_b64_tr_b16 v[80:81], v18 offset:47104
    v_add_f32 v41, 1.0, v41
    v_rcp_f32 v40, v40
    v_mul_f32 v42, v42, v196
    v_mul_f32 v43, v43, v197
    v_mfma_f32_32x32x16_bf16 v[132:147], v[64:67], a[220:223], v[132:147]
    s_waitcnt lgkmcnt(6)
    ds_read_b64_tr_b16 v[82:83], v18 offset:47616
    v_mul_f32 v40, v40, v194
    v_rcp_f32 v41, v41
    v_cvt_pk_bf16_f32 v50, v38, v39
    v_mul_f32 v41, v41, v195
    v_mfma_f32_32x32x16_bf16 v[116:131], v[68:71], a[80:83], v[116:131]
    s_waitcnt vmcnt(9)
    s_barrier
    ds_read_b64_tr_b16 v[60:61], v18 offset:49152
    v_exp_f32 v42, v42
    v_mul_f32 v38, v198, v198
    v_mfma_f32_32x32x16_bf16 v[132:147], v[68:71], a[224:227], v[132:147]
    s_waitcnt lgkmcnt(5)
    ds_read_b64_tr_b16 v[62:63], v18 offset:49664
    v_mul_f32 v39, v199, v199
    v_add_f32 v42, 1.0, v42
    v_exp_f32 v43, v43
    v_fmaak_f32 v38, v38, v28, 0xc0135761
    v_mfma_f32_32x32x16_bf16 v[116:131], v[72:75], a[84:87], v[116:131]
    ds_read_b64_tr_b16 v[64:65], v18 offset:51200
    v_fmaak_f32 v39, v39, v28, 0xc0135761
    v_add_f32 v43, 1.0, v43
    v_rcp_f32 v42, v42
    v_mul_f32 v38, v38, v198
    v_mfma_f32_32x32x16_bf16 v[132:147], v[72:75], a[228:231], v[132:147]
    s_waitcnt lgkmcnt(5)
    ds_read_b64_tr_b16 v[66:67], v18 offset:51712
    v_mul_f32 v39, v39, v199
    v_mul_f32 v42, v42, v196
    v_rcp_f32 v43, v43
    v_cvt_pk_bf16_f32 v51, v40, v41
    v_mfma_f32_32x32x16_bf16 v[116:131], v[76:79], a[88:91], v[116:131]
    s_add_u32 m0, s85, 106496
    ds_read_b64_tr_b16 v[68:69], v18 offset:53248
    buffer_load_dwordx4 v6, s[12:15], s74 offen offset:0 lds
    v_mul_f32 v43, v43, v197
    v_exp_f32 v38, v38
    v_mul_f32 v40, v200, v200
    v_mfma_f32_32x32x16_bf16 v[132:147], v[76:79], a[232:235], v[132:147]
    s_waitcnt lgkmcnt(5)
    ds_read_b64_tr_b16 v[70:71], v18 offset:53760
    v_mul_f32 v41, v201, v201
    v_add_f32 v38, 1.0, v38
    v_exp_f32 v39, v39
    v_fmaak_f32 v40, v40, v28, 0xc0135761
    v_mfma_f32_32x32x16_bf16 v[116:131], v[80:83], a[92:95], v[116:131]
    ds_read_b64_tr_b16 v[72:73], v18 offset:55296
    buffer_load_dwordx4 v7, s[12:15], s74 offen offset:1024 lds
    v_fmaak_f32 v41, v41, v28, 0xc0135761
    v_add_f32 v39, 1.0, v39
    v_rcp_f32 v38, v38
    v_mfma_f32_32x32x16_bf16 v[132:147], v[80:83], a[236:239], v[132:147]
    s_waitcnt lgkmcnt(5)
    ds_read_b64_tr_b16 v[74:75], v18 offset:55808
    v_mul_f32 v40, v40, v200
    v_mul_f32 v41, v41, v201
    v_mul_f32 v38, v38, v198
    v_rcp_f32 v39, v39
    v_mfma_f32_32x32x16_bf16 v[116:131], v[60:63], a[96:99], v[116:131]
    s_add_u32 m0, s85, 114688
    ds_read_b64_tr_b16 v[76:77], v18 offset:57344
    buffer_load_dwordx4 v6, s[12:15], s75 offen offset:0 lds
    v_cvt_pk_bf16_f32 v52, v42, v43
    v_mul_f32 v39, v39, v199
    v_exp_f32 v40, v40
    v_mfma_f32_32x32x16_bf16 v[132:147], v[60:63], a[240:243], v[132:147]
    s_waitcnt lgkmcnt(5)
    ds_read_b64_tr_b16 v[78:79], v18 offset:57856
    v_mul_f32 v42, v202, v202
    v_mul_f32 v43, v203, v203
    v_add_f32 v40, 1.0, v40
    v_exp_f32 v41, v41
    v_mfma_f32_32x32x16_bf16 v[116:131], v[64:67], a[100:103], v[116:131]
    ds_read_b64_tr_b16 v[80:81], v18 offset:59392
    buffer_load_dwordx4 v7, s[12:15], s75 offen offset:1024 lds
    v_fmaak_f32 v42, v42, v28, 0xc0135761
    v_fmaak_f32 v43, v43, v28, 0xc0135761
    v_add_f32 v41, 1.0, v41
    v_mfma_f32_32x32x16_bf16 v[132:147], v[64:67], a[244:247], v[132:147]
    s_waitcnt lgkmcnt(5)
    ds_read_b64_tr_b16 v[82:83], v18 offset:59904
    v_rcp_f32 v40, v40
    v_mul_f32 v42, v42, v202
    v_mul_f32 v43, v43, v203
    v_mul_f32 v40, v40, v200
    v_mfma_f32_32x32x16_bf16 v[116:131], v[68:71], a[104:107], v[116:131]
    ds_read_b64_tr_b16 v[60:61], v18 offset:61440
    v_rcp_f32 v41, v41
    v_cvt_pk_bf16_f32 v53, v38, v39
    v_mul_f32 v41, v41, v201
    v_mfma_f32_32x32x16_bf16 v[132:147], v[68:71], a[248:251], v[132:147]
    s_waitcnt lgkmcnt(5)
    ds_read_b64_tr_b16 v[62:63], v18 offset:61952
    v_exp_f32 v42, v42
    v_mul_f32 v38, v204, v204
    v_mul_f32 v39, v205, v205
    v_add_f32 v42, 1.0, v42
    v_mfma_f32_32x32x16_bf16 v[116:131], v[72:75], a[108:111], v[116:131]
    s_add_u32 m0, s85, 0
    ds_read_b64_tr_b16 v[64:65], v18 offset:63488
    buffer_load_dwordx4 v6, s[12:15], s76 offen offset:0 lds
    v_exp_f32 v43, v43
    v_fmaak_f32 v38, v38, v28, 0xc0135761
    v_fmaak_f32 v39, v39, v28, 0xc0135761
    v_mfma_f32_32x32x16_bf16 v[132:147], v[72:75], a[252:255], v[132:147]
    s_waitcnt lgkmcnt(5)
    ds_read_b64_tr_b16 v[66:67], v18 offset:64000
    v_add_f32 v43, 1.0, v43
    v_rcp_f32 v42, v42
    v_mul_f32 v38, v38, v204
    v_mul_f32 v39, v39, v205
    v_mfma_f32_32x32x16_bf16 v[116:131], v[76:79], a[112:115], v[116:131]
    ds_read_b64_tr_b16 v[68:69], v19 offset:0
    buffer_load_dwordx4 v7, s[12:15], s76 offen offset:1024 lds
    v_mul_f32 v42, v42, v202
    v_rcp_f32 v43, v43
    v_cvt_pk_bf16_f32 v54, v40, v41
    v_mfma_f32_32x32x16_bf16 v[132:147], v[76:79], v[148:151], v[132:147]
    s_waitcnt lgkmcnt(5)
    ds_read_b64_tr_b16 v[70:71], v19 offset:512
    v_mul_f32 v43, v43, v203
    v_exp_f32 v38, v38
    v_mul_f32 v40, v206, v206
    v_mul_f32 v41, v207, v207
    v_mfma_f32_32x32x16_bf16 v[116:131], v[80:83], a[116:119], v[116:131]
    s_add_u32 m0, s85, 8192
    ds_read_b64_tr_b16 v[72:73], v19 offset:2048
    buffer_load_dwordx4 v6, s[12:15], s77 offen offset:0 lds
    v_add_f32 v38, 1.0, v38
    v_exp_f32 v39, v39
    v_fmaak_f32 v40, v40, v28, 0xc0135761
    v_mfma_f32_32x32x16_bf16 v[132:147], v[80:83], v[152:155], v[132:147]
    s_waitcnt lgkmcnt(5)
    ds_read_b64_tr_b16 v[74:75], v19 offset:2560
    v_fmaak_f32 v41, v41, v28, 0xc0135761
    v_add_f32 v39, 1.0, v39
    v_rcp_f32 v38, v38
    v_mul_f32 v40, v40, v206
    v_mfma_f32_32x32x16_bf16 v[116:131], v[60:63], a[120:123], v[116:131]
    ds_read_b64_tr_b16 v[76:77], v19 offset:4096
    buffer_load_dwordx4 v7, s[12:15], s77 offen offset:1024 lds
    v_mul_f32 v41, v41, v207
    v_mul_f32 v38, v38, v204
    v_rcp_f32 v39, v39
    v_mfma_f32_32x32x16_bf16 v[132:147], v[60:63], v[156:159], v[132:147]
    s_waitcnt lgkmcnt(5)
    ds_read_b64_tr_b16 v[78:79], v19 offset:4608
    v_cvt_pk_bf16_f32 v55, v42, v43
    v_mul_f32 v39, v39, v205
    v_exp_f32 v40, v40
    v_mul_f32 v42, v208, v208
    v_mfma_f32_32x32x16_bf16 v[116:131], v[64:67], a[124:127], v[116:131]
    s_add_u32 m0, s85, 16384
    ds_read_b64_tr_b16 v[80:81], v19 offset:6144
    buffer_load_dwordx4 v6, s[12:15], s78 offen offset:0 lds
    v_mul_f32 v43, v209, v209
    v_add_f32 v40, 1.0, v40
    v_exp_f32 v41, v41
    v_mfma_f32_32x32x16_bf16 v[132:147], v[64:67], v[160:163], v[132:147]
    s_waitcnt lgkmcnt(5)
    ds_read_b64_tr_b16 v[82:83], v19 offset:6656
    v_fmaak_f32 v42, v42, v28, 0xc0135761
    v_fmaak_f32 v43, v43, v28, 0xc0135761
    v_add_f32 v41, 1.0, v41
    v_rcp_f32 v40, v40
    v_mfma_f32_32x32x16_bf16 v[116:131], v[68:71], a[128:131], v[116:131]
    s_waitcnt vmcnt(11)
    s_barrier
    ds_read_b64_tr_b16 v[60:61], v19 offset:8192
    buffer_load_dwordx4 v7, s[12:15], s78 offen offset:1024 lds
    v_mul_f32 v42, v42, v208
    v_mul_f32 v43, v43, v209
    v_mfma_f32_32x32x16_bf16 v[132:147], v[68:71], v[164:167], v[132:147]
    s_waitcnt lgkmcnt(5)
    ds_read_b64_tr_b16 v[62:63], v19 offset:8704
    v_mul_f32 v40, v40, v206
    v_rcp_f32 v41, v41
    v_cvt_pk_bf16_f32 v56, v38, v39
    v_mul_f32 v41, v41, v207
    v_mfma_f32_32x32x16_bf16 v[116:131], v[72:75], a[132:135], v[116:131]
    ds_read_b64_tr_b16 v[64:65], v19 offset:10240
    v_exp_f32 v42, v42
    v_mul_f32 v38, v210, v210
    v_mul_f32 v39, v211, v211
    v_add_f32 v42, 1.0, v42
    v_mfma_f32_32x32x16_bf16 v[132:147], v[72:75], v[168:171], v[132:147]
    s_waitcnt lgkmcnt(5)
    ds_read_b64_tr_b16 v[66:67], v19 offset:10752
    v_exp_f32 v43, v43
    v_fmaak_f32 v38, v38, v28, 0xc0135761
    v_fmaak_f32 v39, v39, v28, 0xc0135761
    v_add_f32 v43, 1.0, v43
    v_mfma_f32_32x32x16_bf16 v[116:131], v[76:79], a[136:139], v[116:131]
    s_add_u32 s54, s50, 0
    ds_read_b64_tr_b16 v[68:69], v19 offset:12288
    v_rcp_f32 v42, v42
    v_mul_f32 v38, v38, v210
    v_mul_f32 v39, v39, v211
    v_mul_f32 v42, v42, v208
    v_mfma_f32_32x32x16_bf16 v[132:147], v[76:79], v[172:175], v[132:147]
    s_waitcnt lgkmcnt(5)
    ds_read_b64_tr_b16 v[70:71], v19 offset:12800
    v_rcp_f32 v43, v43
    v_cvt_pk_bf16_f32 v57, v40, v41
    v_mul_f32 v43, v43, v209
    v_mfma_f32_32x32x16_bf16 v[116:131], v[80:83], a[140:143], v[116:131]
    s_add_u32 m0, s88, 24576
    ds_read_b64_tr_b16 v[72:73], v19 offset:14336
    buffer_load_dwordx4 v228, s[24:27], s54 offen offset:0 lds
    v_exp_f32 v38, v38
    v_exp_f32 v39, v39
    v_mfma_f32_32x32x16_bf16 v[132:147], v[80:83], v[176:179], v[132:147]
    s_waitcnt lgkmcnt(5)
    ds_read_b64_tr_b16 v[74:75], v19 offset:14848
    v_add_f32 v38, 1.0, v38
    v_add_f32 v39, 1.0, v39
    v_rcp_f32 v38, v38
    v_mfma_f32_32x32x16_bf16 v[84:99], v[60:63], a[0:3], v[212:227]
    ds_read_b64_tr_b16 v[76:77], v19 offset:16384
    buffer_load_dwordx4 v229, s[24:27], s54 offen offset:1024 lds
    v_rcp_f32 v39, v39
    v_mul_f32 v38, v38, v210
    s_add_u32 s46, s47, 146176
    s_nop 1
    v_mfma_f32_32x32x16_bf16 v[100:115], v[60:63], a[144:147], v[212:227]
    s_waitcnt lgkmcnt(5)
    ds_read_b64_tr_b16 v[78:79], v19 offset:16896
    v_add_u32 v22, s46, v24
    v_add_u32 v36, s46, v25
    v_cvt_pk_bf16_f32 v58, v42, v43
    v_mul_f32 v39, v39, v211
    v_mfma_f32_32x32x16_bf16 v[84:99], v[64:67], a[4:7], v[84:99]
    ds_read_b64_tr_b16 v[80:81], v19 offset:18432
    buffer_load_dwordx4 v230, s[24:27], s54 offen offset:2048 lds
    v_cvt_pk_bf16_f32 v59, v38, v39
    v_mfma_f32_32x32x16_bf16 v[100:115], v[64:67], a[148:151], v[100:115]
    s_waitcnt lgkmcnt(5)
    ds_read_b64_tr_b16 v[82:83], v19 offset:18944
    buffer_store_dwordx4 v[44:47], v24, s[16:19], s41 offen offset:0 sc1
    ds_write_b128 v22, v[44:47] offset:0
    v_mfma_f32_32x32x16_bf16 v[84:99], v[68:71], a[8:11], v[84:99]
    ds_read_b64_tr_b16 v[60:61], v19 offset:20480
    buffer_load_dwordx4 v231, s[24:27], s54 offen offset:3072 lds
    buffer_store_dwordx4 v[48:51], v24, s[16:19], s41 offen offset:512 sc1
    ds_write_b128 v22, v[48:51] offset:512
    v_mfma_f32_32x32x16_bf16 v[100:115], v[68:71], a[152:155], v[100:115]
    s_waitcnt lgkmcnt(7)
    ds_read_b64_tr_b16 v[62:63], v19 offset:20992
    buffer_store_dwordx4 v[52:55], v25, s[16:19], s41 offen offset:0 sc1
    ds_write_b128 v36, v[52:55] offset:0
    v_mfma_f32_32x32x16_bf16 v[84:99], v[72:75], a[12:15], v[84:99]
    s_add_u32 s55, s79, 0
    ds_read_b64_tr_b16 v[64:65], v19 offset:22528
    buffer_load_dwordx4 a[0:3], v239, s[16:19], s55 offen offset:0 sc1
    buffer_store_dwordx4 v[56:59], v25, s[16:19], s41 offen offset:512 sc1
    ds_write_b128 v36, v[56:59] offset:512
    v_mfma_f32_32x32x16_bf16 v[100:115], v[72:75], a[156:159], v[100:115]
    s_waitcnt lgkmcnt(9)
    ds_read_b64_tr_b16 v[66:67], v19 offset:23040
    buffer_load_dwordx4 a[144:147], v239, s[16:19], s55 offen offset:1024 sc1
    v_mul_f32 v38, v116, v116
    v_mul_f32 v39, v117, v117
    v_fmaak_f32 v38, v38, v28, 0xc0135761
    v_mfma_f32_32x32x16_bf16 v[84:99], v[76:79], a[16:19], v[84:99]
    ds_read_b64_tr_b16 v[68:69], v19 offset:24576
    v_fmaak_f32 v39, v39, v28, 0xc0135761
    v_mul_f32 v38, v38, v116
    v_mul_f32 v39, v39, v117
    v_exp_f32 v38, v38
    v_mfma_f32_32x32x16_bf16 v[100:115], v[76:79], a[160:163], v[100:115]
    s_waitcnt lgkmcnt(9)
    ds_read_b64_tr_b16 v[70:71], v19 offset:25088
    buffer_load_dwordx4 a[4:7], v240, s[16:19], s55 offen offset:0 sc1
    v_mul_f32 v40, v118, v118
    v_mul_f32 v41, v119, v119
    v_add_f32 v38, 1.0, v38
    v_mfma_f32_32x32x16_bf16 v[84:99], v[80:83], a[20:23], v[84:99]
    ds_read_b64_tr_b16 v[72:73], v19 offset:26624
    v_exp_f32 v39, v39
    v_fmaak_f32 v40, v40, v28, 0xc0135761
    v_fmaak_f32 v41, v41, v28, 0xc0135761
    v_add_f32 v39, 1.0, v39
    v_mfma_f32_32x32x16_bf16 v[100:115], v[80:83], a[164:167], v[100:115]
    s_waitcnt lgkmcnt(7)
    ds_read_b64_tr_b16 v[74:75], v19 offset:27136
    buffer_load_dwordx4 a[148:151], v240, s[16:19], s55 offen offset:1024 sc1
    v_rcp_f32 v38, v38
    v_mul_f32 v40, v40, v118
    v_mul_f32 v41, v41, v119
    v_mfma_f32_32x32x16_bf16 v[84:99], v[60:63], a[24:27], v[84:99]
    ds_read_b64_tr_b16 v[76:77], v19 offset:28672
    v_mul_f32 v38, v38, v116
    v_rcp_f32 v39, v39
    v_nop
    v_mul_f32 v39, v39, v117
    v_mfma_f32_32x32x16_bf16 v[100:115], v[60:63], a[168:171], v[100:115]
    s_waitcnt lgkmcnt(5)
    ds_read_b64_tr_b16 v[78:79], v19 offset:29184
    v_exp_f32 v40, v40
    v_mul_f32 v42, v120, v120
    v_mul_f32 v43, v121, v121
    v_add_f32 v40, 1.0, v40
    v_mfma_f32_32x32x16_bf16 v[84:99], v[64:67], a[28:31], v[84:99]
    s_add_u32 m0, s88, 28672
    ds_read_b64_tr_b16 v[80:81], v19 offset:30720
    buffer_load_dwordx4 v232, s[24:27], s54 offen offset:0 lds
    v_exp_f32 v41, v41
    v_fmaak_f32 v42, v42, v28, 0xc0135761
    v_fmaak_f32 v43, v43, v28, 0xc0135761
    v_mfma_f32_32x32x16_bf16 v[100:115], v[64:67], a[172:175], v[100:115]
    s_waitcnt lgkmcnt(5)
    ds_read_b64_tr_b16 v[82:83], v19 offset:31232
    v_add_f32 v41, 1.0, v41
    v_rcp_f32 v40, v40
    v_mul_f32 v42, v42, v120
    v_mul_f32 v43, v43, v121
    v_mfma_f32_32x32x16_bf16 v[84:99], v[68:71], a[32:35], v[84:99]
    s_waitcnt vmcnt(19)
    s_barrier
    ds_read_b64_tr_b16 v[60:61], v19 offset:32768
    v_mul_f32 v40, v40, v118
    v_rcp_f32 v41, v41
    v_mfma_f32_32x32x16_bf16 v[100:115], v[68:71], a[176:179], v[100:115]
    s_waitcnt lgkmcnt(5)
    ds_read_b64_tr_b16 v[62:63], v19 offset:33280
    v_cvt_pk_bf16_f32 v44, v38, v39
    v_mul_f32 v41, v41, v119
    v_exp_f32 v42, v42
    v_mul_f32 v38, v122, v122
    v_mfma_f32_32x32x16_bf16 v[84:99], v[72:75], a[36:39], v[84:99]
    s_add_u32 s54, s50, 73728
    ds_read_b64_tr_b16 v[64:65], v19 offset:34816
    ds_read_b128 a[8:11], v35 offset:15104
    v_mul_f32 v39, v123, v123
    v_add_f32 v42, 1.0, v42
    v_exp_f32 v43, v43
    v_mfma_f32_32x32x16_bf16 v[100:115], v[72:75], a[180:183], v[100:115]
    s_waitcnt lgkmcnt(6)
    ds_read_b64_tr_b16 v[66:67], v19 offset:35328
    ds_read_b128 a[152:155], v35 offset:16128
    v_fmaak_f32 v38, v38, v28, 0xc0135761
    v_fmaak_f32 v39, v39, v28, 0xc0135761
    v_add_f32 v43, 1.0, v43
    v_mfma_f32_32x32x16_bf16 v[84:99], v[76:79], a[40:43], v[84:99]
    s_add_u32 m0, s88, 45056
    ds_read_b64_tr_b16 v[68:69], v19 offset:36864
    buffer_load_dwordx4 v228, s[24:27], s54 offen offset:0 lds
    ds_read_b128 a[12:15], v35 offset:23296
    v_rcp_f32 v42, v42
    v_mul_f32 v38, v38, v122
    v_mfma_f32_32x32x16_bf16 v[100:115], v[76:79], a[184:187], v[100:115]
    s_waitcnt lgkmcnt(8)
    ds_read_b64_tr_b16 v[70:71], v19 offset:37376
    ds_read_b128 a[156:159], v35 offset:24320
    v_mul_f32 v39, v39, v123
    v_mul_f32 v42, v42, v120
    v_rcp_f32 v43, v43
    v_mfma_f32_32x32x16_bf16 v[84:99], v[80:83], a[44:47], v[84:99]
    ds_read_b64_tr_b16 v[72:73], v19 offset:38912
    v_cvt_pk_bf16_f32 v45, v40, v41
    v_mul_f32 v43, v43, v121
    v_exp_f32 v38, v38
    v_mul_f32 v40, v124, v124
    v_mfma_f32_32x32x16_bf16 v[100:115], v[80:83], a[188:191], v[100:115]
    s_waitcnt lgkmcnt(9)
    ds_read_b64_tr_b16 v[74:75], v19 offset:39424
    v_mul_f32 v41, v125, v125
    v_add_f32 v38, 1.0, v38
    v_exp_f32 v39, v39
    v_fmaak_f32 v40, v40, v28, 0xc0135761
    v_mfma_f32_32x32x16_bf16 v[84:99], v[60:63], a[48:51], v[84:99]
    ds_read_b64_tr_b16 v[76:77], v19 offset:40960
    buffer_load_dwordx4 v229, s[24:27], s54 offen offset:1024 lds
    v_fmaak_f32 v41, v41, v28, 0xc0135761
    v_add_f32 v39, 1.0, v39
    v_rcp_f32 v38, v38
    v_mfma_f32_32x32x16_bf16 v[100:115], v[60:63], a[192:195], v[100:115]
    s_waitcnt lgkmcnt(8)
    ds_read_b64_tr_b16 v[78:79], v19 offset:41472
    v_mul_f32 v40, v40, v124
    v_mul_f32 v41, v41, v125
    v_mul_f32 v38, v38, v122
    v_rcp_f32 v39, v39
    v_mfma_f32_32x32x16_bf16 v[84:99], v[64:67], a[52:55], v[84:99]
    ds_read_b64_tr_b16 v[80:81], v19 offset:43008
    v_cvt_pk_bf16_f32 v46, v42, v43
    v_mul_f32 v39, v39, v123
    v_exp_f32 v40, v40
    v_mul_f32 v42, v126, v126
    v_mfma_f32_32x32x16_bf16 v[100:115], v[64:67], a[196:199], v[100:115]
    s_waitcnt lgkmcnt(6)
    ds_read_b64_tr_b16 v[82:83], v19 offset:43520
    v_mul_f32 v43, v127, v127
    v_add_f32 v40, 1.0, v40
    v_exp_f32 v41, v41
    v_fmaak_f32 v42, v42, v28, 0xc0135761
    v_mfma_f32_32x32x16_bf16 v[84:99], v[68:71], a[56:59], v[84:99]
    ds_read_b64_tr_b16 v[60:61], v19 offset:45056
    v_fmaak_f32 v43, v43, v28, 0xc0135761
    v_add_f32 v41, 1.0, v41
    v_rcp_f32 v40, v40
    v_mul_f32 v42, v42, v126
    v_mfma_f32_32x32x16_bf16 v[100:115], v[68:71], a[200:203], v[100:115]
    s_waitcnt lgkmcnt(5)
    ds_read_b64_tr_b16 v[62:63], v19 offset:45568
    v_mul_f32 v43, v43, v127
    s_add_u32 s46, s47, 129792
    v_add_u32 v22, s46, v24
    v_add_u32 v36, s46, v25
    v_mul_f32 v40, v40, v124
    v_mfma_f32_32x32x16_bf16 v[84:99], v[72:75], a[60:63], v[84:99]
    ds_read_b64_tr_b16 v[64:65], v19 offset:47104
    v_rcp_f32 v41, v41
    v_cvt_pk_bf16_f32 v47, v38, v39
    v_mfma_f32_32x32x16_bf16 v[100:115], v[72:75], a[204:207], v[100:115]
    s_waitcnt lgkmcnt(5)
    ds_read_b64_tr_b16 v[66:67], v19 offset:47616
    buffer_store_dwordx4 v[44:47], v24, s[16:19], s42 offen offset:0 sc1
    ds_write_b128 v22, v[44:47] offset:0
    v_mul_f32 v41, v41, v125
    v_exp_f32 v42, v42
    v_mfma_f32_32x32x16_bf16 v[84:99], v[76:79], a[64:67], v[84:99]
    ds_read_b64_tr_b16 v[68:69], v19 offset:49152
    v_mul_f32 v38, v128, v128
    v_mul_f32 v39, v129, v129
    v_add_f32 v42, 1.0, v42
    v_exp_f32 v43, v43
    v_mfma_f32_32x32x16_bf16 v[100:115], v[76:79], a[208:211], v[100:115]
    s_waitcnt lgkmcnt(6)
    ds_read_b64_tr_b16 v[70:71], v19 offset:49664
    v_fmaak_f32 v38, v38, v28, 0xc0135761
    v_fmaak_f32 v39, v39, v28, 0xc0135761
    v_add_f32 v43, 1.0, v43
    v_rcp_f32 v42, v42
    v_mfma_f32_32x32x16_bf16 v[84:99], v[80:83], a[68:71], v[84:99]
    ds_read_b64_tr_b16 v[72:73], v19 offset:51200
    v_mul_f32 v38, v38, v128
    v_mul_f32 v39, v39, v129
    v_mul_f32 v42, v42, v126
    v_rcp_f32 v43, v43
    v_mfma_f32_32x32x16_bf16 v[100:115], v[80:83], a[212:215], v[100:115]
    s_waitcnt lgkmcnt(6)
    ds_read_b64_tr_b16 v[74:75], v19 offset:51712
    v_cvt_pk_bf16_f32 v48, v40, v41
    v_mul_f32 v43, v43, v127
    v_exp_f32 v38, v38
    v_mul_f32 v40, v130, v130
    v_mfma_f32_32x32x16_bf16 v[84:99], v[60:63], a[72:75], v[84:99]
    ds_read_b64_tr_b16 v[76:77], v19 offset:53248
    v_mul_f32 v41, v131, v131
    v_add_f32 v38, 1.0, v38
    v_exp_f32 v39, v39
    v_fmaak_f32 v40, v40, v28, 0xc0135761
    v_mfma_f32_32x32x16_bf16 v[100:115], v[60:63], a[216:219], v[100:115]
    s_waitcnt lgkmcnt(6)
    ds_read_b64_tr_b16 v[78:79], v19 offset:53760
    buffer_load_dwordx4 v230, s[24:27], s54 offen offset:2048 lds
    v_fmaak_f32 v41, v41, v28, 0xc0135761
    v_add_f32 v39, 1.0, v39
    v_rcp_f32 v38, v38
    v_mfma_f32_32x32x16_bf16 v[84:99], v[64:67], a[76:79], v[84:99]
    ds_read_b64_tr_b16 v[80:81], v19 offset:55296
    v_mul_f32 v40, v40, v130
    v_mul_f32 v41, v41, v131
    v_mul_f32 v38, v38, v128
    v_rcp_f32 v39, v39
    v_mfma_f32_32x32x16_bf16 v[100:115], v[64:67], a[220:223], v[100:115]
    s_waitcnt lgkmcnt(5)
    ds_read_b64_tr_b16 v[82:83], v19 offset:55808
    v_cvt_pk_bf16_f32 v49, v42, v43
    v_mul_f32 v39, v39, v129
    v_exp_f32 v40, v40
    v_mul_f32 v42, v132, v132
    v_mfma_f32_32x32x16_bf16 v[84:99], v[68:71], a[80:83], v[84:99]
    s_waitcnt vmcnt(8)
    s_barrier
    ds_read_b64_tr_b16 v[60:61], v18 offset:0
    v_mul_f32 v43, v133, v133
    v_add_f32 v40, 1.0, v40
    v_mfma_f32_32x32x16_bf16 v[100:115], v[68:71], a[224:227], v[100:115]
    s_waitcnt lgkmcnt(5)
    ds_read_b64_tr_b16 v[62:63], v18 offset:512
    v_exp_f32 v41, v41
    v_fmaak_f32 v42, v42, v28, 0xc0135761
    v_fmaak_f32 v43, v43, v28, 0xc0135761
    v_add_f32 v41, 1.0, v41
    v_mfma_f32_32x32x16_bf16 v[84:99], v[72:75], a[84:87], v[84:99]
    s_or_b32 s21, s60, 1
    ds_read_b64_tr_b16 v[64:65], v18 offset:2048
    v_rcp_f32 v40, v40
    v_mul_f32 v42, v42, v132
    v_mul_f32 v43, v43, v133
    v_mul_f32 v40, v40, v130
    v_mfma_f32_32x32x16_bf16 v[100:115], v[72:75], a[228:231], v[100:115]
    s_waitcnt lgkmcnt(5)
    ds_read_b64_tr_b16 v[66:67], v18 offset:2560
    v_rcp_f32 v41, v41
    v_cvt_pk_bf16_f32 v50, v38, v39
    v_mul_f32 v41, v41, v131
    v_mfma_f32_32x32x16_bf16 v[84:99], v[76:79], a[88:91], v[84:99]
    v_mov_b32 v243, s21
    ds_read_b64_tr_b16 v[68:69], v18 offset:4096
    buffer_store_dword v243, v241, s[16:19], 0 offen sc1
    v_exp_f32 v42, v42
    v_mul_f32 v38, v134, v134
    v_mul_f32 v39, v135, v135
    v_mfma_f32_32x32x16_bf16 v[100:115], v[76:79], a[232:235], v[100:115]
    s_waitcnt lgkmcnt(5)
    ds_read_b64_tr_b16 v[70:71], v18 offset:4608
    buffer_load_dwordx4 v231, s[24:27], s54 offen offset:3072 lds
    v_add_f32 v42, 1.0, v42
    v_exp_f32 v43, v43
    v_fmaak_f32 v38, v38, v28, 0xc0135761
    v_mfma_f32_32x32x16_bf16 v[84:99], v[80:83], a[92:95], v[84:99]
    ds_read_b64_tr_b16 v[72:73], v18 offset:6144
    v_fmaak_f32 v39, v39, v28, 0xc0135761
    v_add_f32 v43, 1.0, v43
    v_rcp_f32 v42, v42
    v_mul_f32 v38, v38, v134
    v_mfma_f32_32x32x16_bf16 v[100:115], v[80:83], a[236:239], v[100:115]
    s_waitcnt lgkmcnt(5)
    ds_read_b64_tr_b16 v[74:75], v18 offset:6656
    v_mul_f32 v39, v39, v135
    v_mul_f32 v42, v42, v132
    v_rcp_f32 v43, v43
    v_cvt_pk_bf16_f32 v51, v40, v41
    v_mfma_f32_32x32x16_bf16 v[84:99], v[60:63], a[96:99], v[84:99]
    ds_read_b64_tr_b16 v[76:77], v18 offset:8192
    buffer_store_dwordx4 v[48:51], v24, s[16:19], s42 offen offset:512 sc1
    ds_write_b128 v22, v[48:51] offset:512
    v_mul_f32 v43, v43, v133
    v_exp_f32 v38, v38
    v_mfma_f32_32x32x16_bf16 v[100:115], v[60:63], a[240:243], v[100:115]
    s_waitcnt lgkmcnt(6)
    ds_read_b64_tr_b16 v[78:79], v18 offset:8704
    v_mul_f32 v40, v136, v136
    v_mul_f32 v41, v137, v137
    v_add_f32 v38, 1.0, v38
    v_exp_f32 v39, v39
    v_mfma_f32_32x32x16_bf16 v[84:99], v[64:67], a[100:103], v[84:99]
    s_add_u32 m0, s88, 49152
    ds_read_b64_tr_b16 v[80:81], v18 offset:10240
    buffer_load_dwordx4 v232, s[24:27], s54 offen offset:0 lds
    v_fmaak_f32 v40, v40, v28, 0xc0135761
    v_fmaak_f32 v41, v41, v28, 0xc0135761
    v_add_f32 v39, 1.0, v39
    v_mfma_f32_32x32x16_bf16 v[100:115], v[64:67], a[244:247], v[100:115]
    s_waitcnt lgkmcnt(6)
    ds_read_b64_tr_b16 v[82:83], v18 offset:10752
    v_rcp_f32 v38, v38
    v_mul_f32 v40, v40, v136
    v_mul_f32 v41, v41, v137
    v_mul_f32 v38, v38, v134
    v_mfma_f32_32x32x16_bf16 v[84:99], v[68:71], a[104:107], v[84:99]
    s_add_u32 s54, s50, 147456
    ds_read_b64_tr_b16 v[60:61], v18 offset:12288
    v_rcp_f32 v39, v39
    v_cvt_pk_bf16_f32 v52, v42, v43
    v_mul_f32 v39, v39, v135
    v_mfma_f32_32x32x16_bf16 v[100:115], v[68:71], a[248:251], v[100:115]
    s_waitcnt lgkmcnt(6)
    ds_read_b64_tr_b16 v[62:63], v18 offset:12800
    v_exp_f32 v40, v40
    v_mul_f32 v42, v138, v138
    v_mul_f32 v43, v139, v139
    v_add_f32 v40, 1.0, v40
    v_mfma_f32_32x32x16_bf16 v[84:99], v[72:75], a[108:111], v[84:99]
    s_add_u32 m0, s88, 65536
    ds_read_b64_tr_b16 v[64:65], v18 offset:14336
    buffer_load_dwordx4 v228, s[24:27], s54 offen offset:0 lds
    v_exp_f32 v41, v41
    v_fmaak_f32 v42, v42, v28, 0xc0135761
    v_fmaak_f32 v43, v43, v28, 0xc0135761
    v_mfma_f32_32x32x16_bf16 v[100:115], v[72:75], a[252:255], v[100:115]
    s_waitcnt lgkmcnt(5)
    ds_read_b64_tr_b16 v[66:67], v18 offset:14848
    buffer_load_dwordx4 v229, s[24:27], s54 offen offset:1024 lds
    v_add_f32 v41, 1.0, v41
    v_rcp_f32 v40, v40
    v_mul_f32 v42, v42, v138
    v_mfma_f32_32x32x16_bf16 v[84:99], v[76:79], a[112:115], v[84:99]
    ds_read_b64_tr_b16 v[68:69], v18 offset:16384
    v_mul_f32 v43, v43, v139
    v_mul_f32 v40, v40, v136
    v_rcp_f32 v41, v41
    v_cvt_pk_bf16_f32 v53, v38, v39
    v_mfma_f32_32x32x16_bf16 v[100:115], v[76:79], v[148:151], v[100:115]
    s_waitcnt lgkmcnt(5)
    ds_read_b64_tr_b16 v[70:71], v18 offset:16896
    buffer_load_dwordx4 v230, s[24:27], s54 offen offset:2048 lds
    v_mul_f32 v41, v41, v137
    v_exp_f32 v42, v42
    v_mul_f32 v38, v140, v140
    v_mfma_f32_32x32x16_bf16 v[84:99], v[80:83], a[116:119], v[84:99]
    ds_read_b64_tr_b16 v[72:73], v18 offset:18432
    v_mul_f32 v39, v141, v141
    v_add_f32 v42, 1.0, v42
    v_exp_f32 v43, v43
    v_fmaak_f32 v38, v38, v28, 0xc0135761
    v_mfma_f32_32x32x16_bf16 v[100:115], v[80:83], v[152:155], v[100:115]
    s_waitcnt lgkmcnt(5)
    ds_read_b64_tr_b16 v[74:75], v18 offset:18944
    v_fmaak_f32 v39, v39, v28, 0xc0135761
    v_add_f32 v43, 1.0, v43
    v_rcp_f32 v42, v42
    v_mul_f32 v38, v38, v140
    v_mfma_f32_32x32x16_bf16 v[84:99], v[60:63], a[120:123], v[84:99]
    ds_read_b64_tr_b16 v[76:77], v18 offset:20480
    v_mul_f32 v39, v39, v141
    v_mul_f32 v42, v42, v138
    v_rcp_f32 v43, v43
    v_cvt_pk_bf16_f32 v54, v40, v41
    v_mfma_f32_32x32x16_bf16 v[100:115], v[60:63], v[156:159], v[100:115]
    s_waitcnt lgkmcnt(5)
    ds_read_b64_tr_b16 v[78:79], v18 offset:20992
    v_mul_f32 v43, v43, v139
    v_exp_f32 v38, v38
    v_mul_f32 v40, v142, v142
    v_mul_f32 v41, v143, v143
    v_mfma_f32_32x32x16_bf16 v[84:99], v[64:67], a[124:127], v[84:99]
    ds_read_b64_tr_b16 v[80:81], v18 offset:22528
    v_add_f32 v38, 1.0, v38
    v_exp_f32 v39, v39
    v_fmaak_f32 v40, v40, v28, 0xc0135761
    v_fmaak_f32 v41, v41, v28, 0xc0135761
    v_mfma_f32_32x32x16_bf16 v[100:115], v[64:67], v[160:163], v[100:115]
    s_waitcnt lgkmcnt(5)
    ds_read_b64_tr_b16 v[82:83], v18 offset:23040
    v_add_f32 v39, 1.0, v39
    v_rcp_f32 v38, v38
    v_mul_f32 v40, v40, v142
    v_mul_f32 v41, v41, v143
    v_mfma_f32_32x32x16_bf16 v[84:99], v[68:71], a[128:131], v[84:99]
    s_waitcnt vmcnt(11)
    s_barrier
    ds_read_b64_tr_b16 v[60:61], v233 offset:24576
    v_mul_f32 v38, v38, v140
    v_rcp_f32 v39, v39
    v_mfma_f32_32x32x16_bf16 v[100:115], v[68:71], v[164:167], v[100:115]
    s_waitcnt lgkmcnt(5)
    ds_read_b64_tr_b16 v[62:63], v233 offset:27136
    buffer_load_dword v29, v242, s[16:19], 0 offen sc1
    v_cvt_pk_bf16_f32 v55, v42, v43
    v_mfma_f32_32x32x16_bf16 v[84:99], v[72:75], a[132:135], v[84:99]
    ds_read_b64_tr_b16 v[64:65], v236 offset:24608
    buffer_load_dwordx4 v231, s[24:27], s54 offen offset:3072 lds
    buffer_store_dwordx4 v[52:55], v25, s[16:19], s42 offen offset:0 sc1
    ds_write_b128 v36, v[52:55] offset:0
    v_mul_f32 v39, v39, v141
    v_mfma_f32_32x32x16_bf16 v[100:115], v[72:75], v[168:171], v[100:115]
    s_waitcnt lgkmcnt(6)
    ds_read_b64_tr_b16 v[66:67], v236 offset:27168
    v_exp_f32 v40, v40
    v_mul_f32 v42, v144, v144
    v_mul_f32 v43, v145, v145
    v_add_f32 v40, 1.0, v40
    v_mfma_f32_32x32x16_bf16 v[84:99], v[76:79], a[136:139], v[84:99]
    s_add_u32 m0, s88, 69632
    ds_read_b64_tr_b16 v[68:69], v233 offset:24640
    buffer_load_dwordx4 v232, s[24:27], s54 offen offset:0 lds
    v_exp_f32 v41, v41
    v_fmaak_f32 v42, v42, v28, 0xc0135761
    v_fmaak_f32 v43, v43, v28, 0xc0135761
    v_mfma_f32_32x32x16_bf16 v[100:115], v[76:79], v[172:175], v[100:115]
    s_waitcnt lgkmcnt(6)
    ds_read_b64_tr_b16 v[70:71], v233 offset:27200
    v_add_f32 v41, 1.0, v41
    v_rcp_f32 v40, v40
    v_mul_f32 v42, v42, v144
    v_mul_f32 v43, v43, v145
    v_mfma_f32_32x32x16_bf16 v[84:99], v[80:83], a[140:143], v[84:99]
    ds_read_b64_tr_b16 v[72:73], v236 offset:24672
    v_mul_f32 v40, v40, v142
    v_rcp_f32 v41, v41
    v_cvt_pk_bf16_f32 v56, v38, v39
    v_mul_f32 v41, v41, v143
    v_mfma_f32_32x32x16_bf16 v[100:115], v[80:83], v[176:179], v[100:115]
    s_waitcnt lgkmcnt(6)
    ds_read_b64_tr_b16 v[74:75], v236 offset:27232
    v_exp_f32 v42, v42
    v_mul_f32 v38, v146, v146
    v_mul_f32 v39, v147, v147
    v_add_f32 v42, 1.0, v42
    v_mfma_f32_16x16x32_bf16 v[148:151], v[60:63], a[0:3], 0
    s_add_u32 s54, s51, 0
    v_exp_f32 v43, v43
    v_fmaak_f32 v38, v38, v28, 0xc0135761
    v_fmaak_f32 v39, v39, v28, 0xc0135761
    v_mfma_f32_16x16x32_bf16 v[152:155], v[60:63], a[144:147], 0
    s_waitcnt lgkmcnt(4)
    ds_read_b64_tr_b16 v[76:77], v233 offset:24704
    ds_read_b64_tr_b16 v[78:79], v233 offset:27264
    ds_read_b64_tr_b16 v[80:81], v236 offset:24736
    ds_read_b64_tr_b16 v[82:83], v236 offset:27296
    v_mfma_f32_16x16x32_bf16 v[156:159], v[64:67], a[0:3], 0
    s_add_u32 m0, s88, 86016
    v_add_f32 v43, 1.0, v43
    v_rcp_f32 v42, v42
    v_mul_f32 v38, v38, v146
    v_mfma_f32_16x16x32_bf16 v[160:163], v[64:67], a[144:147], 0
    s_waitcnt lgkmcnt(6)
    ds_read_b64_tr_b16 v[60:61], v233 offset:24768
    ds_read_b64_tr_b16 v[62:63], v233 offset:27328
    v_mfma_f32_16x16x32_bf16 v[164:167], v[68:71], a[0:3], 0
    buffer_load_dwordx4 v228, s[24:27], s54 offen offset:0 lds
    v_mul_f32 v39, v39, v147
    v_mul_f32 v42, v42, v144
    v_mfma_f32_16x16x32_bf16 v[168:171], v[68:71], a[144:147], 0
    s_waitcnt lgkmcnt(6)
    ds_read_b64_tr_b16 v[64:65], v236 offset:24800
    ds_read_b64_tr_b16 v[66:67], v236 offset:27360
    v_mfma_f32_16x16x32_bf16 v[172:175], v[72:75], a[0:3], 0
    buffer_load_dwordx4 v229, s[24:27], s54 offen offset:1024 lds
    v_rcp_f32 v43, v43
    v_cvt_pk_bf16_f32 v57, v40, v41
    v_mfma_f32_16x16x32_bf16 v[176:179], v[72:75], a[144:147], 0
    s_waitcnt lgkmcnt(6)
    ds_read_b64_tr_b16 v[68:69], v233 offset:24832
    ds_read_b64_tr_b16 v[70:71], v233 offset:27392
    v_mfma_f32_16x16x32_bf16 v[180:183], v[76:79], a[0:3], 0
    buffer_load_dwordx4 v230, s[24:27], s54 offen offset:2048 lds
    v_mul_f32 v43, v43, v145
    v_exp_f32 v38, v38
    v_mfma_f32_16x16x32_bf16 v[184:187], v[76:79], a[144:147], 0
    s_waitcnt lgkmcnt(6)
    ds_read_b64_tr_b16 v[72:73], v236 offset:24864
    ds_read_b64_tr_b16 v[74:75], v236 offset:27424
    v_mfma_f32_16x16x32_bf16 v[188:191], v[80:83], a[0:3], 0
    v_exp_f32 v39, v39
    v_add_f32 v38, 1.0, v38
    v_add_f32 v39, 1.0, v39
    v_mfma_f32_16x16x32_bf16 v[192:195], v[80:83], a[144:147], 0
    s_waitcnt lgkmcnt(6)
    ds_read_b64_tr_b16 v[76:77], v233 offset:34816
    ds_read_b64_tr_b16 v[78:79], v233 offset:37376
    v_mfma_f32_16x16x32_bf16 v[196:199], v[60:63], a[0:3], 0
    v_rcp_f32 v38, v38
    v_rcp_f32 v39, v39
    v_mfma_f32_16x16x32_bf16 v[200:203], v[60:63], a[144:147], 0
    s_waitcnt lgkmcnt(6)
    ds_read_b64_tr_b16 v[80:81], v236 offset:34848
    ds_read_b64_tr_b16 v[82:83], v236 offset:37408
    v_mfma_f32_16x16x32_bf16 v[204:207], v[64:67], a[0:3], 0
    buffer_load_dwordx4 v231, s[24:27], s54 offen offset:3072 lds
    v_mul_f32 v38, v38, v146
    v_cvt_pk_bf16_f32 v58, v42, v43
    v_mul_f32 v39, v39, v147
    v_mfma_f32_16x16x32_bf16 v[208:211], v[64:67], a[144:147], 0
    s_waitcnt lgkmcnt(6)
    ds_read_b64_tr_b16 v[60:61], v233 offset:34880
    ds_read_b64_tr_b16 v[62:63], v233 offset:37440
    v_mfma_f32_16x16x32_bf16 v[212:215], v[68:71], a[0:3], 0
    v_cvt_pk_bf16_f32 v59, v38, v39
    v_mfma_f32_16x16x32_bf16 v[216:219], v[68:71], a[144:147], 0
    s_waitcnt lgkmcnt(6)
    ds_read_b64_tr_b16 v[64:65], v236 offset:34912
    ds_read_b64_tr_b16 v[66:67], v236 offset:37472
    v_mfma_f32_16x16x32_bf16 v[220:223], v[72:75], a[0:3], 0
    s_add_u32 m0, s88, 90112
    buffer_store_dwordx4 v[56:59], v25, s[16:19], s42 offen offset:512 sc1
    ds_write_b128 v36, v[56:59] offset:512
    v_mfma_f32_16x16x32_bf16 v[224:227], v[72:75], a[144:147], 0
    s_waitcnt lgkmcnt(7)
    ds_read_b64_tr_b16 v[68:69], v233 offset:34944
    ds_read_b64_tr_b16 v[70:71], v233 offset:37504
    v_mfma_f32_16x16x32_bf16 v[148:151], v[76:79], a[4:7], v[148:151]
    buffer_load_dwordx4 v232, s[24:27], s54 offen offset:0 lds
    v_mul_f32 v38, v84, v84
    v_mul_f32 v39, v85, v85
    v_fmaak_f32 v38, v38, v28, 0xc0135761
    v_mfma_f32_16x16x32_bf16 v[152:155], v[76:79], a[148:151], v[152:155]
    s_waitcnt lgkmcnt(7)
    ds_read_b64_tr_b16 v[72:73], v236 offset:34976
    ds_read_b64_tr_b16 v[74:75], v236 offset:37536
    v_mfma_f32_16x16x32_bf16 v[156:159], v[80:83], a[4:7], v[156:159]
    v_fmaak_f32 v39, v39, v28, 0xc0135761
    v_mul_f32 v38, v38, v84
    v_mul_f32 v39, v39, v85
    v_mfma_f32_16x16x32_bf16 v[160:163], v[80:83], a[148:151], v[160:163]
    s_waitcnt lgkmcnt(7)
    ds_read_b64_tr_b16 v[76:77], v233 offset:35008
    ds_read_b64_tr_b16 v[78:79], v233 offset:37568
    v_mfma_f32_16x16x32_bf16 v[164:167], v[60:63], a[4:7], v[164:167]
    v_exp_f32 v38, v38
    v_mul_f32 v40, v86, v86
    v_mul_f32 v41, v87, v87
    v_mfma_f32_16x16x32_bf16 v[168:171], v[60:63], a[148:151], v[168:171]
    s_waitcnt lgkmcnt(7)
    ds_read_b64_tr_b16 v[80:81], v236 offset:35040
    ds_read_b64_tr_b16 v[82:83], v236 offset:37600
    v_mfma_f32_16x16x32_bf16 v[172:175], v[64:67], a[4:7], v[172:175]
    v_add_f32 v38, 1.0, v38
    v_exp_f32 v39, v39
    v_fmaak_f32 v40, v40, v28, 0xc0135761
    v_mfma_f32_16x16x32_bf16 v[176:179], v[64:67], a[148:151], v[176:179]
    s_waitcnt lgkmcnt(6)
    ds_read_b64_tr_b16 v[60:61], v233 offset:35072
    ds_read_b64_tr_b16 v[62:63], v233 offset:37632
    v_mfma_f32_16x16x32_bf16 v[180:183], v[68:71], a[4:7], v[180:183]
    v_fmaak_f32 v41, v41, v28, 0xc0135761
    v_add_f32 v39, 1.0, v39
    v_rcp_f32 v38, v38
    v_mfma_f32_16x16x32_bf16 v[184:187], v[68:71], a[148:151], v[184:187]
    s_waitcnt lgkmcnt(6)
    ds_read_b64_tr_b16 v[64:65], v236 offset:35104
    ds_read_b64_tr_b16 v[66:67], v236 offset:37664
    v_mfma_f32_16x16x32_bf16 v[188:191], v[72:75], a[4:7], v[188:191]
    v_mul_f32 v40, v40, v86
    v_mul_f32 v41, v41, v87
    v_mul_f32 v38, v38, v84
    v_mfma_f32_16x16x32_bf16 v[192:195], v[72:75], a[148:151], v[192:195]
    s_waitcnt lgkmcnt(6)
    s_waitcnt vmcnt(13)
    s_barrier
    s_waitcnt vmcnt(9)
    s_add_u32 s3, s60, 1
    v_subrev_u32 v23, s3, v29
    v_cmp_ge_u32 vcc, 6, v23
    s_and_b64 vcc, vcc, s[90:91]
    s_cmp_eq_u64 vcc, s[90:91]
    s_cbranch_scc0 L_spino1
L_backo1:
    ds_read_b64_tr_b16 v[68:69], v233 offset:45056
    ds_read_b64_tr_b16 v[70:71], v233 offset:47616
    v_mfma_f32_16x16x32_bf16 v[196:199], v[76:79], a[4:7], v[196:199]
    s_add_u32 s55, s80, 0
    ds_read_b128 a[16:19], v34 offset:64256
    buffer_load_dwordx4 a[24:27], v239, s[16:19], s55 offen offset:0 sc1
    v_rcp_f32 v39, v39
    v_mfma_f32_16x16x32_bf16 v[200:203], v[76:79], a[148:151], v[200:203]
    s_waitcnt lgkmcnt(7)
    ds_read_b64_tr_b16 v[72:73], v236 offset:45088
    ds_read_b64_tr_b16 v[74:75], v236 offset:47648
    v_mfma_f32_16x16x32_bf16 v[204:207], v[80:83], a[4:7], v[204:207]
    ds_read_b128 a[160:163], v34 offset:65280
    buffer_load_dwordx4 a[168:171], v239, s[16:19], s55 offen offset:1024 sc1
    v_nop
    v_mul_f32 v39, v39, v85
    v_mfma_f32_16x16x32_bf16 v[208:211], v[80:83], a[148:151], v[208:211]
    s_waitcnt lgkmcnt(8)
    ds_read_b64_tr_b16 v[76:77], v233 offset:45120
    ds_read_b64_tr_b16 v[78:79], v233 offset:47680
    v_mfma_f32_16x16x32_bf16 v[212:215], v[60:63], a[4:7], v[212:215]
    ds_read_b128 a[20:23], v35 offset:6912
    buffer_load_dwordx4 a[28:31], v240, s[16:19], s55 offen offset:0 sc1
    v_exp_f32 v40, v40
    v_mfma_f32_16x16x32_bf16 v[216:219], v[60:63], a[148:151], v[216:219]
    s_waitcnt lgkmcnt(9)
    ds_read_b64_tr_b16 v[80:81], v236 offset:45152
    ds_read_b64_tr_b16 v[82:83], v236 offset:47712
    v_mfma_f32_16x16x32_bf16 v[220:223], v[64:67], a[4:7], v[220:223]
    ds_read_b128 a[164:167], v35 offset:7936
    v_mul_f32 v42, v88, v88
    v_mul_f32 v43, v89, v89
    v_add_f32 v40, 1.0, v40
    v_mfma_f32_16x16x32_bf16 v[224:227], v[64:67], a[148:151], v[224:227]
    s_waitcnt lgkmcnt(10)
    ds_read_b64_tr_b16 v[60:61], v233 offset:45184
    ds_read_b64_tr_b16 v[62:63], v233 offset:47744
    v_mfma_f32_16x16x32_bf16 v[148:151], v[68:71], a[8:11], v[148:151]
    buffer_load_dwordx4 a[172:175], v240, s[16:19], s55 offen offset:1024 sc1
    v_exp_f32 v41, v41
    v_fmaak_f32 v42, v42, v28, 0xc0135761
    v_mfma_f32_16x16x32_bf16 v[152:155], v[68:71], a[152:155], v[152:155]
    s_waitcnt lgkmcnt(9)
    ds_read_b64_tr_b16 v[64:65], v236 offset:45216
    ds_read_b64_tr_b16 v[66:67], v236 offset:47776
    v_mfma_f32_16x16x32_bf16 v[156:159], v[72:75], a[8:11], v[156:159]
    v_fmaak_f32 v43, v43, v28, 0xc0135761
    v_add_f32 v41, 1.0, v41
    v_rcp_f32 v40, v40
    v_mfma_f32_16x16x32_bf16 v[160:163], v[72:75], a[152:155], v[160:163]
    s_waitcnt lgkmcnt(8)
    ds_read_b64_tr_b16 v[68:69], v233 offset:45248
    ds_read_b64_tr_b16 v[70:71], v233 offset:47808
    v_mfma_f32_16x16x32_bf16 v[164:167], v[76:79], a[8:11], v[164:167]
    s_add_u32 s54, s52, 0
    v_mul_f32 v42, v42, v88
    v_mul_f32 v43, v43, v89
    v_mul_f32 v40, v40, v86
    v_mfma_f32_16x16x32_bf16 v[168:171], v[76:79], a[152:155], v[168:171]
    s_waitcnt lgkmcnt(7)
    ds_read_b64_tr_b16 v[72:73], v236 offset:45280
    ds_read_b64_tr_b16 v[74:75], v236 offset:47840
    v_mfma_f32_16x16x32_bf16 v[172:175], v[80:83], a[8:11], v[172:175]
    s_add_u32 m0, s88, 0
    v_rcp_f32 v41, v41
    v_cvt_pk_bf16_f32 v44, v38, v39
    v_mul_f32 v41, v41, v87
    v_mfma_f32_16x16x32_bf16 v[176:179], v[80:83], a[152:155], v[176:179]
    s_waitcnt lgkmcnt(6)
    ds_read_b64_tr_b16 v[76:77], v233 offset:45312
    ds_read_b64_tr_b16 v[78:79], v233 offset:47872
    v_mfma_f32_16x16x32_bf16 v[180:183], v[60:63], a[8:11], v[180:183]
    buffer_load_dwordx4 v228, s[24:27], s54 offen offset:0 lds
    v_exp_f32 v42, v42
    v_mul_f32 v38, v90, v90
    v_mfma_f32_16x16x32_bf16 v[184:187], v[60:63], a[152:155], v[184:187]
    s_waitcnt lgkmcnt(6)
    ds_read_b64_tr_b16 v[80:81], v236 offset:45344
    ds_read_b64_tr_b16 v[82:83], v236 offset:47904
    v_mfma_f32_16x16x32_bf16 v[188:191], v[64:67], a[8:11], v[188:191]
    s_add_u32 s55, s81, 0
    buffer_load_dwordx4 a[32:35], v239, s[16:19], s55 offen offset:0 sc1
    v_mul_f32 v39, v91, v91
    v_add_f32 v42, 1.0, v42
    v_mfma_f32_16x16x32_bf16 v[192:195], v[64:67], a[152:155], v[192:195]
    s_waitcnt lgkmcnt(6)
    ds_read_b64_tr_b16 v[60:61], v233 offset:55296
    ds_read_b64_tr_b16 v[62:63], v233 offset:57856
    v_mfma_f32_16x16x32_bf16 v[196:199], v[68:71], a[8:11], v[196:199]
    v_exp_f32 v43, v43
    v_fmaak_f32 v38, v38, v28, 0xc0135761
    v_fmaak_f32 v39, v39, v28, 0xc0135761
    v_mfma_f32_16x16x32_bf16 v[200:203], v[68:71], a[152:155], v[200:203]
    s_waitcnt lgkmcnt(6)
    ds_read_b64_tr_b16 v[64:65], v236 offset:55328
    ds_read_b64_tr_b16 v[66:67], v236 offset:57888
    v_mfma_f32_16x16x32_bf16 v[204:207], v[72:75], a[8:11], v[204:207]
    buffer_load_dwordx4 v229, s[24:27], s54 offen offset:1024 lds
    v_add_f32 v43, 1.0, v43
    v_rcp_f32 v42, v42
    v_mfma_f32_16x16x32_bf16 v[208:211], v[72:75], a[152:155], v[208:211]
    s_waitcnt lgkmcnt(6)
    ds_read_b64_tr_b16 v[68:69], v233 offset:55360
    ds_read_b64_tr_b16 v[70:71], v233 offset:57920
    v_mfma_f32_16x16x32_bf16 v[212:215], v[76:79], a[8:11], v[212:215]
    v_mul_f32 v38, v38, v90
    v_mul_f32 v39, v39, v91
    v_mul_f32 v42, v42, v88
    v_mfma_f32_16x16x32_bf16 v[216:219], v[76:79], a[152:155], v[216:219]
    s_waitcnt lgkmcnt(6)
    ds_read_b64_tr_b16 v[72:73], v236 offset:55392
    ds_read_b64_tr_b16 v[74:75], v236 offset:57952
    v_mfma_f32_16x16x32_bf16 v[220:223], v[80:83], a[8:11], v[220:223]
    buffer_load_dwordx4 a[176:179], v239, s[16:19], s55 offen offset:1024 sc1
    v_rcp_f32 v43, v43
    v_cvt_pk_bf16_f32 v45, v40, v41
    v_mfma_f32_16x16x32_bf16 v[224:227], v[80:83], a[152:155], v[224:227]
    s_waitcnt lgkmcnt(6)
    ds_read_b64_tr_b16 v[76:77], v233 offset:55424
    ds_read_b64_tr_b16 v[78:79], v233 offset:57984
    v_mfma_f32_16x16x32_bf16 v[148:151], v[60:63], a[12:15], v[148:151]
    v_mul_f32 v43, v43, v89
    v_exp_f32 v38, v38
    v_mul_f32 v40, v92, v92
    v_mfma_f32_16x16x32_bf16 v[152:155], v[60:63], a[156:159], v[152:155]
    s_waitcnt lgkmcnt(6)
    ds_read_b64_tr_b16 v[80:81], v236 offset:55456
    ds_read_b64_tr_b16 v[82:83], v236 offset:58016
    v_mfma_f32_16x16x32_bf16 v[156:159], v[64:67], a[12:15], v[156:159]
    buffer_load_dwordx4 v230, s[24:27], s54 offen offset:2048 lds
    v_mul_f32 v41, v93, v93
    v_add_f32 v38, 1.0, v38
    v_mfma_f32_16x16x32_bf16 v[160:163], v[64:67], a[156:159], v[160:163]
    s_waitcnt lgkmcnt(6)
    ds_read_b64_tr_b16 v[60:61], v233 offset:55488
    ds_read_b64_tr_b16 v[62:63], v233 offset:58048
    v_mfma_f32_16x16x32_bf16 v[164:167], v[68:71], a[12:15], v[164:167]
    v_exp_f32 v39, v39
    v_fmaak_f32 v40, v40, v28, 0xc0135761
    v_fmaak_f32 v41, v41, v28, 0xc0135761
    v_mfma_f32_16x16x32_bf16 v[168:171], v[68:71], a[156:159], v[168:171]
    s_waitcnt lgkmcnt(6)
    ds_read_b64_tr_b16 v[64:65], v236 offset:55520
    ds_read_b64_tr_b16 v[66:67], v236 offset:58080
    v_mfma_f32_16x16x32_bf16 v[172:175], v[72:75], a[12:15], v[172:175]
    buffer_load_dwordx4 a[36:39], v240, s[16:19], s55 offen offset:0 sc1
    v_add_f32 v39, 1.0, v39
    v_rcp_f32 v38, v38
    v_mfma_f32_16x16x32_bf16 v[176:179], v[72:75], a[156:159], v[176:179]
    s_waitcnt lgkmcnt(6)
    ds_read_b64_tr_b16 v[68:69], v233 offset:55552
    ds_read_b64_tr_b16 v[70:71], v233 offset:58112
    v_mfma_f32_16x16x32_bf16 v[180:183], v[76:79], a[12:15], v[180:183]
    v_mul_f32 v40, v40, v92
    v_mul_f32 v41, v41, v93
    v_mul_f32 v38, v38, v90
    v_mfma_f32_16x16x32_bf16 v[184:187], v[76:79], a[156:159], v[184:187]
    s_waitcnt lgkmcnt(6)
    ds_read_b64_tr_b16 v[72:73], v236 offset:55584
    ds_read_b64_tr_b16 v[74:75], v236 offset:58144
    v_mfma_f32_16x16x32_bf16 v[188:191], v[80:83], a[12:15], v[188:191]
    v_rcp_f32 v39, v39
    v_cvt_pk_bf16_f32 v46, v42, v43
    v_mul_f32 v39, v39, v91
    v_mfma_f32_16x16x32_bf16 v[192:195], v[80:83], a[156:159], v[192:195]
    s_waitcnt lgkmcnt(6)
    s_waitcnt vmcnt(16)
    s_barrier
    ds_read_b64_tr_b16 v[76:77], v234 offset:0
    ds_read_b64_tr_b16 v[78:79], v234 offset:2560
    v_mfma_f32_16x16x32_bf16 v[196:199], v[60:63], a[12:15], v[196:199]
    buffer_load_dwordx4 v231, s[24:27], s54 offen offset:3072 lds
    v_exp_f32 v40, v40
    v_mul_f32 v42, v94, v94
    v_mfma_f32_16x16x32_bf16 v[200:203], v[60:63], a[156:159], v[200:203]
    s_waitcnt lgkmcnt(6)
    ds_read_b64_tr_b16 v[80:81], v237 offset:32
    ds_read_b64_tr_b16 v[82:83], v237 offset:2592
    v_mfma_f32_16x16x32_bf16 v[204:207], v[64:67], a[12:15], v[204:207]
    v_mul_f32 v43, v95, v95
    v_add_f32 v40, 1.0, v40
    v_exp_f32 v41, v41
    v_mfma_f32_16x16x32_bf16 v[208:211], v[64:67], a[156:159], v[208:211]
    s_waitcnt lgkmcnt(6)
    ds_read_b64_tr_b16 v[60:61], v234 offset:64
    ds_read_b64_tr_b16 v[62:63], v234 offset:2624
    v_mfma_f32_16x16x32_bf16 v[212:215], v[68:71], a[12:15], v[212:215]
    buffer_load_dwordx4 a[180:183], v240, s[16:19], s55 offen offset:1024 sc1
    v_fmaak_f32 v42, v42, v28, 0xc0135761
    v_fmaak_f32 v43, v43, v28, 0xc0135761
    v_add_f32 v41, 1.0, v41
    v_mfma_f32_16x16x32_bf16 v[216:219], v[68:71], a[156:159], v[216:219]
    s_waitcnt lgkmcnt(6)
    ds_read_b64_tr_b16 v[64:65], v237 offset:96
    ds_read_b64_tr_b16 v[66:67], v237 offset:2656
    v_mfma_f32_16x16x32_bf16 v[220:223], v[72:75], a[12:15], v[220:223]
    v_rcp_f32 v40, v40
    v_mul_f32 v42, v42, v94
    v_mul_f32 v43, v43, v95
    s_add_u32 s46, s47, 113408
    v_mfma_f32_16x16x32_bf16 v[224:227], v[72:75], a[156:159], v[224:227]
    s_waitcnt lgkmcnt(6)
    ds_read_b64_tr_b16 v[68:69], v234 offset:128
    ds_read_b64_tr_b16 v[70:71], v234 offset:2688
    v_mfma_f32_16x16x32_bf16 v[148:151], v[76:79], a[16:19], v[148:151]
    s_add_u32 m0, s88, 4096
    v_add_u32 v22, s46, v24
    v_add_u32 v36, s46, v25
    v_mul_f32 v40, v40, v92
    v_mfma_f32_16x16x32_bf16 v[152:155], v[76:79], a[160:163], v[152:155]
    s_waitcnt lgkmcnt(6)
    ds_read_b64_tr_b16 v[72:73], v237 offset:160
    ds_read_b64_tr_b16 v[74:75], v237 offset:2720
    v_mfma_f32_16x16x32_bf16 v[156:159], v[80:83], a[16:19], v[156:159]
    buffer_load_dwordx4 v232, s[24:27], s54 offen offset:0 lds
    v_rcp_f32 v41, v41
    v_cvt_pk_bf16_f32 v47, v38, v39
    v_mfma_f32_16x16x32_bf16 v[160:163], v[80:83], a[160:163], v[160:163]
    s_waitcnt lgkmcnt(6)
    ds_read_b64_tr_b16 v[76:77], v234 offset:192
    ds_read_b64_tr_b16 v[78:79], v234 offset:2752
    v_mfma_f32_16x16x32_bf16 v[164:167], v[60:63], a[16:19], v[164:167]
    s_add_u32 s54, s53, 0
    buffer_store_dwordx4 v[44:47], v24, s[16:19], s43 offen offset:0 sc1
    ds_write_b128 v22, v[44:47] offset:0
    v_mul_f32 v41, v41, v93
    v_mfma_f32_16x16x32_bf16 v[168:171], v[60:63], a[160:163], v[168:171]
    s_waitcnt lgkmcnt(7)
    ds_read_b64_tr_b16 v[80:81], v237 offset:224
    ds_read_b64_tr_b16 v[82:83], v237 offset:2784
    v_mfma_f32_16x16x32_bf16 v[172:175], v[64:67], a[16:19], v[172:175]
    s_add_u32 m0, s88, 20480
    v_exp_f32 v42, v42
    v_mul_f32 v38, v96, v96
    v_mul_f32 v39, v97, v97
    v_mfma_f32_16x16x32_bf16 v[176:179], v[64:67], a[160:163], v[176:179]
    s_waitcnt lgkmcnt(7)
    ds_read_b64_tr_b16 v[60:61], v234 offset:256
    ds_read_b64_tr_b16 v[62:63], v234 offset:2816
    v_mfma_f32_16x16x32_bf16 v[180:183], v[68:71], a[16:19], v[180:183]
    buffer_load_dwordx4 v228, s[24:27], s54 offen offset:0 lds
    v_add_f32 v42, 1.0, v42
    v_exp_f32 v43, v43
    v_mfma_f32_16x16x32_bf16 v[184:187], v[68:71], a[160:163], v[184:187]
    s_waitcnt lgkmcnt(7)
    ds_read_b64_tr_b16 v[64:65], v237 offset:288
    ds_read_b64_tr_b16 v[66:67], v237 offset:2848
    v_mfma_f32_16x16x32_bf16 v[188:191], v[72:75], a[16:19], v[188:191]
    s_add_u32 s55, s82, 0
    buffer_load_dwordx4 a[40:43], v239, s[16:19], s55 offen offset:0 sc1
    v_fmaak_f32 v38, v38, v28, 0xc0135761
    v_fmaak_f32 v39, v39, v28, 0xc0135761
    v_add_f32 v43, 1.0, v43
    v_mfma_f32_16x16x32_bf16 v[192:195], v[72:75], a[160:163], v[192:195]
    s_waitcnt lgkmcnt(7)
    ds_read_b64_tr_b16 v[68:69], v234 offset:10240
    ds_read_b64_tr_b16 v[70:71], v234 offset:12800
    v_mfma_f32_16x16x32_bf16 v[196:199], v[76:79], a[16:19], v[196:199]
    v_rcp_f32 v42, v42
    v_mul_f32 v38, v38, v96
    v_mul_f32 v39, v39, v97
    v_mfma_f32_16x16x32_bf16 v[200:203], v[76:79], a[160:163], v[200:203]
    s_waitcnt lgkmcnt(6)
    ds_read_b64_tr_b16 v[72:73], v237 offset:10272
    ds_read_b64_tr_b16 v[74:75], v237 offset:12832
    v_mfma_f32_16x16x32_bf16 v[204:207], v[80:83], a[16:19], v[204:207]
    buffer_load_dwordx4 v229, s[24:27], s54 offen offset:1024 lds
    v_mul_f32 v42, v42, v94
    v_rcp_f32 v43, v43
    v_mfma_f32_16x16x32_bf16 v[208:211], v[80:83], a[160:163], v[208:211]
    s_waitcnt lgkmcnt(6)
    ds_read_b64_tr_b16 v[76:77], v234 offset:10304
    ds_read_b64_tr_b16 v[78:79], v234 offset:12864
    v_mfma_f32_16x16x32_bf16 v[212:215], v[60:63], a[16:19], v[212:215]
    v_cvt_pk_bf16_f32 v48, v40, v41
    v_mul_f32 v43, v43, v95
    v_exp_f32 v38, v38
    v_mfma_f32_16x16x32_bf16 v[216:219], v[60:63], a[160:163], v[216:219]
    s_waitcnt lgkmcnt(6)
    ds_read_b64_tr_b16 v[80:81], v237 offset:10336
    ds_read_b64_tr_b16 v[82:83], v237 offset:12896
    v_mfma_f32_16x16x32_bf16 v[220:223], v[64:67], a[16:19], v[220:223]
    buffer_load_dwordx4 a[184:187], v239, s[16:19], s55 offen offset:1024 sc1
    v_mul_f32 v40, v98, v98
    v_mul_f32 v41, v99, v99
    v_add_f32 v38, 1.0, v38
    v_mfma_f32_16x16x32_bf16 v[224:227], v[64:67], a[160:163], v[224:227]
    s_waitcnt lgkmcnt(6)
    ds_read_b64_tr_b16 v[60:61], v234 offset:10368
    ds_read_b64_tr_b16 v[62:63], v234 offset:12928
    v_mfma_f32_16x16x32_bf16 v[148:151], v[68:71], a[20:23], v[148:151]
    v_exp_f32 v39, v39
    v_fmaak_f32 v40, v40, v28, 0xc0135761
    v_fmaak_f32 v41, v41, v28, 0xc0135761
    v_mfma_f32_16x16x32_bf16 v[152:155], v[68:71], a[164:167], v[152:155]
    s_waitcnt lgkmcnt(6)
    ds_read_b64_tr_b16 v[64:65], v237 offset:10400
    ds_read_b64_tr_b16 v[66:67], v237 offset:12960
    v_mfma_f32_16x16x32_bf16 v[156:159], v[72:75], a[20:23], v[156:159]
    buffer_load_dwordx4 v230, s[24:27], s54 offen offset:2048 lds
    v_add_f32 v39, 1.0, v39
    v_rcp_f32 v38, v38
    v_mfma_f32_16x16x32_bf16 v[160:163], v[72:75], a[164:167], v[160:163]
    s_waitcnt lgkmcnt(6)
    ds_read_b64_tr_b16 v[68:69], v234 offset:10432
    ds_read_b64_tr_b16 v[70:71], v234 offset:12992
    v_mfma_f32_16x16x32_bf16 v[164:167], v[76:79], a[20:23], v[164:167]
    v_mul_f32 v40, v40, v98
    v_mul_f32 v41, v41, v99
    v_mul_f32 v38, v38, v96
    v_mfma_f32_16x16x32_bf16 v[168:171], v[76:79], a[164:167], v[168:171]
    s_waitcnt lgkmcnt(6)
    ds_read_b64_tr_b16 v[72:73], v237 offset:10464
    ds_read_b64_tr_b16 v[74:75], v237 offset:13024
    v_mfma_f32_16x16x32_bf16 v[172:175], v[80:83], a[20:23], v[172:175]
    buffer_load_dwordx4 a[44:47], v240, s[16:19], s55 offen offset:0 sc1
    v_rcp_f32 v39, v39
    v_cvt_pk_bf16_f32 v49, v42, v43
    v_mfma_f32_16x16x32_bf16 v[176:179], v[80:83], a[164:167], v[176:179]
    s_waitcnt lgkmcnt(6)
    ds_read_b64_tr_b16 v[76:77], v234 offset:10496
    ds_read_b64_tr_b16 v[78:79], v234 offset:13056
    v_mfma_f32_16x16x32_bf16 v[180:183], v[60:63], a[20:23], v[180:183]
    v_mul_f32 v39, v39, v97
    v_exp_f32 v40, v40
    v_mul_f32 v42, v100, v100
    v_mfma_f32_16x16x32_bf16 v[184:187], v[60:63], a[164:167], v[184:187]
    s_waitcnt lgkmcnt(6)
    ds_read_b64_tr_b16 v[80:81], v237 offset:10528
    ds_read_b64_tr_b16 v[82:83], v237 offset:13088
    v_mfma_f32_16x16x32_bf16 v[188:191], v[64:67], a[20:23], v[188:191]
    buffer_load_dwordx4 v231, s[24:27], s54 offen offset:3072 lds
    v_mul_f32 v43, v101, v101
    v_add_f32 v40, 1.0, v40
    v_mfma_f32_16x16x32_bf16 v[192:195], v[64:67], a[164:167], v[192:195]
    s_waitcnt lgkmcnt(6)
    s_waitcnt vmcnt(21)
    s_barrier
    ds_read_b64_tr_b16 v[60:61], v234 offset:20480
    ds_read_b64_tr_b16 v[62:63], v234 offset:23040
    v_mfma_f32_16x16x32_bf16 v[196:199], v[68:71], a[20:23], v[196:199]
    v_exp_f32 v41, v41
    v_fmaak_f32 v42, v42, v28, 0xc0135761
    v_fmaak_f32 v43, v43, v28, 0xc0135761
    v_mfma_f32_16x16x32_bf16 v[200:203], v[68:71], a[164:167], v[200:203]
    s_waitcnt lgkmcnt(6)
    ds_read_b64_tr_b16 v[64:65], v237 offset:20512
    ds_read_b64_tr_b16 v[66:67], v237 offset:23072
    v_mfma_f32_16x16x32_bf16 v[204:207], v[72:75], a[20:23], v[204:207]
    v_add_f32 v41, 1.0, v41
    v_rcp_f32 v40, v40
    v_mul_f32 v42, v42, v100
    v_mfma_f32_16x16x32_bf16 v[208:211], v[72:75], a[164:167], v[208:211]
    s_waitcnt lgkmcnt(6)
    ds_read_b64_tr_b16 v[68:69], v234 offset:20544
    ds_read_b64_tr_b16 v[70:71], v234 offset:23104
    v_mfma_f32_16x16x32_bf16 v[212:215], v[76:79], a[20:23], v[212:215]
    buffer_load_dwordx4 a[188:191], v240, s[16:19], s55 offen offset:1024 sc1
    v_mul_f32 v43, v43, v101
    v_mul_f32 v40, v40, v98
    v_mfma_f32_16x16x32_bf16 v[216:219], v[76:79], a[164:167], v[216:219]
    s_waitcnt lgkmcnt(6)
    ds_read_b64_tr_b16 v[72:73], v237 offset:20576
    ds_read_b64_tr_b16 v[74:75], v237 offset:23136
    v_mfma_f32_16x16x32_bf16 v[220:223], v[80:83], a[20:23], v[220:223]
    v_rcp_f32 v41, v41
    v_cvt_pk_bf16_f32 v50, v38, v39
    v_mul_f32 v41, v41, v99
    v_mfma_f32_16x16x32_bf16 v[224:227], v[80:83], a[164:167], v[224:227]
    s_waitcnt vmcnt(20) lgkmcnt(6)
    ds_read_b64_tr_b16 v[76:77], v234 offset:20608
    ds_read_b64_tr_b16 v[78:79], v234 offset:23168
    v_mfma_f32_16x16x32_bf16 v[148:151], v[60:63], a[24:27], v[148:151]
    s_add_u32 m0, s88, 24576
    v_exp_f32 v42, v42
    v_mul_f32 v38, v102, v102
    v_mul_f32 v39, v103, v103
    v_mfma_f32_16x16x32_bf16 v[152:155], v[60:63], a[168:171], v[152:155]
    s_waitcnt lgkmcnt(6)
    ds_read_b64_tr_b16 v[80:81], v237 offset:20640
    ds_read_b64_tr_b16 v[82:83], v237 offset:23200
    v_mfma_f32_16x16x32_bf16 v[156:159], v[64:67], a[24:27], v[156:159]
    buffer_load_dwordx4 v232, s[24:27], s54 offen offset:0 lds
    v_add_f32 v42, 1.0, v42
    v_exp_f32 v43, v43
    v_mfma_f32_16x16x32_bf16 v[160:163], v[64:67], a[168:171], v[160:163]
    s_waitcnt lgkmcnt(6)
    ds_read_b64_tr_b16 v[60:61], v234 offset:20672
    ds_read_b64_tr_b16 v[62:63], v234 offset:23232
    v_mfma_f32_16x16x32_bf16 v[164:167], v[68:71], a[24:27], v[164:167]
    s_add_u32 s54, s51, 73728
    v_fmaak_f32 v38, v38, v28, 0xc0135761
    v_fmaak_f32 v39, v39, v28, 0xc0135761
    v_add_f32 v43, 1.0, v43
    v_mfma_f32_16x16x32_bf16 v[168:171], v[68:71], a[168:171], v[168:171]
    s_waitcnt lgkmcnt(6)
    ds_read_b64_tr_b16 v[64:65], v237 offset:20704
    ds_read_b64_tr_b16 v[66:67], v237 offset:23264
    v_mfma_f32_16x16x32_bf16 v[172:175], v[72:75], a[24:27], v[172:175]
    s_add_u32 m0, s88, 40960
    v_rcp_f32 v42, v42
    v_mul_f32 v38, v38, v102
    v_mul_f32 v39, v39, v103
    v_mfma_f32_16x16x32_bf16 v[176:179], v[72:75], a[168:171], v[176:179]
    s_waitcnt lgkmcnt(6)
    ds_read_b64_tr_b16 v[68:69], v234 offset:20736
    ds_read_b64_tr_b16 v[70:71], v234 offset:23296
    v_mfma_f32_16x16x32_bf16 v[180:183], v[76:79], a[24:27], v[180:183]
    buffer_load_dwordx4 v228, s[24:27], s54 offen offset:0 lds
    v_mul_f32 v42, v42, v100
    v_rcp_f32 v43, v43
    v_mfma_f32_16x16x32_bf16 v[184:187], v[76:79], a[168:171], v[184:187]
    s_waitcnt lgkmcnt(6)
    ds_read_b64_tr_b16 v[72:73], v237 offset:20768
    ds_read_b64_tr_b16 v[74:75], v237 offset:23328
    v_mfma_f32_16x16x32_bf16 v[188:191], v[80:83], a[24:27], v[188:191]
    s_add_u32 s55, s80, 16384
    buffer_load_dwordx4 a[48:51], v239, s[16:19], s55 offen offset:0 sc1
    v_cvt_pk_bf16_f32 v51, v40, v41
    v_mfma_f32_16x16x32_bf16 v[192:195], v[80:83], a[168:171], v[192:195]
    s_waitcnt lgkmcnt(6)
    ds_read_b64_tr_b16 v[76:77], v234 offset:30720
    ds_read_b64_tr_b16 v[78:79], v234 offset:33280
    v_mfma_f32_16x16x32_bf16 v[196:199], v[60:63], a[24:27], v[196:199]
    buffer_store_dwordx4 v[48:51], v24, s[16:19], s43 offen offset:512 sc1
    ds_write_b128 v22, v[48:51] offset:512
    buffer_load_dwordx4 v229, s[24:27], s54 offen offset:1024 lds
    v_mul_f32 v43, v43, v101
    v_mfma_f32_16x16x32_bf16 v[200:203], v[60:63], a[168:171], v[200:203]
    s_waitcnt lgkmcnt(7)
    ds_read_b64_tr_b16 v[80:81], v237 offset:30752
    ds_read_b64_tr_b16 v[82:83], v237 offset:33312
    v_mfma_f32_16x16x32_bf16 v[204:207], v[64:67], a[24:27], v[204:207]
    v_exp_f32 v38, v38
    v_mul_f32 v40, v104, v104
    v_mul_f32 v41, v105, v105
    v_mfma_f32_16x16x32_bf16 v[208:211], v[64:67], a[168:171], v[208:211]
    s_waitcnt lgkmcnt(7)
    ds_read_b64_tr_b16 v[60:61], v234 offset:30784
    ds_read_b64_tr_b16 v[62:63], v234 offset:33344
    v_mfma_f32_16x16x32_bf16 v[212:215], v[68:71], a[24:27], v[212:215]
    v_add_f32 v38, 1.0, v38
    v_exp_f32 v39, v39
    v_fmaak_f32 v40, v40, v28, 0xc0135761
    v_mfma_f32_16x16x32_bf16 v[216:219], v[68:71], a[168:171], v[216:219]
    s_waitcnt lgkmcnt(7)
    ds_read_b64_tr_b16 v[64:65], v237 offset:30816
    ds_read_b64_tr_b16 v[66:67], v237 offset:33376
    v_mfma_f32_16x16x32_bf16 v[220:223], v[72:75], a[24:27], v[220:223]
    buffer_load_dwordx4 a[192:195], v239, s[16:19], s55 offen offset:1024 sc1
    v_fmaak_f32 v41, v41, v28, 0xc0135761
    v_add_f32 v39, 1.0, v39
    v_mfma_f32_16x16x32_bf16 v[224:227], v[72:75], a[168:171], v[224:227]
    s_waitcnt vmcnt(24) lgkmcnt(7)
    ds_read_b64_tr_b16 v[68:69], v234 offset:30848
    ds_read_b64_tr_b16 v[70:71], v234 offset:33408
    v_mfma_f32_16x16x32_bf16 v[148:151], v[76:79], a[28:31], v[148:151]
    v_rcp_f32 v38, v38
    v_mul_f32 v40, v40, v104
    v_mul_f32 v41, v41, v105
    v_mfma_f32_16x16x32_bf16 v[152:155], v[76:79], a[172:175], v[152:155]
    s_waitcnt lgkmcnt(6)
    ds_read_b64_tr_b16 v[72:73], v237 offset:30880
    ds_read_b64_tr_b16 v[74:75], v237 offset:33440
    v_mfma_f32_16x16x32_bf16 v[156:159], v[80:83], a[28:31], v[156:159]
    buffer_load_dwordx4 v230, s[24:27], s54 offen offset:2048 lds
    v_mul_f32 v38, v38, v102
    v_rcp_f32 v39, v39
    v_mfma_f32_16x16x32_bf16 v[160:163], v[80:83], a[172:175], v[160:163]
    s_waitcnt lgkmcnt(6)
    ds_read_b64_tr_b16 v[76:77], v234 offset:30912
    ds_read_b64_tr_b16 v[78:79], v234 offset:33472
    v_mfma_f32_16x16x32_bf16 v[164:167], v[60:63], a[28:31], v[164:167]
    v_cvt_pk_bf16_f32 v52, v42, v43
    v_mul_f32 v39, v39, v103
    v_exp_f32 v40, v40
    v_mfma_f32_16x16x32_bf16 v[168:171], v[60:63], a[172:175], v[168:171]
    s_waitcnt lgkmcnt(6)
    ds_read_b64_tr_b16 v[80:81], v237 offset:30944
    ds_read_b64_tr_b16 v[82:83], v237 offset:33504
    v_mfma_f32_16x16x32_bf16 v[172:175], v[64:67], a[28:31], v[172:175]
    buffer_load_dwordx4 a[52:55], v240, s[16:19], s55 offen offset:0 sc1
    v_mul_f32 v42, v106, v106
    v_mul_f32 v43, v107, v107
    v_add_f32 v40, 1.0, v40
    v_mfma_f32_16x16x32_bf16 v[176:179], v[64:67], a[172:175], v[176:179]
    s_waitcnt lgkmcnt(6)
    ds_read_b64_tr_b16 v[60:61], v234 offset:30976
    ds_read_b64_tr_b16 v[62:63], v234 offset:33536
    v_mfma_f32_16x16x32_bf16 v[180:183], v[68:71], a[28:31], v[180:183]
    v_exp_f32 v41, v41
    v_fmaak_f32 v42, v42, v28, 0xc0135761
    v_fmaak_f32 v43, v43, v28, 0xc0135761
    v_mfma_f32_16x16x32_bf16 v[184:187], v[68:71], a[172:175], v[184:187]
    s_waitcnt lgkmcnt(6)
    ds_read_b64_tr_b16 v[64:65], v237 offset:31008
    ds_read_b64_tr_b16 v[66:67], v237 offset:33568
    v_mfma_f32_16x16x32_bf16 v[188:191], v[72:75], a[28:31], v[188:191]
    buffer_load_dwordx4 v231, s[24:27], s54 offen offset:3072 lds
    v_add_f32 v41, 1.0, v41
    v_rcp_f32 v40, v40
    v_mfma_f32_16x16x32_bf16 v[192:195], v[72:75], a[172:175], v[192:195]
    s_waitcnt lgkmcnt(6)
    s_waitcnt vmcnt(18)
    s_barrier
    ds_read_b64_tr_b16 v[68:69], v233 offset:0
    ds_read_b64_tr_b16 v[70:71], v233 offset:2560
    v_mfma_f32_16x16x32_bf16 v[196:199], v[76:79], a[28:31], v[196:199]
    v_mul_f32 v42, v42, v106
    v_mul_f32 v43, v43, v107
    v_mul_f32 v40, v40, v104
    v_mfma_f32_16x16x32_bf16 v[200:203], v[76:79], a[172:175], v[200:203]
    s_waitcnt lgkmcnt(6)
    ds_read_b64_tr_b16 v[72:73], v236 offset:32
    ds_read_b64_tr_b16 v[74:75], v236 offset:2592
    v_mfma_f32_16x16x32_bf16 v[204:207], v[80:83], a[28:31], v[204:207]
    buffer_load_dwordx4 a[196:199], v240, s[16:19], s55 offen offset:1024 sc1
    v_rcp_f32 v41, v41
    v_cvt_pk_bf16_f32 v53, v38, v39
    v_mfma_f32_16x16x32_bf16 v[208:211], v[80:83], a[172:175], v[208:211]
    s_waitcnt lgkmcnt(6)
    ds_read_b64_tr_b16 v[76:77], v233 offset:64
    ds_read_b64_tr_b16 v[78:79], v233 offset:2624
    v_mfma_f32_16x16x32_bf16 v[212:215], v[60:63], a[28:31], v[212:215]
    v_mul_f32 v41, v41, v105
    v_exp_f32 v42, v42
    v_mul_f32 v38, v108, v108
    v_mfma_f32_16x16x32_bf16 v[216:219], v[60:63], a[172:175], v[216:219]
    s_waitcnt lgkmcnt(6)
    ds_read_b64_tr_b16 v[80:81], v236 offset:96
    ds_read_b64_tr_b16 v[82:83], v236 offset:2656
    v_mfma_f32_16x16x32_bf16 v[220:223], v[64:67], a[28:31], v[220:223]
    v_mul_f32 v39, v109, v109
    v_add_f32 v42, 1.0, v42
    v_exp_f32 v43, v43
    v_mfma_f32_16x16x32_bf16 v[224:227], v[64:67], a[172:175], v[224:227]
    s_waitcnt lgkmcnt(6)
    ds_read_b64_tr_b16 v[60:61], v233 offset:128
    ds_read_b64_tr_b16 v[62:63], v233 offset:2688
    v_mfma_f32_16x16x32_bf16 v[148:151], v[68:71], a[32:35], v[148:151]
    s_add_u32 m0, s88, 45056
    v_fmaak_f32 v38, v38, v28, 0xc0135761
    v_fmaak_f32 v39, v39, v28, 0xc0135761
    v_add_f32 v43, 1.0, v43
    v_mfma_f32_16x16x32_bf16 v[152:155], v[68:71], a[176:179], v[152:155]
    s_waitcnt lgkmcnt(6)
    ds_read_b64_tr_b16 v[64:65], v236 offset:160
    ds_read_b64_tr_b16 v[66:67], v236 offset:2720
    v_mfma_f32_16x16x32_bf16 v[156:159], v[72:75], a[32:35], v[156:159]
    s_lshl_b32 s76, s57, 2
    buffer_load_dwordx4 v232, s[24:27], s54 offen offset:0 lds
    v_rcp_f32 v42, v42
    v_mul_f32 v38, v38, v108
    v_mfma_f32_16x16x32_bf16 v[160:163], v[72:75], a[176:179], v[160:163]
    s_waitcnt lgkmcnt(6)
    ds_read_b64_tr_b16 v[68:69], v233 offset:192
    ds_read_b64_tr_b16 v[70:71], v233 offset:2752
    v_mfma_f32_16x16x32_bf16 v[164:167], v[76:79], a[32:35], v[164:167]
    s_add_u32 s54, s52, 73728
    v_mul_f32 v39, v39, v109
    v_mul_f32 v42, v42, v106
    v_rcp_f32 v43, v43
    v_mfma_f32_16x16x32_bf16 v[168:171], v[76:79], a[176:179], v[168:171]
    s_waitcnt lgkmcnt(6)
    ds_read_b64_tr_b16 v[72:73], v236 offset:224
    ds_read_b64_tr_b16 v[74:75], v236 offset:2784
    v_mfma_f32_16x16x32_bf16 v[172:175], v[80:83], a[32:35], v[172:175]
    s_add_u32 m0, s88, 142080
    v_cvt_pk_bf16_f32 v54, v40, v41
    v_mul_f32 v43, v43, v107
    v_exp_f32 v38, v38
    v_mfma_f32_16x16x32_bf16 v[176:179], v[80:83], a[176:179], v[176:179]
    s_waitcnt lgkmcnt(6)
    ds_read_b64_tr_b16 v[76:77], v233 offset:256
    ds_read_b64_tr_b16 v[78:79], v233 offset:2816
    v_mfma_f32_16x16x32_bf16 v[180:183], v[60:63], a[32:35], v[180:183]
    s_add_u32 s76, s76, s59
    buffer_load_dwordx4 v228, s[24:27], s54 offen offset:0 lds
    v_mul_f32 v40, v110, v110
    v_mul_f32 v41, v111, v111
    v_add_f32 v38, 1.0, v38
    v_mfma_f32_16x16x32_bf16 v[184:187], v[60:63], a[176:179], v[184:187]
    s_waitcnt lgkmcnt(6)
    ds_read_b64_tr_b16 v[80:81], v236 offset:288
    ds_read_b64_tr_b16 v[82:83], v236 offset:2848
    v_mfma_f32_16x16x32_bf16 v[188:191], v[64:67], a[32:35], v[188:191]
    s_add_u32 s55, s81, 16384
    buffer_load_dwordx4 a[56:59], v239, s[16:19], s55 offen offset:0 sc1
    v_exp_f32 v39, v39
    v_fmaak_f32 v40, v40, v28, 0xc0135761
    v_mfma_f32_16x16x32_bf16 v[192:195], v[64:67], a[176:179], v[192:195]
    s_waitcnt lgkmcnt(6)
    ds_read_b64_tr_b16 v[60:61], v233 offset:10240
    ds_read_b64_tr_b16 v[62:63], v233 offset:12800
    v_mfma_f32_16x16x32_bf16 v[196:199], v[68:71], a[32:35], v[196:199]
    s_mul_i32 s75, s76, 163840
    buffer_load_dwordx4 v229, s[24:27], s54 offen offset:1024 lds
    v_fmaak_f32 v41, v41, v28, 0xc0135761
    v_add_f32 v39, 1.0, v39
    v_mfma_f32_16x16x32_bf16 v[200:203], v[68:71], a[176:179], v[200:203]
    s_waitcnt lgkmcnt(6)
    ds_read_b64_tr_b16 v[64:65], v236 offset:10272
    ds_read_b64_tr_b16 v[66:67], v236 offset:12832
    v_mfma_f32_16x16x32_bf16 v[204:207], v[72:75], a[32:35], v[204:207]
    s_lshl_b32 s76, s56, 10
    v_rcp_f32 v38, v38
    v_mul_f32 v40, v40, v110
    v_mul_f32 v41, v41, v111
    v_mfma_f32_16x16x32_bf16 v[208:211], v[72:75], a[176:179], v[208:211]
    s_waitcnt lgkmcnt(6)
    ds_read_b64_tr_b16 v[68:69], v233 offset:10304
    ds_read_b64_tr_b16 v[70:71], v233 offset:12864
    v_mfma_f32_16x16x32_bf16 v[212:215], v[76:79], a[32:35], v[212:215]
    s_add_u32 s75, s75, s76
    buffer_load_dwordx4 a[200:203], v239, s[16:19], s55 offen offset:1024 sc1
    v_mul_f32 v38, v38, v108
    v_rcp_f32 v39, v39
    v_mfma_f32_16x16x32_bf16 v[216:219], v[76:79], a[176:179], v[216:219]
    s_waitcnt lgkmcnt(6)
    ds_read_b64_tr_b16 v[72:73], v236 offset:10336
    ds_read_b64_tr_b16 v[74:75], v236 offset:12896
    v_mfma_f32_16x16x32_bf16 v[220:223], v[80:83], a[32:35], v[220:223]
    s_add_u32 s75, s75, 33554432
    v_cvt_pk_bf16_f32 v55, v42, v43
    v_mfma_f32_16x16x32_bf16 v[224:227], v[80:83], a[176:179], v[224:227]
    s_waitcnt lgkmcnt(6)
    ds_read_b64_tr_b16 v[76:77], v233 offset:10368
    ds_read_b64_tr_b16 v[78:79], v233 offset:12928
    v_mfma_f32_16x16x32_bf16 v[148:151], v[60:63], a[36:39], v[148:151]
    s_lshl_b32 s94, s58, 12
    buffer_store_dwordx4 v[52:55], v25, s[16:19], s43 offen offset:0 sc1
    ds_write_b128 v36, v[52:55] offset:0
    buffer_load_dwordx4 v230, s[24:27], s54 offen offset:2048 lds
    v_mul_f32 v39, v39, v109
    v_mfma_f32_16x16x32_bf16 v[152:155], v[60:63], a[180:183], v[152:155]
    s_waitcnt lgkmcnt(7)
    ds_read_b64_tr_b16 v[80:81], v236 offset:10400
    ds_read_b64_tr_b16 v[82:83], v236 offset:12960
    v_mfma_f32_16x16x32_bf16 v[156:159], v[64:67], a[36:39], v[156:159]
    s_add_u32 s94, s94, s75
    v_exp_f32 v40, v40
    v_mul_f32 v42, v112, v112
    v_mul_f32 v43, v113, v113
    v_mfma_f32_16x16x32_bf16 v[160:163], v[64:67], a[180:183], v[160:163]
    s_waitcnt lgkmcnt(7)
    ds_read_b64_tr_b16 v[60:61], v233 offset:10432
    ds_read_b64_tr_b16 v[62:63], v233 offset:12992
    v_mfma_f32_16x16x32_bf16 v[164:167], v[68:71], a[36:39], v[164:167]
    s_add_u32 s76, s58, 1
    v_add_f32 v40, 1.0, v40
    v_exp_f32 v41, v41
    v_fmaak_f32 v42, v42, v28, 0xc0135761
    v_mfma_f32_16x16x32_bf16 v[168:171], v[68:71], a[180:183], v[168:171]
    s_waitcnt lgkmcnt(7)
    ds_read_b64_tr_b16 v[64:65], v236 offset:10464
    ds_read_b64_tr_b16 v[66:67], v236 offset:13024
    v_mfma_f32_16x16x32_bf16 v[172:175], v[72:75], a[36:39], v[172:175]
    s_and_b32 s76, s76, 3
    buffer_load_dwordx4 a[60:63], v240, s[16:19], s55 offen offset:0 sc1
    v_fmaak_f32 v43, v43, v28, 0xc0135761
    v_add_f32 v41, 1.0, v41
    v_mfma_f32_16x16x32_bf16 v[176:179], v[72:75], a[180:183], v[176:179]
    s_waitcnt lgkmcnt(7)
    ds_read_b64_tr_b16 v[68:69], v233 offset:10496
    ds_read_b64_tr_b16 v[70:71], v233 offset:13056
    v_mfma_f32_16x16x32_bf16 v[180:183], v[76:79], a[36:39], v[180:183]
    s_add_u32 s76, s76, 1
    v_rcp_f32 v40, v40
    v_mul_f32 v42, v42, v112
    v_mul_f32 v43, v43, v113
    v_mfma_f32_16x16x32_bf16 v[184:187], v[76:79], a[180:183], v[184:187]
    s_waitcnt lgkmcnt(6)
    ds_read_b64_tr_b16 v[72:73], v236 offset:10528
    ds_read_b64_tr_b16 v[74:75], v236 offset:13088
    v_mfma_f32_16x16x32_bf16 v[188:191], v[80:83], a[36:39], v[188:191]
    s_lshl_b32 s76, s76, 15
    buffer_load_dwordx4 v231, s[24:27], s54 offen offset:3072 lds
    v_mul_f32 v40, v40, v110
    v_rcp_f32 v41, v41
    v_mfma_f32_16x16x32_bf16 v[192:195], v[80:83], a[180:183], v[192:195]
    s_waitcnt lgkmcnt(6)
    s_waitcnt vmcnt(18)
    s_barrier
    ds_read_b64_tr_b16 v[76:77], v233 offset:20480
    ds_read_b64_tr_b16 v[78:79], v233 offset:23040
    v_mfma_f32_16x16x32_bf16 v[196:199], v[60:63], a[36:39], v[196:199]
    s_add_u32 s61, s76, s94
    v_cvt_pk_bf16_f32 v56, v38, v39
    v_mul_f32 v41, v41, v111
    v_exp_f32 v42, v42
    v_mfma_f32_16x16x32_bf16 v[200:203], v[60:63], a[180:183], v[200:203]
    s_waitcnt lgkmcnt(6)
    ds_read_b64_tr_b16 v[80:81], v236 offset:20512
    ds_read_b64_tr_b16 v[82:83], v236 offset:23072
    v_mfma_f32_16x16x32_bf16 v[204:207], v[64:67], a[36:39], v[204:207]
    s_add_u32 s62, s61, 16384
    buffer_load_dwordx4 a[204:207], v240, s[16:19], s55 offen offset:1024 sc1
    v_mul_f32 v38, v114, v114
    v_mul_f32 v39, v115, v115
    v_add_f32 v42, 1.0, v42
    v_mfma_f32_16x16x32_bf16 v[208:211], v[64:67], a[180:183], v[208:211]
    s_waitcnt lgkmcnt(6)
    ds_read_b64_tr_b16 v[60:61], v233 offset:20544
    ds_read_b64_tr_b16 v[62:63], v233 offset:23104
    v_mfma_f32_16x16x32_bf16 v[212:215], v[68:71], a[36:39], v[212:215]
    s_add_u32 s76, s58, 2
    v_exp_f32 v43, v43
    v_fmaak_f32 v38, v38, v28, 0xc0135761
    v_fmaak_f32 v39, v39, v28, 0xc0135761
    v_mfma_f32_16x16x32_bf16 v[216:219], v[68:71], a[180:183], v[216:219]
    s_waitcnt lgkmcnt(6)
    ds_read_b64_tr_b16 v[64:65], v236 offset:20576
    ds_read_b64_tr_b16 v[66:67], v236 offset:23136
    v_mfma_f32_16x16x32_bf16 v[220:223], v[72:75], a[36:39], v[220:223]
    s_add_u32 m0, s88, 146176
    v_add_f32 v43, 1.0, v43
    v_rcp_f32 v42, v42
    v_mul_f32 v38, v38, v114
    v_mfma_f32_16x16x32_bf16 v[224:227], v[72:75], a[180:183], v[224:227]
    s_waitcnt lgkmcnt(6)
    ds_read_b64_tr_b16 v[68:69], v233 offset:20608
    ds_read_b64_tr_b16 v[70:71], v233 offset:23168
    v_mfma_f32_16x16x32_bf16 v[148:151], v[76:79], a[40:43], v[148:151]
    s_and_b32 s76, s76, 3
    buffer_load_dwordx4 v232, s[24:27], s54 offen offset:0 lds
    v_mul_f32 v39, v39, v115
    v_mul_f32 v42, v42, v112
    v_mfma_f32_16x16x32_bf16 v[152:155], v[76:79], a[184:187], v[152:155]
    s_waitcnt lgkmcnt(6)
    ds_read_b64_tr_b16 v[72:73], v236 offset:20640
    ds_read_b64_tr_b16 v[74:75], v236 offset:23200
    v_mfma_f32_16x16x32_bf16 v[156:159], v[80:83], a[40:43], v[156:159]
    s_add_u32 s54, s53, 73728
    v_rcp_f32 v43, v43
    v_cvt_pk_bf16_f32 v57, v40, v41
    v_mul_f32 v43, v43, v113
    v_mfma_f32_16x16x32_bf16 v[160:163], v[80:83], a[184:187], v[160:163]
    s_waitcnt lgkmcnt(6)
    ds_read_b64_tr_b16 v[76:77], v233 offset:20672
    ds_read_b64_tr_b16 v[78:79], v233 offset:23232
    v_mfma_f32_16x16x32_bf16 v[164:167], v[60:63], a[40:43], v[164:167]
    s_add_u32 m0, s88, 61440
    v_exp_f32 v38, v38
    v_exp_f32 v39, v39
    v_mfma_f32_16x16x32_bf16 v[168:171], v[60:63], a[184:187], v[168:171]
    s_waitcnt lgkmcnt(6)
    ds_read_b64_tr_b16 v[80:81], v236 offset:20704
    ds_read_b64_tr_b16 v[82:83], v236 offset:23264
    v_mfma_f32_16x16x32_bf16 v[172:175], v[64:67], a[40:43], v[172:175]
    s_add_u32 s76, s76, 1
    buffer_load_dwordx4 v228, s[24:27], s54 offen offset:0 lds
    v_add_f32 v38, 1.0, v38
    v_add_f32 v39, 1.0, v39
    v_mfma_f32_16x16x32_bf16 v[176:179], v[64:67], a[184:187], v[176:179]
    s_waitcnt lgkmcnt(6)
    ds_read_b64_tr_b16 v[60:61], v233 offset:20736
    ds_read_b64_tr_b16 v[62:63], v233 offset:23296
    v_mfma_f32_16x16x32_bf16 v[180:183], v[68:71], a[40:43], v[180:183]
    s_add_u32 s55, s82, 16384
    buffer_load_dwordx4 a[64:67], v239, s[16:19], s55 offen offset:0 sc1
    v_rcp_f32 v38, v38
    v_mfma_f32_16x16x32_bf16 v[184:187], v[68:71], a[184:187], v[184:187]
    s_waitcnt lgkmcnt(6)
    ds_read_b64_tr_b16 v[64:65], v236 offset:20768
    ds_read_b64_tr_b16 v[66:67], v236 offset:23328
    v_mfma_f32_16x16x32_bf16 v[188:191], v[72:75], a[40:43], v[188:191]
    s_lshl_b32 s76, s76, 15
    v_rcp_f32 v39, v39
    v_mul_f32 v38, v38, v114
    v_cvt_pk_bf16_f32 v58, v42, v43
    v_mfma_f32_16x16x32_bf16 v[192:195], v[72:75], a[184:187], v[192:195]
    s_waitcnt lgkmcnt(6)
    ds_read_b64_tr_b16 v[68:69], v233 offset:30720
    ds_read_b64_tr_b16 v[70:71], v233 offset:33280
    v_mfma_f32_16x16x32_bf16 v[196:199], v[76:79], a[40:43], v[196:199]
    s_add_u32 s63, s76, s94
    buffer_load_dwordx4 v229, s[24:27], s54 offen offset:1024 lds
    v_mul_f32 v39, v39, v115
    v_cvt_pk_bf16_f32 v59, v38, v39
    v_mfma_f32_16x16x32_bf16 v[200:203], v[76:79], a[184:187], v[200:203]
    s_waitcnt lgkmcnt(6)
    ds_read_b64_tr_b16 v[72:73], v236 offset:30752
    ds_read_b64_tr_b16 v[74:75], v236 offset:33312
    v_mfma_f32_16x16x32_bf16 v[204:207], v[80:83], a[40:43], v[204:207]
    s_add_u32 s64, s63, 16384
    buffer_store_dwordx4 v[56:59], v25, s[16:19], s43 offen offset:512 sc1
    ds_write_b128 v36, v[56:59] offset:512
    v_mfma_f32_16x16x32_bf16 v[208:211], v[80:83], a[184:187], v[208:211]
    s_waitcnt lgkmcnt(7)
    ds_read_b64_tr_b16 v[76:77], v233 offset:30784
    ds_read_b64_tr_b16 v[78:79], v233 offset:33344
    v_mfma_f32_16x16x32_bf16 v[212:215], v[60:63], a[40:43], v[212:215]
    s_add_u32 s76, s58, 3
    buffer_load_dwordx4 a[208:211], v239, s[16:19], s55 offen offset:1024 sc1
    v_mfma_f32_16x16x32_bf16 v[216:219], v[60:63], a[184:187], v[216:219]
    s_waitcnt lgkmcnt(7)
    ds_read_b64_tr_b16 v[80:81], v236 offset:30816
    ds_read_b64_tr_b16 v[82:83], v236 offset:33376
    v_mfma_f32_16x16x32_bf16 v[220:223], v[64:67], a[40:43], v[220:223]
    s_and_b32 s76, s76, 3
    v_mfma_f32_16x16x32_bf16 v[224:227], v[64:67], a[184:187], v[224:227]
    s_waitcnt lgkmcnt(7)
    ds_read_b64_tr_b16 v[60:61], v233 offset:30848
    ds_read_b64_tr_b16 v[62:63], v233 offset:33408
    v_mfma_f32_16x16x32_bf16 v[148:151], v[68:71], a[44:47], v[148:151]
    s_add_u32 s76, s76, 1
    buffer_load_dwordx4 v230, s[24:27], s54 offen offset:2048 lds
    v_mfma_f32_16x16x32_bf16 v[152:155], v[68:71], a[188:191], v[152:155]
    s_waitcnt lgkmcnt(7)
    ds_read_b64_tr_b16 v[64:65], v236 offset:30880
    ds_read_b64_tr_b16 v[66:67], v236 offset:33440
    v_mfma_f32_16x16x32_bf16 v[156:159], v[72:75], a[44:47], v[156:159]
    s_lshl_b32 s76, s76, 15
    v_mfma_f32_16x16x32_bf16 v[160:163], v[72:75], a[188:191], v[160:163]
    s_waitcnt lgkmcnt(6)
    ds_read_b64_tr_b16 v[68:69], v233 offset:30912
    ds_read_b64_tr_b16 v[70:71], v233 offset:33472
    v_mfma_f32_16x16x32_bf16 v[164:167], v[76:79], a[44:47], v[164:167]
    s_add_u32 s65, s76, s94
    buffer_load_dwordx4 a[68:71], v240, s[16:19], s55 offen offset:0 sc1
    v_mfma_f32_16x16x32_bf16 v[168:171], v[76:79], a[188:191], v[168:171]
    s_waitcnt lgkmcnt(6)
    ds_read_b64_tr_b16 v[72:73], v236 offset:30944
    ds_read_b64_tr_b16 v[74:75], v236 offset:33504
    v_mfma_f32_16x16x32_bf16 v[172:175], v[80:83], a[44:47], v[172:175]
    s_add_u32 s66, s65, 16384
    v_mfma_f32_16x16x32_bf16 v[176:179], v[80:83], a[188:191], v[176:179]
    s_waitcnt lgkmcnt(6)
    ds_read_b64_tr_b16 v[76:77], v233 offset:30976
    ds_read_b64_tr_b16 v[78:79], v233 offset:33536
    v_mfma_f32_16x16x32_bf16 v[180:183], v[60:63], a[44:47], v[180:183]
    s_mov_b32 s76, 0
    v_mfma_f32_16x16x32_bf16 v[184:187], v[60:63], a[188:191], v[184:187]
    s_waitcnt lgkmcnt(6)
    ds_read_b64_tr_b16 v[80:81], v236 offset:31008
    ds_read_b64_tr_b16 v[82:83], v236 offset:33568
    v_mfma_f32_16x16x32_bf16 v[188:191], v[64:67], a[44:47], v[188:191]
    s_lshl_b32 s76, s76, 15
    buffer_load_dwordx4 v231, s[24:27], s54 offen offset:3072 lds
    v_mfma_f32_16x16x32_bf16 v[192:195], v[64:67], a[188:191], v[192:195]
    s_waitcnt lgkmcnt(6)
    s_waitcnt vmcnt(4)
    s_barrier
    ds_read_b64_tr_b16 v[60:61], v233 offset:40960
    ds_read_b64_tr_b16 v[62:63], v233 offset:43520
    v_mfma_f32_16x16x32_bf16 v[196:199], v[68:71], a[44:47], v[196:199]
    s_or_b32 s21, s60, 3
    v_mov_b32 v243, s21
    v_mfma_f32_16x16x32_bf16 v[200:203], v[68:71], a[188:191], v[200:203]
    s_waitcnt lgkmcnt(6)
    ds_read_b64_tr_b16 v[64:65], v236 offset:40992
    ds_read_b64_tr_b16 v[66:67], v236 offset:43552
    v_mfma_f32_16x16x32_bf16 v[204:207], v[72:75], a[44:47], v[204:207]
    s_add_u32 s67, s76, s94
    buffer_store_dword v243, v241, s[16:19], 0 offen sc1
    v_mfma_f32_16x16x32_bf16 v[208:211], v[72:75], a[188:191], v[208:211]
    s_waitcnt lgkmcnt(6)
    ds_read_b64_tr_b16 v[68:69], v233 offset:41024
    ds_read_b64_tr_b16 v[70:71], v233 offset:43584
    v_mfma_f32_16x16x32_bf16 v[212:215], v[76:79], a[44:47], v[212:215]
    s_add_u32 s68, s67, 16384
    v_mfma_f32_16x16x32_bf16 v[216:219], v[76:79], a[188:191], v[216:219]
    s_waitcnt lgkmcnt(6)
    ds_read_b64_tr_b16 v[72:73], v236 offset:41056
    ds_read_b64_tr_b16 v[74:75], v236 offset:43616
    v_mfma_f32_16x16x32_bf16 v[220:223], v[80:83], a[44:47], v[220:223]
    s_lshl_b32 s95, s57, 7
    buffer_load_dwordx4 a[212:215], v240, s[16:19], s55 offen offset:1024 sc1
    v_mfma_f32_16x16x32_bf16 v[224:227], v[80:83], a[188:191], v[224:227]
    s_waitcnt lgkmcnt(6)
    ds_read_b64_tr_b16 v[76:77], v233 offset:41088
    ds_read_b64_tr_b16 v[78:79], v233 offset:43648
    v_mfma_f32_16x16x32_bf16 v[148:151], v[60:63], a[48:51], v[148:151]
    s_lshl_b32 s76, s56, 5
    v_mfma_f32_16x16x32_bf16 v[152:155], v[60:63], a[192:195], v[152:155]
    s_waitcnt lgkmcnt(6)
    ds_read_b64_tr_b16 v[80:81], v236 offset:41120
    ds_read_b64_tr_b16 v[82:83], v236 offset:43680
    v_mfma_f32_16x16x32_bf16 v[156:159], v[64:67], a[48:51], v[156:159]
    s_add_u32 m0, s88, 65536
    v_mfma_f32_16x16x32_bf16 v[160:163], v[64:67], a[192:195], v[160:163]
    s_waitcnt lgkmcnt(6)
    ds_read_b64_tr_b16 v[60:61], v233 offset:41152
    ds_read_b64_tr_b16 v[62:63], v233 offset:43712
    v_mfma_f32_16x16x32_bf16 v[164:167], v[68:71], a[48:51], v[164:167]
    s_add_u32 s95, s95, s76
    buffer_load_dwordx4 v232, s[24:27], s54 offen offset:0 lds
    v_mfma_f32_16x16x32_bf16 v[168:171], v[68:71], a[192:195], v[168:171]
    s_waitcnt lgkmcnt(6)
    ds_read_b64_tr_b16 v[64:65], v236 offset:41184
    ds_read_b64_tr_b16 v[66:67], v236 offset:43744
    v_mfma_f32_16x16x32_bf16 v[172:175], v[72:75], a[48:51], v[172:175]
    s_add_u32 s54, s51, 147456
    v_mfma_f32_16x16x32_bf16 v[176:179], v[72:75], a[192:195], v[176:179]
    s_waitcnt lgkmcnt(6)
    ds_read_b64_tr_b16 v[68:69], v233 offset:41216
    ds_read_b64_tr_b16 v[70:71], v233 offset:43776
    v_mfma_f32_16x16x32_bf16 v[180:183], v[76:79], a[48:51], v[180:183]
    s_add_u32 m0, s88, 81920
    v_mfma_f32_16x16x32_bf16 v[184:187], v[76:79], a[192:195], v[184:187]
    s_waitcnt lgkmcnt(6)
    ds_read_b64_tr_b16 v[72:73], v236 offset:41248
    ds_read_b64_tr_b16 v[74:75], v236 offset:43808
    v_mfma_f32_16x16x32_bf16 v[188:191], v[80:83], a[48:51], v[188:191]
    s_mul_i32 s95, s95, 1152
    buffer_load_dwordx4 v228, s[24:27], s54 offen offset:0 lds
    v_mfma_f32_16x16x32_bf16 v[192:195], v[80:83], a[192:195], v[192:195]
    s_waitcnt lgkmcnt(6)
    ds_read_b64_tr_b16 v[76:77], v233 offset:51200
    ds_read_b64_tr_b16 v[78:79], v233 offset:53760
    v_mfma_f32_16x16x32_bf16 v[196:199], v[60:63], a[48:51], v[196:199]
    s_add_u32 s76, s58, 4
    buffer_load_dwordx4 v229, s[24:27], s54 offen offset:1024 lds
    v_mfma_f32_16x16x32_bf16 v[200:203], v[60:63], a[192:195], v[200:203]
    s_waitcnt lgkmcnt(6)
    ds_read_b64_tr_b16 v[80:81], v236 offset:51232
    ds_read_b64_tr_b16 v[82:83], v236 offset:53792
    v_mfma_f32_16x16x32_bf16 v[204:207], v[64:67], a[48:51], v[204:207]
    s_and_b32 s76, s76, 3
    v_mfma_f32_16x16x32_bf16 v[208:211], v[64:67], a[192:195], v[208:211]
    s_waitcnt lgkmcnt(6)
    ds_read_b64_tr_b16 v[60:61], v233 offset:51264
    ds_read_b64_tr_b16 v[62:63], v233 offset:53824
    v_mfma_f32_16x16x32_bf16 v[212:215], v[68:71], a[48:51], v[212:215]
    s_add_u32 s76, s76, 1
    buffer_load_dwordx4 v230, s[24:27], s54 offen offset:2048 lds
    v_mfma_f32_16x16x32_bf16 v[216:219], v[68:71], a[192:195], v[216:219]
    s_waitcnt lgkmcnt(6)
    ds_read_b64_tr_b16 v[64:65], v236 offset:51296
    ds_read_b64_tr_b16 v[66:67], v236 offset:53856
    v_mfma_f32_16x16x32_bf16 v[220:223], v[72:75], a[48:51], v[220:223]
    s_lshl_b32 s77, s76, 15
    v_mfma_f32_16x16x32_bf16 v[224:227], v[72:75], a[192:195], v[224:227]
    s_waitcnt lgkmcnt(6)
    ds_read_b64_tr_b16 v[68:69], v233 offset:51328
    ds_read_b64_tr_b16 v[70:71], v233 offset:53888
    v_mfma_f32_16x16x32_bf16 v[148:151], v[76:79], a[52:55], v[148:151]
    s_add_u32 s69, s77, s75
    buffer_load_dwordx4 v231, s[24:27], s54 offen offset:3072 lds
    v_mfma_f32_16x16x32_bf16 v[152:155], v[76:79], a[196:199], v[152:155]
    s_waitcnt lgkmcnt(6)
    ds_read_b64_tr_b16 v[72:73], v236 offset:51360
    ds_read_b64_tr_b16 v[74:75], v236 offset:53920
    v_mfma_f32_16x16x32_bf16 v[156:159], v[80:83], a[52:55], v[156:159]
    s_lshl_b32 s76, s76, 6
    v_mfma_f32_16x16x32_bf16 v[160:163], v[80:83], a[196:199], v[160:163]
    s_waitcnt lgkmcnt(6)
    ds_read_b64_tr_b16 v[76:77], v233 offset:51392
    ds_read_b64_tr_b16 v[78:79], v233 offset:53952
    v_mfma_f32_16x16x32_bf16 v[164:167], v[60:63], a[52:55], v[164:167]
    s_add_u32 m0, s88, 86016
    v_mfma_f32_16x16x32_bf16 v[168:171], v[60:63], a[196:199], v[168:171]
    s_waitcnt lgkmcnt(6)
    ds_read_b64_tr_b16 v[80:81], v236 offset:51424
    ds_read_b64_tr_b16 v[82:83], v236 offset:53984
    v_mfma_f32_16x16x32_bf16 v[172:175], v[64:67], a[52:55], v[172:175]
    s_add_u32 s78, s76, s86
    buffer_load_dwordx4 v232, s[24:27], s54 offen offset:0 lds
    v_mfma_f32_16x16x32_bf16 v[176:179], v[64:67], a[196:199], v[176:179]
    s_waitcnt lgkmcnt(6)
    ds_read_b64_tr_b16 v[60:61], v233 offset:51456
    ds_read_b64_tr_b16 v[62:63], v233 offset:54016
    v_mfma_f32_16x16x32_bf16 v[180:183], v[68:71], a[52:55], v[180:183]
    s_add_u32 s54, s52, 147456
    v_mfma_f32_16x16x32_bf16 v[184:187], v[68:71], a[196:199], v[184:187]
    s_waitcnt lgkmcnt(6)
    ds_read_b64_tr_b16 v[64:65], v236 offset:51488
    ds_read_b64_tr_b16 v[66:67], v236 offset:54048
    v_mfma_f32_16x16x32_bf16 v[188:191], v[72:75], a[52:55], v[188:191]
    s_add_u32 m0, s88, 0
    v_mfma_f32_16x16x32_bf16 v[192:195], v[72:75], a[196:199], v[192:195]
    s_waitcnt lgkmcnt(6)
    s_barrier
    ds_read_b64_tr_b16 v[68:69], v235 offset:11008
    ds_read_b64_tr_b16 v[70:71], v235 offset:13568
    v_mfma_f32_16x16x32_bf16 v[196:199], v[76:79], a[52:55], v[196:199]
    s_add_u32 s72, s78, s95
    buffer_load_dword v29, v242, s[16:19], 0 offen sc1
    v_mfma_f32_16x16x32_bf16 v[200:203], v[76:79], a[196:199], v[200:203]
    s_waitcnt lgkmcnt(6)
    ds_read_b64_tr_b16 v[72:73], v238 offset:11040
    ds_read_b64_tr_b16 v[74:75], v238 offset:13600
    v_mfma_f32_16x16x32_bf16 v[204:207], v[80:83], a[52:55], v[204:207]
    s_mov_b32 s76, 0
    buffer_load_dwordx4 v228, s[24:27], s54 offen offset:0 lds
    v_mfma_f32_16x16x32_bf16 v[208:211], v[80:83], a[196:199], v[208:211]
    s_waitcnt lgkmcnt(6)
    ds_read_b64_tr_b16 v[76:77], v235 offset:11072
    ds_read_b64_tr_b16 v[78:79], v235 offset:13632
    v_mfma_f32_16x16x32_bf16 v[212:215], v[60:63], a[52:55], v[212:215]
    s_lshl_b32 s77, s76, 15
    v_mfma_f32_16x16x32_bf16 v[216:219], v[60:63], a[196:199], v[216:219]
    s_waitcnt lgkmcnt(6)
    ds_read_b64_tr_b16 v[80:81], v238 offset:11104
    ds_read_b64_tr_b16 v[82:83], v238 offset:13664
    v_mfma_f32_16x16x32_bf16 v[220:223], v[64:67], a[52:55], v[220:223]
    s_add_u32 s70, s77, s75
    buffer_load_dwordx4 v229, s[24:27], s54 offen offset:1024 lds
    v_mfma_f32_16x16x32_bf16 v[224:227], v[64:67], a[196:199], v[224:227]
    s_waitcnt lgkmcnt(6)
    ds_read_b64_tr_b16 v[60:61], v235 offset:11136
    ds_read_b64_tr_b16 v[62:63], v235 offset:13696
    v_mfma_f32_16x16x32_bf16 v[148:151], v[68:71], a[56:59], v[148:151]
    s_lshl_b32 s76, s76, 6
    v_mfma_f32_16x16x32_bf16 v[152:155], v[68:71], a[200:203], v[152:155]
    s_waitcnt lgkmcnt(6)
    ds_read_b64_tr_b16 v[64:65], v238 offset:11168
    ds_read_b64_tr_b16 v[66:67], v238 offset:13728
    v_mfma_f32_16x16x32_bf16 v[156:159], v[72:75], a[56:59], v[156:159]
    s_add_u32 s78, s76, s86
    buffer_load_dwordx4 v230, s[24:27], s54 offen offset:2048 lds
    v_mfma_f32_16x16x32_bf16 v[160:163], v[72:75], a[200:203], v[160:163]
    s_waitcnt lgkmcnt(6)
    ds_read_b64_tr_b16 v[68:69], v235 offset:11200
    ds_read_b64_tr_b16 v[70:71], v235 offset:13760
    v_mfma_f32_16x16x32_bf16 v[164:167], v[76:79], a[56:59], v[164:167]
    s_add_u32 s73, s78, s95
    v_mfma_f32_16x16x32_bf16 v[168:171], v[76:79], a[200:203], v[168:171]
    s_waitcnt lgkmcnt(6)
    ds_read_b64_tr_b16 v[72:73], v238 offset:11232
    ds_read_b64_tr_b16 v[74:75], v238 offset:13792
    v_mfma_f32_16x16x32_bf16 v[172:175], v[80:83], a[56:59], v[172:175]
    buffer_load_dwordx4 v231, s[24:27], s54 offen offset:3072 lds
    v_mfma_f32_16x16x32_bf16 v[176:179], v[80:83], a[200:203], v[176:179]
    s_waitcnt lgkmcnt(6)
    ds_read_b64_tr_b16 v[76:77], v235 offset:11264
    ds_read_b64_tr_b16 v[78:79], v235 offset:13824
    v_mfma_f32_16x16x32_bf16 v[180:183], v[60:63], a[56:59], v[180:183]
    v_mfma_f32_16x16x32_bf16 v[184:187], v[60:63], a[200:203], v[184:187]
    s_waitcnt lgkmcnt(6)
    ds_read_b64_tr_b16 v[80:81], v238 offset:11296
    ds_read_b64_tr_b16 v[82:83], v238 offset:13856
    v_mfma_f32_16x16x32_bf16 v[188:191], v[64:67], a[56:59], v[188:191]
    s_add_u32 m0, s88, 4096
    v_mfma_f32_16x16x32_bf16 v[192:195], v[64:67], a[200:203], v[192:195]
    s_waitcnt lgkmcnt(6)
    ds_read_b64_tr_b16 v[60:61], v235 offset:21248
    ds_read_b64_tr_b16 v[62:63], v235 offset:23808
    v_mfma_f32_16x16x32_bf16 v[196:199], v[68:71], a[56:59], v[196:199]
    buffer_load_dwordx4 v232, s[24:27], s54 offen offset:0 lds
    v_mfma_f32_16x16x32_bf16 v[200:203], v[68:71], a[200:203], v[200:203]
    s_waitcnt lgkmcnt(6)
    ds_read_b64_tr_b16 v[64:65], v238 offset:21280
    ds_read_b64_tr_b16 v[66:67], v238 offset:23840
    v_mfma_f32_16x16x32_bf16 v[204:207], v[72:75], a[56:59], v[204:207]
    v_mfma_f32_16x16x32_bf16 v[208:211], v[72:75], a[200:203], v[208:211]
    s_waitcnt lgkmcnt(6)
    ds_read_b64_tr_b16 v[68:69], v235 offset:21312
    ds_read_b64_tr_b16 v[70:71], v235 offset:23872
    v_mfma_f32_16x16x32_bf16 v[212:215], v[76:79], a[56:59], v[212:215]
    s_add_u32 s54, s53, 147456
    v_mfma_f32_16x16x32_bf16 v[216:219], v[76:79], a[200:203], v[216:219]
    s_waitcnt lgkmcnt(6)
    ds_read_b64_tr_b16 v[72:73], v238 offset:21344
    ds_read_b64_tr_b16 v[74:75], v238 offset:23904
    v_mfma_f32_16x16x32_bf16 v[220:223], v[80:83], a[56:59], v[220:223]
    s_add_u32 m0, s88, 20480
    v_mfma_f32_16x16x32_bf16 v[224:227], v[80:83], a[200:203], v[224:227]
    s_waitcnt lgkmcnt(6)
    ds_read_b64_tr_b16 v[76:77], v235 offset:21376
    ds_read_b64_tr_b16 v[78:79], v235 offset:23936
    v_mfma_f32_16x16x32_bf16 v[148:151], v[60:63], a[60:63], v[148:151]
    buffer_load_dwordx4 v228, s[24:27], s54 offen offset:0 lds
    v_mfma_f32_16x16x32_bf16 v[152:155], v[60:63], a[204:207], v[152:155]
    s_waitcnt lgkmcnt(6)
    ds_read_b64_tr_b16 v[80:81], v238 offset:21408
    ds_read_b64_tr_b16 v[82:83], v238 offset:23968
    v_mfma_f32_16x16x32_bf16 v[156:159], v[64:67], a[60:63], v[156:159]
    buffer_load_dwordx4 v229, s[24:27], s54 offen offset:1024 lds
    v_mfma_f32_16x16x32_bf16 v[160:163], v[64:67], a[204:207], v[160:163]
    s_waitcnt lgkmcnt(6)
    ds_read_b64_tr_b16 v[60:61], v235 offset:21440
    ds_read_b64_tr_b16 v[62:63], v235 offset:24000
    v_mfma_f32_16x16x32_bf16 v[164:167], v[68:71], a[60:63], v[164:167]
    buffer_load_dwordx4 v230, s[24:27], s54 offen offset:2048 lds
    v_mfma_f32_16x16x32_bf16 v[168:171], v[68:71], a[204:207], v[168:171]
    s_waitcnt lgkmcnt(6)
    ds_read_b64_tr_b16 v[64:65], v238 offset:21472
    ds_read_b64_tr_b16 v[66:67], v238 offset:24032
    v_mfma_f32_16x16x32_bf16 v[172:175], v[72:75], a[60:63], v[172:175]
    v_mfma_f32_16x16x32_bf16 v[176:179], v[72:75], a[204:207], v[176:179]
    s_waitcnt lgkmcnt(6)
    ds_read_b64_tr_b16 v[68:69], v235 offset:21504
    ds_read_b64_tr_b16 v[70:71], v235 offset:24064
    v_mfma_f32_16x16x32_bf16 v[180:183], v[76:79], a[60:63], v[180:183]
    buffer_load_dwordx4 v231, s[24:27], s54 offen offset:3072 lds
    v_mfma_f32_16x16x32_bf16 v[184:187], v[76:79], a[204:207], v[184:187]
    s_waitcnt lgkmcnt(6)
    ds_read_b64_tr_b16 v[72:73], v238 offset:21536
    ds_read_b64_tr_b16 v[74:75], v238 offset:24096
    v_mfma_f32_16x16x32_bf16 v[188:191], v[80:83], a[60:63], v[188:191]
    v_mfma_f32_16x16x32_bf16 v[192:195], v[80:83], a[204:207], v[192:195]
    s_waitcnt lgkmcnt(6)
    s_waitcnt vmcnt(15)
    s_barrier
    s_waitcnt vmcnt(9)
    s_add_u32 s3, s60, 2
    v_subrev_u32 v23, s3, v29
    v_cmp_ge_u32 vcc, 5, v23
    s_and_b64 vcc, vcc, s[90:91]
    s_cmp_eq_u64 vcc, s[90:91]
    s_cbranch_scc0 L_spino2
L_backo2:
    ds_read_b64_tr_b16 v[76:77], v233 offset:61440
    ds_read_b64_tr_b16 v[78:79], v233 offset:64000
    v_mfma_f32_16x16x32_bf16 v[196:199], v[60:63], a[60:63], v[196:199]
    s_add_u32 s55, s80, 32768
    ds_read_b128 a[96:99], v34 offset:47872
    buffer_load_dwordx4 a[72:75], v239, s[16:19], s55 offen offset:0 sc1
    v_mfma_f32_16x16x32_bf16 v[200:203], v[60:63], a[204:207], v[200:203]
    s_waitcnt lgkmcnt(7)
    ds_read_b64_tr_b16 v[80:81], v236 offset:61472
    ds_read_b64_tr_b16 v[82:83], v236 offset:64032
    v_mfma_f32_16x16x32_bf16 v[204:207], v[64:67], a[60:63], v[204:207]
    ds_read_b128 a[240:243], v34 offset:48896
    buffer_load_dwordx4 a[216:219], v239, s[16:19], s55 offen offset:1024 sc1
    v_mfma_f32_16x16x32_bf16 v[208:211], v[64:67], a[204:207], v[208:211]
    s_waitcnt lgkmcnt(8)
    ds_read_b64_tr_b16 v[60:61], v233 offset:61504
    ds_read_b64_tr_b16 v[62:63], v233 offset:64064
    v_mfma_f32_16x16x32_bf16 v[212:215], v[68:71], a[60:63], v[212:215]
    ds_read_b128 a[100:103], v34 offset:56064
    buffer_load_dwordx4 a[76:79], v240, s[16:19], s55 offen offset:0 sc1
    v_mfma_f32_16x16x32_bf16 v[216:219], v[68:71], a[204:207], v[216:219]
    s_waitcnt lgkmcnt(9)
    ds_read_b64_tr_b16 v[64:65], v236 offset:61536
    ds_read_b64_tr_b16 v[66:67], v236 offset:64096
    v_mfma_f32_16x16x32_bf16 v[220:223], v[72:75], a[60:63], v[220:223]
    ds_read_b128 a[244:247], v34 offset:57088
    buffer_load_dwordx4 a[220:223], v240, s[16:19], s55 offen offset:1024 sc1
    v_mfma_f32_16x16x32_bf16 v[224:227], v[72:75], a[204:207], v[224:227]
    s_waitcnt lgkmcnt(10)
    ds_read_b64_tr_b16 v[68:69], v233 offset:61568
    ds_read_b64_tr_b16 v[70:71], v233 offset:64128
    v_mfma_f32_16x16x32_bf16 v[148:151], v[76:79], a[64:67], v[148:151]
    s_add_u32 s55, s81, 32768
    buffer_load_dwordx4 a[80:83], v239, s[16:19], s55 offen offset:0 sc1
    v_mfma_f32_16x16x32_bf16 v[152:155], v[76:79], a[208:211], v[152:155]
    s_waitcnt lgkmcnt(9)
    ds_read_b64_tr_b16 v[72:73], v236 offset:61600
    ds_read_b64_tr_b16 v[74:75], v236 offset:64160
    v_mfma_f32_16x16x32_bf16 v[156:159], v[80:83], a[64:67], v[156:159]
    buffer_load_dwordx4 a[224:227], v239, s[16:19], s55 offen offset:1024 sc1
    v_mfma_f32_16x16x32_bf16 v[160:163], v[80:83], a[208:211], v[160:163]
    s_waitcnt lgkmcnt(8)
    ds_read_b64_tr_b16 v[76:77], v233 offset:61632
    ds_read_b64_tr_b16 v[78:79], v233 offset:64192
    v_mfma_f32_16x16x32_bf16 v[164:167], v[60:63], a[64:67], v[164:167]
    v_mfma_f32_16x16x32_bf16 v[168:171], v[60:63], a[208:211], v[168:171]
    s_waitcnt lgkmcnt(7)
    ds_read_b64_tr_b16 v[80:81], v236 offset:61664
    ds_read_b64_tr_b16 v[82:83], v236 offset:64224
    v_mfma_f32_16x16x32_bf16 v[172:175], v[64:67], a[64:67], v[172:175]
    buffer_load_dwordx4 a[84:87], v240, s[16:19], s55 offen offset:0 sc1
    v_mfma_f32_16x16x32_bf16 v[176:179], v[64:67], a[208:211], v[176:179]
    s_waitcnt lgkmcnt(6)
    ds_read_b64_tr_b16 v[60:61], v233 offset:61696
    ds_read_b64_tr_b16 v[62:63], v233 offset:64256
    v_mfma_f32_16x16x32_bf16 v[180:183], v[68:71], a[64:67], v[180:183]
    v_mfma_f32_16x16x32_bf16 v[184:187], v[68:71], a[208:211], v[184:187]
    s_waitcnt lgkmcnt(6)
    ds_read_b64_tr_b16 v[64:65], v236 offset:61728
    ds_read_b64_tr_b16 v[66:67], v236 offset:64288
    v_mfma_f32_16x16x32_bf16 v[188:191], v[72:75], a[64:67], v[188:191]
    v_mfma_f32_16x16x32_bf16 v[192:195], v[72:75], a[208:211], v[192:195]
    s_waitcnt lgkmcnt(6)
    ds_read_b64_tr_b16 v[68:69], v234 offset:6144
    ds_read_b64_tr_b16 v[70:71], v234 offset:8704
    v_mfma_f32_16x16x32_bf16 v[196:199], v[76:79], a[64:67], v[196:199]
    v_mfma_f32_16x16x32_bf16 v[200:203], v[76:79], a[208:211], v[200:203]
    s_waitcnt lgkmcnt(6)
    ds_read_b64_tr_b16 v[72:73], v237 offset:6176
    ds_read_b64_tr_b16 v[74:75], v237 offset:8736
    v_mfma_f32_16x16x32_bf16 v[204:207], v[80:83], a[64:67], v[204:207]
    buffer_load_dwordx4 a[228:231], v240, s[16:19], s55 offen offset:1024 sc1
    v_mfma_f32_16x16x32_bf16 v[208:211], v[80:83], a[208:211], v[208:211]
    s_waitcnt lgkmcnt(6)
    ds_read_b64_tr_b16 v[76:77], v234 offset:6208
    ds_read_b64_tr_b16 v[78:79], v234 offset:8768
    v_mfma_f32_16x16x32_bf16 v[212:215], v[60:63], a[64:67], v[212:215]
    v_mfma_f32_16x16x32_bf16 v[216:219], v[60:63], a[208:211], v[216:219]
    s_waitcnt lgkmcnt(6)
    ds_read_b64_tr_b16 v[80:81], v237 offset:6240
    ds_read_b64_tr_b16 v[82:83], v237 offset:8800
    v_mfma_f32_16x16x32_bf16 v[220:223], v[64:67], a[64:67], v[220:223]
    v_mfma_f32_16x16x32_bf16 v[224:227], v[64:67], a[208:211], v[224:227]
    s_waitcnt lgkmcnt(6)
    ds_read_b64_tr_b16 v[60:61], v234 offset:6272
    ds_read_b64_tr_b16 v[62:63], v234 offset:8832
    v_mfma_f32_16x16x32_bf16 v[148:151], v[68:71], a[68:71], v[148:151]
    v_mfma_f32_16x16x32_bf16 v[152:155], v[68:71], a[212:215], v[152:155]
    s_waitcnt lgkmcnt(6)
    ds_read_b64_tr_b16 v[64:65], v237 offset:6304
    ds_read_b64_tr_b16 v[66:67], v237 offset:8864
    v_mfma_f32_16x16x32_bf16 v[156:159], v[72:75], a[68:71], v[156:159]
    v_mfma_f32_16x16x32_bf16 v[160:163], v[72:75], a[212:215], v[160:163]
    s_waitcnt lgkmcnt(6)
    ds_read_b64_tr_b16 v[68:69], v234 offset:6336
    ds_read_b64_tr_b16 v[70:71], v234 offset:8896
    v_mfma_f32_16x16x32_bf16 v[164:167], v[76:79], a[68:71], v[164:167]
    v_mfma_f32_16x16x32_bf16 v[168:171], v[76:79], a[212:215], v[168:171]
    s_waitcnt lgkmcnt(6)
    ds_read_b64_tr_b16 v[72:73], v237 offset:6368
    ds_read_b64_tr_b16 v[74:75], v237 offset:8928
    v_mfma_f32_16x16x32_bf16 v[172:175], v[80:83], a[68:71], v[172:175]
    v_mfma_f32_16x16x32_bf16 v[176:179], v[80:83], a[212:215], v[176:179]
    s_waitcnt lgkmcnt(6)
    ds_read_b64_tr_b16 v[76:77], v234 offset:6400
    ds_read_b64_tr_b16 v[78:79], v234 offset:8960
    v_mfma_f32_16x16x32_bf16 v[180:183], v[60:63], a[68:71], v[180:183]
    s_add_u32 s55, s82, 32768
    buffer_load_dwordx4 a[88:91], v239, s[16:19], s55 offen offset:0 sc1
    v_mfma_f32_16x16x32_bf16 v[184:187], v[60:63], a[212:215], v[184:187]
    s_waitcnt lgkmcnt(6)
    ds_read_b64_tr_b16 v[80:81], v237 offset:6432
    ds_read_b64_tr_b16 v[82:83], v237 offset:8992
    v_mfma_f32_16x16x32_bf16 v[188:191], v[64:67], a[68:71], v[188:191]
    v_mfma_f32_16x16x32_bf16 v[192:195], v[64:67], a[212:215], v[192:195]
    s_waitcnt lgkmcnt(6)
    s_barrier
    ds_read_b64_tr_b16 v[60:61], v234 offset:16384
    ds_read_b64_tr_b16 v[62:63], v234 offset:18944
    v_mfma_f32_16x16x32_bf16 v[196:199], v[68:71], a[68:71], v[196:199]
    buffer_load_dwordx4 a[232:235], v239, s[16:19], s55 offen offset:1024 sc1
    v_mfma_f32_16x16x32_bf16 v[200:203], v[68:71], a[212:215], v[200:203]
    s_waitcnt lgkmcnt(6)
    ds_read_b64_tr_b16 v[64:65], v237 offset:16416
    ds_read_b64_tr_b16 v[66:67], v237 offset:18976
    v_mfma_f32_16x16x32_bf16 v[204:207], v[72:75], a[68:71], v[204:207]
    v_mfma_f32_16x16x32_bf16 v[208:211], v[72:75], a[212:215], v[208:211]
    s_waitcnt lgkmcnt(6)
    ds_read_b64_tr_b16 v[68:69], v234 offset:16448
    ds_read_b64_tr_b16 v[70:71], v234 offset:19008
    v_mfma_f32_16x16x32_bf16 v[212:215], v[76:79], a[68:71], v[212:215]
    buffer_load_dwordx4 a[92:95], v240, s[16:19], s55 offen offset:0 sc1
    v_mfma_f32_16x16x32_bf16 v[216:219], v[76:79], a[212:215], v[216:219]
    s_waitcnt lgkmcnt(6)
    ds_read_b64_tr_b16 v[72:73], v237 offset:16480
    ds_read_b64_tr_b16 v[74:75], v237 offset:19040
    v_mfma_f32_16x16x32_bf16 v[220:223], v[80:83], a[68:71], v[220:223]
    v_mfma_f32_16x16x32_bf16 v[224:227], v[80:83], a[212:215], v[224:227]
    s_waitcnt vmcnt(9) lgkmcnt(6)
    ds_read_b64_tr_b16 v[76:77], v234 offset:16512
    ds_read_b64_tr_b16 v[78:79], v234 offset:19072
    v_mfma_f32_16x16x32_bf16 v[148:151], v[60:63], a[72:75], v[148:151]
    v_mfma_f32_16x16x32_bf16 v[152:155], v[60:63], a[216:219], v[152:155]
    s_waitcnt lgkmcnt(6)
    ds_read_b64_tr_b16 v[80:81], v237 offset:16544
    ds_read_b64_tr_b16 v[82:83], v237 offset:19104
    v_mfma_f32_16x16x32_bf16 v[156:159], v[64:67], a[72:75], v[156:159]
    buffer_load_dwordx4 a[236:239], v240, s[16:19], s55 offen offset:1024 sc1
    v_mfma_f32_16x16x32_bf16 v[160:163], v[64:67], a[216:219], v[160:163]
    s_waitcnt lgkmcnt(6)
    ds_read_b64_tr_b16 v[60:61], v234 offset:16576
    ds_read_b64_tr_b16 v[62:63], v234 offset:19136
    v_mfma_f32_16x16x32_bf16 v[164:167], v[68:71], a[72:75], v[164:167]
    v_mfma_f32_16x16x32_bf16 v[168:171], v[68:71], a[216:219], v[168:171]
    s_waitcnt lgkmcnt(6)
    ds_read_b64_tr_b16 v[64:65], v237 offset:16608
    ds_read_b64_tr_b16 v[66:67], v237 offset:19168
    v_mfma_f32_16x16x32_bf16 v[172:175], v[72:75], a[72:75], v[172:175]
    s_add_u32 m0, s88, 24576
    v_mfma_f32_16x16x32_bf16 v[176:179], v[72:75], a[216:219], v[176:179]
    s_waitcnt lgkmcnt(6)
    ds_read_b64_tr_b16 v[68:69], v234 offset:16640
    ds_read_b64_tr_b16 v[70:71], v234 offset:19200
    v_mfma_f32_16x16x32_bf16 v[180:183], v[76:79], a[72:75], v[180:183]
    buffer_load_dwordx4 v232, s[24:27], s54 offen offset:0 lds
    v_mfma_f32_16x16x32_bf16 v[184:187], v[76:79], a[216:219], v[184:187]
    s_waitcnt lgkmcnt(6)
    ds_read_b64_tr_b16 v[72:73], v237 offset:16672
    ds_read_b64_tr_b16 v[74:75], v237 offset:19232
    v_mfma_f32_16x16x32_bf16 v[188:191], v[80:83], a[72:75], v[188:191]
    s_add_u32 s54, s50, 221184
    v_mfma_f32_16x16x32_bf16 v[192:195], v[80:83], a[216:219], v[192:195]
    s_waitcnt lgkmcnt(6)
    ds_read_b64_tr_b16 v[76:77], v234 offset:26624
    ds_read_b64_tr_b16 v[78:79], v234 offset:29184
    v_mfma_f32_16x16x32_bf16 v[196:199], v[60:63], a[72:75], v[196:199]
    s_add_u32 m0, s88, 40960
    v_mfma_f32_16x16x32_bf16 v[200:203], v[60:63], a[216:219], v[200:203]
    s_waitcnt lgkmcnt(6)
    ds_read_b64_tr_b16 v[80:81], v237 offset:26656
    ds_read_b64_tr_b16 v[82:83], v237 offset:29216
    v_mfma_f32_16x16x32_bf16 v[204:207], v[64:67], a[72:75], v[204:207]
    buffer_load_dwordx4 v228, s[24:27], s54 offen offset:0 lds
    v_mfma_f32_16x16x32_bf16 v[208:211], v[64:67], a[216:219], v[208:211]
    s_waitcnt lgkmcnt(6)
    ds_read_b64_tr_b16 v[60:61], v234 offset:26688
    ds_read_b64_tr_b16 v[62:63], v234 offset:29248
    v_mfma_f32_16x16x32_bf16 v[212:215], v[68:71], a[72:75], v[212:215]
    buffer_load_dwordx4 v229, s[24:27], s54 offen offset:1024 lds
    v_mfma_f32_16x16x32_bf16 v[216:219], v[68:71], a[216:219], v[216:219]
    s_waitcnt lgkmcnt(6)
    ds_read_b64_tr_b16 v[64:65], v237 offset:26720
    ds_read_b64_tr_b16 v[66:67], v237 offset:29280
    v_mfma_f32_16x16x32_bf16 v[220:223], v[72:75], a[72:75], v[220:223]
    buffer_load_dwordx4 v230, s[24:27], s54 offen offset:2048 lds
    v_mfma_f32_16x16x32_bf16 v[224:227], v[72:75], a[216:219], v[224:227]
    s_waitcnt vmcnt(12) lgkmcnt(6)
    ds_read_b64_tr_b16 v[68:69], v234 offset:26752
    ds_read_b64_tr_b16 v[70:71], v234 offset:29312
    v_mfma_f32_16x16x32_bf16 v[148:151], v[76:79], a[76:79], v[148:151]
    v_mfma_f32_16x16x32_bf16 v[152:155], v[76:79], a[220:223], v[152:155]
    s_waitcnt lgkmcnt(6)
    ds_read_b64_tr_b16 v[72:73], v237 offset:26784
    ds_read_b64_tr_b16 v[74:75], v237 offset:29344
    v_mfma_f32_16x16x32_bf16 v[156:159], v[80:83], a[76:79], v[156:159]
    v_mfma_f32_16x16x32_bf16 v[160:163], v[80:83], a[220:223], v[160:163]
    s_waitcnt lgkmcnt(6)
    ds_read_b64_tr_b16 v[76:77], v234 offset:26816
    ds_read_b64_tr_b16 v[78:79], v234 offset:29376
    v_mfma_f32_16x16x32_bf16 v[164:167], v[60:63], a[76:79], v[164:167]
    buffer_load_dwordx4 v231, s[24:27], s54 offen offset:3072 lds
    v_mfma_f32_16x16x32_bf16 v[168:171], v[60:63], a[220:223], v[168:171]
    s_waitcnt lgkmcnt(6)
    ds_read_b64_tr_b16 v[80:81], v237 offset:26848
    ds_read_b64_tr_b16 v[82:83], v237 offset:29408
    v_mfma_f32_16x16x32_bf16 v[172:175], v[64:67], a[76:79], v[172:175]
    v_mfma_f32_16x16x32_bf16 v[176:179], v[64:67], a[220:223], v[176:179]
    s_waitcnt lgkmcnt(6)
    ds_read_b64_tr_b16 v[60:61], v234 offset:26880
    ds_read_b64_tr_b16 v[62:63], v234 offset:29440
    v_mfma_f32_16x16x32_bf16 v[180:183], v[68:71], a[76:79], v[180:183]
    s_add_u32 m0, s88, 45056
    v_mfma_f32_16x16x32_bf16 v[184:187], v[68:71], a[220:223], v[184:187]
    s_waitcnt lgkmcnt(6)
    ds_read_b64_tr_b16 v[64:65], v237 offset:26912
    ds_read_b64_tr_b16 v[66:67], v237 offset:29472
    v_mfma_f32_16x16x32_bf16 v[188:191], v[72:75], a[76:79], v[188:191]
    buffer_load_dwordx4 v232, s[24:27], s54 offen offset:0 lds
    v_mfma_f32_16x16x32_bf16 v[192:195], v[72:75], a[220:223], v[192:195]
    s_waitcnt lgkmcnt(6)
    s_barrier
    ds_read_b64_tr_b16 v[68:69], v233 offset:0
    ds_read_b64_tr_b16 v[70:71], v233 offset:2560
    v_mfma_f32_16x16x32_bf16 v[196:199], v[76:79], a[76:79], v[196:199]
    s_add_u32 s54, s51, 221184
    v_mfma_f32_16x16x32_bf16 v[200:203], v[76:79], a[220:223], v[200:203]
    s_waitcnt lgkmcnt(6)
    ds_read_b64_tr_b16 v[72:73], v236 offset:32
    ds_read_b64_tr_b16 v[74:75], v236 offset:2592
    v_mfma_f32_16x16x32_bf16 v[204:207], v[80:83], a[76:79], v[204:207]
    s_add_u32 m0, s88, 142080
    v_mfma_f32_16x16x32_bf16 v[208:211], v[80:83], a[220:223], v[208:211]
    s_waitcnt lgkmcnt(6)
    ds_read_b64_tr_b16 v[76:77], v233 offset:64
    ds_read_b64_tr_b16 v[78:79], v233 offset:2624
    v_mfma_f32_16x16x32_bf16 v[212:215], v[60:63], a[76:79], v[212:215]
    buffer_load_dwordx4 v228, s[24:27], s54 offen offset:0 lds
    v_mfma_f32_16x16x32_bf16 v[216:219], v[60:63], a[220:223], v[216:219]
    s_waitcnt lgkmcnt(6)
    ds_read_b64_tr_b16 v[80:81], v236 offset:96
    ds_read_b64_tr_b16 v[82:83], v236 offset:2656
    v_mfma_f32_16x16x32_bf16 v[220:223], v[64:67], a[76:79], v[220:223]
    s_add_u32 s55, s80, 49152
    buffer_load_dwordx4 a[104:107], v239, s[16:19], s55 offen offset:0 sc1
    v_mfma_f32_16x16x32_bf16 v[224:227], v[64:67], a[220:223], v[224:227]
    s_waitcnt vmcnt(14) lgkmcnt(6)
    ds_read_b64_tr_b16 v[60:61], v233 offset:128
    ds_read_b64_tr_b16 v[62:63], v233 offset:2688
    v_mfma_f32_16x16x32_bf16 v[148:151], v[68:71], a[80:83], v[148:151]
    buffer_load_dwordx4 v229, s[24:27], s54 offen offset:1024 lds
    v_mfma_f32_16x16x32_bf16 v[152:155], v[68:71], a[224:227], v[152:155]
    s_waitcnt lgkmcnt(6)
    ds_read_b64_tr_b16 v[64:65], v236 offset:160
    ds_read_b64_tr_b16 v[66:67], v236 offset:2720
    v_mfma_f32_16x16x32_bf16 v[156:159], v[72:75], a[80:83], v[156:159]
    v_mfma_f32_16x16x32_bf16 v[160:163], v[72:75], a[224:227], v[160:163]
    s_waitcnt lgkmcnt(6)
    ds_read_b64_tr_b16 v[68:69], v233 offset:192
    ds_read_b64_tr_b16 v[70:71], v233 offset:2752
    v_mfma_f32_16x16x32_bf16 v[164:167], v[76:79], a[80:83], v[164:167]
    v_mfma_f32_16x16x32_bf16 v[168:171], v[76:79], a[224:227], v[168:171]
    s_waitcnt lgkmcnt(6)
    ds_read_b64_tr_b16 v[72:73], v236 offset:224
    ds_read_b64_tr_b16 v[74:75], v236 offset:2784
    v_mfma_f32_16x16x32_bf16 v[172:175], v[80:83], a[80:83], v[172:175]
    buffer_load_dwordx4 a[248:251], v239, s[16:19], s55 offen offset:1024 sc1
    v_mfma_f32_16x16x32_bf16 v[176:179], v[80:83], a[224:227], v[176:179]
    s_waitcnt lgkmcnt(6)
    ds_read_b64_tr_b16 v[76:77], v233 offset:256
    ds_read_b64_tr_b16 v[78:79], v233 offset:2816
    v_mfma_f32_16x16x32_bf16 v[180:183], v[60:63], a[80:83], v[180:183]
    v_mfma_f32_16x16x32_bf16 v[184:187], v[60:63], a[224:227], v[184:187]
    s_waitcnt lgkmcnt(6)
    ds_read_b64_tr_b16 v[80:81], v236 offset:288
    ds_read_b64_tr_b16 v[82:83], v236 offset:2848
    v_mfma_f32_16x16x32_bf16 v[188:191], v[64:67], a[80:83], v[188:191]
    buffer_load_dwordx4 v230, s[24:27], s54 offen offset:2048 lds
    v_mfma_f32_16x16x32_bf16 v[192:195], v[64:67], a[224:227], v[192:195]
    s_waitcnt lgkmcnt(6)
    ds_read_b64_tr_b16 v[60:61], v233 offset:10240
    ds_read_b64_tr_b16 v[62:63], v233 offset:12800
    v_mfma_f32_16x16x32_bf16 v[196:199], v[68:71], a[80:83], v[196:199]
    v_mfma_f32_16x16x32_bf16 v[200:203], v[68:71], a[224:227], v[200:203]
    s_waitcnt lgkmcnt(6)
    ds_read_b64_tr_b16 v[64:65], v236 offset:10272
    ds_read_b64_tr_b16 v[66:67], v236 offset:12832
    v_mfma_f32_16x16x32_bf16 v[204:207], v[72:75], a[80:83], v[204:207]
    buffer_load_dwordx4 a[108:111], v240, s[16:19], s55 offen offset:0 sc1
    v_mfma_f32_16x16x32_bf16 v[208:211], v[72:75], a[224:227], v[208:211]
    s_waitcnt lgkmcnt(6)
    ds_read_b64_tr_b16 v[68:69], v233 offset:10304
    ds_read_b64_tr_b16 v[70:71], v233 offset:12864
    v_mfma_f32_16x16x32_bf16 v[212:215], v[76:79], a[80:83], v[212:215]
    v_mfma_f32_16x16x32_bf16 v[216:219], v[76:79], a[224:227], v[216:219]
    s_waitcnt lgkmcnt(6)
    ds_read_b64_tr_b16 v[72:73], v236 offset:10336
    ds_read_b64_tr_b16 v[74:75], v236 offset:12896
    v_mfma_f32_16x16x32_bf16 v[220:223], v[80:83], a[80:83], v[220:223]
    buffer_load_dwordx4 v231, s[24:27], s54 offen offset:3072 lds
    v_mfma_f32_16x16x32_bf16 v[224:227], v[80:83], a[224:227], v[224:227]
    s_waitcnt vmcnt(17) lgkmcnt(6)
    ds_read_b64_tr_b16 v[76:77], v233 offset:10368
    ds_read_b64_tr_b16 v[78:79], v233 offset:12928
    v_mfma_f32_16x16x32_bf16 v[148:151], v[60:63], a[84:87], v[148:151]
    v_mfma_f32_16x16x32_bf16 v[152:155], v[60:63], a[228:231], v[152:155]
    s_waitcnt lgkmcnt(6)
    ds_read_b64_tr_b16 v[80:81], v236 offset:10400
    ds_read_b64_tr_b16 v[82:83], v236 offset:12960
    v_mfma_f32_16x16x32_bf16 v[156:159], v[64:67], a[84:87], v[156:159]
    buffer_load_dwordx4 a[252:255], v240, s[16:19], s55 offen offset:1024 sc1
    v_mfma_f32_16x16x32_bf16 v[160:163], v[64:67], a[228:231], v[160:163]
    s_waitcnt lgkmcnt(6)
    ds_read_b64_tr_b16 v[60:61], v233 offset:10432
    ds_read_b64_tr_b16 v[62:63], v233 offset:12992
    v_mfma_f32_16x16x32_bf16 v[164:167], v[68:71], a[84:87], v[164:167]
    v_mfma_f32_16x16x32_bf16 v[168:171], v[68:71], a[228:231], v[168:171]
    s_waitcnt lgkmcnt(6)
    ds_read_b64_tr_b16 v[64:65], v236 offset:10464
    ds_read_b64_tr_b16 v[66:67], v236 offset:13024
    v_mfma_f32_16x16x32_bf16 v[172:175], v[72:75], a[84:87], v[172:175]
    v_mfma_f32_16x16x32_bf16 v[176:179], v[72:75], a[228:231], v[176:179]
    s_waitcnt lgkmcnt(6)
    ds_read_b64_tr_b16 v[68:69], v233 offset:10496
    ds_read_b64_tr_b16 v[70:71], v233 offset:13056
    v_mfma_f32_16x16x32_bf16 v[180:183], v[76:79], a[84:87], v[180:183]
    s_add_u32 m0, s88, 146176
    v_mfma_f32_16x16x32_bf16 v[184:187], v[76:79], a[228:231], v[184:187]
    s_waitcnt lgkmcnt(6)
    ds_read_b64_tr_b16 v[72:73], v236 offset:10528
    ds_read_b64_tr_b16 v[74:75], v236 offset:13088
    v_mfma_f32_16x16x32_bf16 v[188:191], v[80:83], a[84:87], v[188:191]
    buffer_load_dwordx4 v232, s[24:27], s54 offen offset:0 lds
    v_mfma_f32_16x16x32_bf16 v[192:195], v[80:83], a[228:231], v[192:195]
    s_waitcnt lgkmcnt(6)
    s_waitcnt vmcnt(14)
    s_barrier
    ds_read_b64_tr_b16 v[76:77], v233 offset:20480
    ds_read_b64_tr_b16 v[78:79], v233 offset:23040
    v_mfma_f32_16x16x32_bf16 v[196:199], v[60:63], a[84:87], v[196:199]
    s_add_u32 s54, s52, 221184
    v_mfma_f32_16x16x32_bf16 v[200:203], v[60:63], a[228:231], v[200:203]
    s_waitcnt lgkmcnt(6)
    ds_read_b64_tr_b16 v[80:81], v236 offset:20512
    ds_read_b64_tr_b16 v[82:83], v236 offset:23072
    v_mfma_f32_16x16x32_bf16 v[204:207], v[64:67], a[84:87], v[204:207]
    s_add_u32 m0, s88, 61440
    v_mfma_f32_16x16x32_bf16 v[208:211], v[64:67], a[228:231], v[208:211]
    s_waitcnt lgkmcnt(6)
    ds_read_b64_tr_b16 v[60:61], v233 offset:20544
    ds_read_b64_tr_b16 v[62:63], v233 offset:23104
    v_mfma_f32_16x16x32_bf16 v[212:215], v[68:71], a[84:87], v[212:215]
    buffer_load_dwordx4 v228, s[24:27], s54 offen offset:0 lds
    v_mfma_f32_16x16x32_bf16 v[216:219], v[68:71], a[228:231], v[216:219]
    s_waitcnt lgkmcnt(6)
    ds_read_b64_tr_b16 v[64:65], v236 offset:20576
    ds_read_b64_tr_b16 v[66:67], v236 offset:23136
    v_mfma_f32_16x16x32_bf16 v[220:223], v[72:75], a[84:87], v[220:223]
    s_add_u32 s55, s81, 49152
    buffer_load_dwordx4 a[112:115], v239, s[16:19], s55 offen offset:0 sc1
    v_mfma_f32_16x16x32_bf16 v[224:227], v[72:75], a[228:231], v[224:227]
    s_waitcnt lgkmcnt(6)
    ds_read_b64_tr_b16 v[68:69], v233 offset:20608
    ds_read_b64_tr_b16 v[70:71], v233 offset:23168
    v_mfma_f32_16x16x32_bf16 v[148:151], v[76:79], a[88:91], v[148:151]
    buffer_load_dwordx4 v229, s[24:27], s54 offen offset:1024 lds
    v_mfma_f32_16x16x32_bf16 v[152:155], v[76:79], a[232:235], v[152:155]
    s_waitcnt lgkmcnt(6)
    ds_read_b64_tr_b16 v[72:73], v236 offset:20640
    ds_read_b64_tr_b16 v[74:75], v236 offset:23200
    v_mfma_f32_16x16x32_bf16 v[156:159], v[80:83], a[88:91], v[156:159]
    v_mfma_f32_16x16x32_bf16 v[160:163], v[80:83], a[232:235], v[160:163]
    s_waitcnt lgkmcnt(6)
    ds_read_b64_tr_b16 v[76:77], v233 offset:20672
    ds_read_b64_tr_b16 v[78:79], v233 offset:23232
    v_mfma_f32_16x16x32_bf16 v[164:167], v[60:63], a[88:91], v[164:167]
    buffer_load_dwordx4 a[116:119], v239, s[16:19], s55 offen offset:1024 sc1
    v_mfma_f32_16x16x32_bf16 v[168:171], v[60:63], a[232:235], v[168:171]
    s_waitcnt lgkmcnt(6)
    ds_read_b64_tr_b16 v[80:81], v236 offset:20704
    ds_read_b64_tr_b16 v[82:83], v236 offset:23264
    v_mfma_f32_16x16x32_bf16 v[172:175], v[64:67], a[88:91], v[172:175]
    v_mfma_f32_16x16x32_bf16 v[176:179], v[64:67], a[232:235], v[176:179]
    s_waitcnt lgkmcnt(6)
    ds_read_b64_tr_b16 v[60:61], v233 offset:20736
    ds_read_b64_tr_b16 v[62:63], v233 offset:23296
    v_mfma_f32_16x16x32_bf16 v[180:183], v[68:71], a[88:91], v[180:183]
    buffer_load_dwordx4 v230, s[24:27], s54 offen offset:2048 lds
    v_mfma_f32_16x16x32_bf16 v[184:187], v[68:71], a[232:235], v[184:187]
    s_waitcnt lgkmcnt(6)
    ds_read_b64_tr_b16 v[64:65], v236 offset:20768
    ds_read_b64_tr_b16 v[66:67], v236 offset:23328
    v_mfma_f32_16x16x32_bf16 v[188:191], v[72:75], a[88:91], v[188:191]
    v_mfma_f32_16x16x32_bf16 v[192:195], v[72:75], a[232:235], v[192:195]
    s_waitcnt lgkmcnt(6)
    ds_read_b64_tr_b16 v[68:69], v233 offset:30720
    ds_read_b64_tr_b16 v[70:71], v233 offset:33280
    v_mfma_f32_16x16x32_bf16 v[196:199], v[76:79], a[88:91], v[196:199]
    v_mfma_f32_16x16x32_bf16 v[200:203], v[76:79], a[232:235], v[200:203]
    s_waitcnt lgkmcnt(6)
    ds_read_b64_tr_b16 v[72:73], v236 offset:30752
    ds_read_b64_tr_b16 v[74:75], v236 offset:33312
    v_mfma_f32_16x16x32_bf16 v[204:207], v[80:83], a[88:91], v[204:207]
    buffer_load_dwordx4 a[120:123], v240, s[16:19], s55 offen offset:0 sc1
    v_mfma_f32_16x16x32_bf16 v[208:211], v[80:83], a[232:235], v[208:211]
    s_waitcnt lgkmcnt(6)
    ds_read_b64_tr_b16 v[76:77], v233 offset:30784
    ds_read_b64_tr_b16 v[78:79], v233 offset:33344
    v_mfma_f32_16x16x32_bf16 v[212:215], v[60:63], a[88:91], v[212:215]
    v_mfma_f32_16x16x32_bf16 v[216:219], v[60:63], a[232:235], v[216:219]
    s_waitcnt lgkmcnt(6)
    ds_read_b64_tr_b16 v[80:81], v236 offset:30816
    ds_read_b64_tr_b16 v[82:83], v236 offset:33376
    v_mfma_f32_16x16x32_bf16 v[220:223], v[64:67], a[88:91], v[220:223]
    buffer_load_dwordx4 v231, s[24:27], s54 offen offset:3072 lds
    v_mfma_f32_16x16x32_bf16 v[224:227], v[64:67], a[232:235], v[224:227]
    s_waitcnt lgkmcnt(6)
    ds_read_b64_tr_b16 v[60:61], v233 offset:30848
    ds_read_b64_tr_b16 v[62:63], v233 offset:33408
    v_mfma_f32_16x16x32_bf16 v[148:151], v[68:71], a[92:95], v[148:151]
    v_mfma_f32_16x16x32_bf16 v[152:155], v[68:71], a[236:239], v[152:155]
    s_waitcnt lgkmcnt(6)
    ds_read_b64_tr_b16 v[64:65], v236 offset:30880
    ds_read_b64_tr_b16 v[66:67], v236 offset:33440
    v_mfma_f32_16x16x32_bf16 v[156:159], v[72:75], a[92:95], v[156:159]
    buffer_load_dwordx4 a[124:127], v240, s[16:19], s55 offen offset:1024 sc1
    v_mfma_f32_16x16x32_bf16 v[160:163], v[72:75], a[236:239], v[160:163]
    s_waitcnt lgkmcnt(6)
    ds_read_b64_tr_b16 v[68:69], v233 offset:30912
    ds_read_b64_tr_b16 v[70:71], v233 offset:33472
    v_mfma_f32_16x16x32_bf16 v[164:167], v[76:79], a[92:95], v[164:167]
    v_mfma_f32_16x16x32_bf16 v[168:171], v[76:79], a[236:239], v[168:171]
    s_waitcnt lgkmcnt(6)
    ds_read_b64_tr_b16 v[72:73], v236 offset:30944
    ds_read_b64_tr_b16 v[74:75], v236 offset:33504
    v_mfma_f32_16x16x32_bf16 v[172:175], v[80:83], a[92:95], v[172:175]
    s_add_u32 m0, s88, 65536
    v_mfma_f32_16x16x32_bf16 v[176:179], v[80:83], a[236:239], v[176:179]
    s_waitcnt lgkmcnt(6)
    ds_read_b64_tr_b16 v[76:77], v233 offset:30976
    ds_read_b64_tr_b16 v[78:79], v233 offset:33536
    v_mfma_f32_16x16x32_bf16 v[180:183], v[60:63], a[92:95], v[180:183]
    buffer_load_dwordx4 v232, s[24:27], s54 offen offset:0 lds
    v_mfma_f32_16x16x32_bf16 v[184:187], v[60:63], a[236:239], v[184:187]
    s_waitcnt lgkmcnt(6)
    ds_read_b64_tr_b16 v[80:81], v236 offset:31008
    ds_read_b64_tr_b16 v[82:83], v236 offset:33568
    v_mfma_f32_16x16x32_bf16 v[188:191], v[64:67], a[92:95], v[188:191]
    s_add_u32 s54, s53, 221184
    v_mfma_f32_16x16x32_bf16 v[192:195], v[64:67], a[236:239], v[192:195]
    s_waitcnt lgkmcnt(6)
    s_waitcnt vmcnt(18)
    s_barrier
    ds_read_b64_tr_b16 v[60:61], v233 offset:40960
    ds_read_b64_tr_b16 v[62:63], v233 offset:43520
    v_mfma_f32_16x16x32_bf16 v[196:199], v[68:71], a[92:95], v[196:199]
    buffer_load_dword v29, v242, s[16:19], 0 offen sc1
    v_mfma_f32_16x16x32_bf16 v[200:203], v[68:71], a[236:239], v[200:203]
    s_waitcnt lgkmcnt(6)
    ds_read_b64_tr_b16 v[64:65], v236 offset:40992
    ds_read_b64_tr_b16 v[66:67], v236 offset:43552
    v_mfma_f32_16x16x32_bf16 v[204:207], v[72:75], a[92:95], v[204:207]
    v_mfma_f32_16x16x32_bf16 v[208:211], v[72:75], a[236:239], v[208:211]
    s_waitcnt lgkmcnt(6)
    ds_read_b64_tr_b16 v[68:69], v233 offset:41024
    ds_read_b64_tr_b16 v[70:71], v233 offset:43584
    v_mfma_f32_16x16x32_bf16 v[212:215], v[76:79], a[92:95], v[212:215]
    s_add_u32 m0, s88, 81920
    v_mfma_f32_16x16x32_bf16 v[216:219], v[76:79], a[236:239], v[216:219]
    s_waitcnt lgkmcnt(6)
    ds_read_b64_tr_b16 v[72:73], v236 offset:41056
    ds_read_b64_tr_b16 v[74:75], v236 offset:43616
    v_mfma_f32_16x16x32_bf16 v[220:223], v[80:83], a[92:95], v[220:223]
    buffer_load_dwordx4 v228, s[24:27], s54 offen offset:0 lds
    v_mfma_f32_16x16x32_bf16 v[224:227], v[80:83], a[236:239], v[224:227]
    s_waitcnt lgkmcnt(6)
    ds_read_b64_tr_b16 v[76:77], v233 offset:41088
    ds_read_b64_tr_b16 v[78:79], v233 offset:43648
    v_mfma_f32_16x16x32_bf16 v[148:151], v[60:63], a[96:99], v[148:151]
    s_add_u32 s55, s82, 49152
    buffer_load_dwordx4 a[128:131], v239, s[16:19], s55 offen offset:0 sc1
    v_mfma_f32_16x16x32_bf16 v[152:155], v[60:63], a[240:243], v[152:155]
    s_waitcnt lgkmcnt(6)
    ds_read_b64_tr_b16 v[80:81], v236 offset:41120
    ds_read_b64_tr_b16 v[82:83], v236 offset:43680
    v_mfma_f32_16x16x32_bf16 v[156:159], v[64:67], a[96:99], v[156:159]
    v_mfma_f32_16x16x32_bf16 v[160:163], v[64:67], a[240:243], v[160:163]
    s_waitcnt lgkmcnt(6)
    ds_read_b64_tr_b16 v[60:61], v233 offset:41152
    ds_read_b64_tr_b16 v[62:63], v233 offset:43712
    v_mfma_f32_16x16x32_bf16 v[164:167], v[68:71], a[96:99], v[164:167]
    buffer_load_dwordx4 v229, s[24:27], s54 offen offset:1024 lds
    v_mfma_f32_16x16x32_bf16 v[168:171], v[68:71], a[240:243], v[168:171]
    s_waitcnt lgkmcnt(6)
    ds_read_b64_tr_b16 v[64:65], v236 offset:41184
    ds_read_b64_tr_b16 v[66:67], v236 offset:43744
    v_mfma_f32_16x16x32_bf16 v[172:175], v[72:75], a[96:99], v[172:175]
    v_mfma_f32_16x16x32_bf16 v[176:179], v[72:75], a[240:243], v[176:179]
    s_waitcnt lgkmcnt(6)
    ds_read_b64_tr_b16 v[68:69], v233 offset:51200
    ds_read_b64_tr_b16 v[70:71], v233 offset:53760
    v_mfma_f32_16x16x32_bf16 v[180:183], v[76:79], a[96:99], v[180:183]
    buffer_load_dwordx4 a[132:135], v239, s[16:19], s55 offen offset:1024 sc1
    v_mfma_f32_16x16x32_bf16 v[184:187], v[76:79], a[240:243], v[184:187]
    s_waitcnt lgkmcnt(6)
    ds_read_b64_tr_b16 v[72:73], v236 offset:51232
    ds_read_b64_tr_b16 v[74:75], v236 offset:53792
    v_mfma_f32_16x16x32_bf16 v[188:191], v[80:83], a[96:99], v[188:191]
    v_mfma_f32_16x16x32_bf16 v[192:195], v[80:83], a[240:243], v[192:195]
    s_waitcnt lgkmcnt(6)
    ds_read_b64_tr_b16 v[76:77], v233 offset:51264
    ds_read_b64_tr_b16 v[78:79], v233 offset:53824
    v_mfma_f32_16x16x32_bf16 v[196:199], v[60:63], a[96:99], v[196:199]
    buffer_load_dwordx4 v230, s[24:27], s54 offen offset:2048 lds
    v_mfma_f32_16x16x32_bf16 v[200:203], v[60:63], a[240:243], v[200:203]
    s_waitcnt lgkmcnt(6)
    ds_read_b64_tr_b16 v[80:81], v236 offset:51296
    ds_read_b64_tr_b16 v[82:83], v236 offset:53856
    v_mfma_f32_16x16x32_bf16 v[204:207], v[64:67], a[96:99], v[204:207]
    v_mfma_f32_16x16x32_bf16 v[208:211], v[64:67], a[240:243], v[208:211]
    s_waitcnt lgkmcnt(6)
    ds_read_b64_tr_b16 v[60:61], v233 offset:51328
    ds_read_b64_tr_b16 v[62:63], v233 offset:53888
    v_mfma_f32_16x16x32_bf16 v[148:151], v[68:71], a[100:103], v[148:151]
    v_mfma_f32_16x16x32_bf16 v[152:155], v[68:71], a[244:247], v[152:155]
    s_waitcnt lgkmcnt(6)
    ds_read_b64_tr_b16 v[64:65], v236 offset:51360
    ds_read_b64_tr_b16 v[66:67], v236 offset:53920
    v_mfma_f32_16x16x32_bf16 v[156:159], v[72:75], a[100:103], v[156:159]
    buffer_load_dwordx4 a[136:139], v240, s[16:19], s55 offen offset:0 sc1
    v_mfma_f32_16x16x32_bf16 v[160:163], v[72:75], a[244:247], v[160:163]
    s_waitcnt lgkmcnt(6)
    ds_read_b64_tr_b16 v[68:69], v233 offset:51392
    ds_read_b64_tr_b16 v[70:71], v233 offset:53952
    v_mfma_f32_16x16x32_bf16 v[164:167], v[76:79], a[100:103], v[164:167]
    v_mfma_f32_16x16x32_bf16 v[168:171], v[76:79], a[244:247], v[168:171]
    s_waitcnt lgkmcnt(6)
    ds_read_b64_tr_b16 v[72:73], v236 offset:51424
    ds_read_b64_tr_b16 v[74:75], v236 offset:53984
    v_mfma_f32_16x16x32_bf16 v[172:175], v[80:83], a[100:103], v[172:175]
    buffer_load_dwordx4 v231, s[24:27], s54 offen offset:3072 lds
    v_mfma_f32_16x16x32_bf16 v[176:179], v[80:83], a[244:247], v[176:179]
    s_waitcnt lgkmcnt(6)
    s_waitcnt vmcnt(17)
    s_barrier
    s_waitcnt vmcnt(7)
    s_add_u32 s3, s60, 3
    v_subrev_u32 v23, s3, v29
    v_cmp_ge_u32 vcc, 4, v23
    s_and_b64 vcc, vcc, s[90:91]
    s_cmp_eq_u64 vcc, s[90:91]
    s_cbranch_scc0 L_spino3
L_backo3:
    ds_read_b64_tr_b16 v[76:77], v235 offset:11008
    ds_read_b64_tr_b16 v[78:79], v235 offset:13568
    v_mfma_f32_16x16x32_bf16 v[180:183], v[60:63], a[100:103], v[180:183]
    v_mfma_f32_16x16x32_bf16 v[184:187], v[60:63], a[244:247], v[184:187]
    s_waitcnt lgkmcnt(6)
    ds_read_b64_tr_b16 v[80:81], v238 offset:11040
    ds_read_b64_tr_b16 v[82:83], v238 offset:13600
    v_mfma_f32_16x16x32_bf16 v[188:191], v[64:67], a[100:103], v[188:191]
    buffer_load_dwordx4 a[140:143], v240, s[16:19], s55 offen offset:1024 sc1
    v_mfma_f32_16x16x32_bf16 v[192:195], v[64:67], a[244:247], v[192:195]
    s_waitcnt lgkmcnt(6)
    ds_read_b64_tr_b16 v[60:61], v235 offset:11072
    ds_read_b64_tr_b16 v[62:63], v235 offset:13632
    v_mfma_f32_16x16x32_bf16 v[196:199], v[68:71], a[100:103], v[196:199]
    v_mfma_f32_16x16x32_bf16 v[200:203], v[68:71], a[244:247], v[200:203]
    s_waitcnt lgkmcnt(6)
    ds_read_b64_tr_b16 v[64:65], v238 offset:11104
    ds_read_b64_tr_b16 v[66:67], v238 offset:13664
    v_mfma_f32_16x16x32_bf16 v[204:207], v[72:75], a[100:103], v[204:207]
    s_add_u32 m0, s88, 86016
    v_mfma_f32_16x16x32_bf16 v[208:211], v[72:75], a[244:247], v[208:211]
    s_waitcnt lgkmcnt(6)
    ds_read_b64_tr_b16 v[68:69], v235 offset:11136
    ds_read_b64_tr_b16 v[70:71], v235 offset:13696
    v_mfma_f32_16x16x32_bf16 v[148:151], v[76:79], a[104:107], v[148:151]
    buffer_load_dwordx4 v232, s[24:27], s54 offen offset:0 lds
    v_mfma_f32_16x16x32_bf16 v[152:155], v[76:79], a[248:251], v[152:155]
    s_waitcnt lgkmcnt(6)
    ds_read_b64_tr_b16 v[72:73], v238 offset:11168
    ds_read_b64_tr_b16 v[74:75], v238 offset:13728
    v_mfma_f32_16x16x32_bf16 v[156:159], v[80:83], a[104:107], v[156:159]
    s_add_u32 s54, s51, 294912
    v_mfma_f32_16x16x32_bf16 v[160:163], v[80:83], a[248:251], v[160:163]
    s_waitcnt lgkmcnt(6)
    ds_read_b64_tr_b16 v[76:77], v235 offset:11200
    ds_read_b64_tr_b16 v[78:79], v235 offset:13760
    v_mfma_f32_16x16x32_bf16 v[164:167], v[60:63], a[104:107], v[164:167]
    s_add_u32 m0, s88, 0
    v_mfma_f32_16x16x32_bf16 v[168:171], v[60:63], a[248:251], v[168:171]
    s_waitcnt lgkmcnt(6)
    ds_read_b64_tr_b16 v[80:81], v238 offset:11232
    ds_read_b64_tr_b16 v[82:83], v238 offset:13792
    v_mfma_f32_16x16x32_bf16 v[172:175], v[64:67], a[104:107], v[172:175]
    buffer_load_dwordx4 v228, s[24:27], s54 offen offset:0 lds
    v_mfma_f32_16x16x32_bf16 v[176:179], v[64:67], a[248:251], v[176:179]
    s_waitcnt lgkmcnt(6)
    ds_read_b64_tr_b16 v[60:61], v235 offset:21248
    ds_read_b64_tr_b16 v[62:63], v235 offset:23808
    v_mfma_f32_16x16x32_bf16 v[180:183], v[68:71], a[104:107], v[180:183]
    s_add_u32 s55, s80, 65536
    buffer_load_dwordx4 a[0:3], v239, s[16:19], s55 offen offset:0 sc1
    v_mfma_f32_16x16x32_bf16 v[184:187], v[68:71], a[248:251], v[184:187]
    s_waitcnt lgkmcnt(6)
    ds_read_b64_tr_b16 v[64:65], v238 offset:21280
    ds_read_b64_tr_b16 v[66:67], v238 offset:23840
    v_mfma_f32_16x16x32_bf16 v[188:191], v[72:75], a[104:107], v[188:191]
    buffer_load_dwordx4 v229, s[24:27], s54 offen offset:1024 lds
    v_mfma_f32_16x16x32_bf16 v[192:195], v[72:75], a[248:251], v[192:195]
    s_waitcnt lgkmcnt(6)
    ds_read_b64_tr_b16 v[68:69], v235 offset:21312
    ds_read_b64_tr_b16 v[70:71], v235 offset:23872
    v_mfma_f32_16x16x32_bf16 v[196:199], v[76:79], a[104:107], v[196:199]
    buffer_load_dwordx4 a[144:147], v239, s[16:19], s55 offen offset:1024 sc1
    v_mfma_f32_16x16x32_bf16 v[200:203], v[76:79], a[248:251], v[200:203]
    s_waitcnt lgkmcnt(6)
    ds_read_b64_tr_b16 v[72:73], v238 offset:21344
    ds_read_b64_tr_b16 v[74:75], v238 offset:23904
    v_mfma_f32_16x16x32_bf16 v[204:207], v[80:83], a[104:107], v[204:207]
    v_mfma_f32_16x16x32_bf16 v[208:211], v[80:83], a[248:251], v[208:211]
    s_waitcnt lgkmcnt(6)
    ds_read_b64_tr_b16 v[76:77], v235 offset:21376
    ds_read_b64_tr_b16 v[78:79], v235 offset:23936
    v_mfma_f32_16x16x32_bf16 v[148:151], v[60:63], a[108:111], v[148:151]
    v_mfma_f32_16x16x32_bf16 v[152:155], v[60:63], a[252:255], v[152:155]
    s_waitcnt lgkmcnt(6)
    ds_read_b64_tr_b16 v[80:81], v238 offset:21408
    ds_read_b64_tr_b16 v[82:83], v238 offset:23968
    v_mfma_f32_16x16x32_bf16 v[156:159], v[64:67], a[108:111], v[156:159]
    buffer_load_dwordx4 v230, s[24:27], s54 offen offset:2048 lds
    v_mfma_f32_16x16x32_bf16 v[160:163], v[64:67], a[252:255], v[160:163]
    s_waitcnt lgkmcnt(6)
    ds_read_b64_tr_b16 v[60:61], v235 offset:21440
    ds_read_b64_tr_b16 v[62:63], v235 offset:24000
    v_mfma_f32_16x16x32_bf16 v[164:167], v[68:71], a[108:111], v[164:167]
    v_mfma_f32_16x16x32_bf16 v[168:171], v[68:71], a[252:255], v[168:171]
    s_waitcnt lgkmcnt(6)
    ds_read_b64_tr_b16 v[64:65], v238 offset:21472
    ds_read_b64_tr_b16 v[66:67], v238 offset:24032
    v_mfma_f32_16x16x32_bf16 v[172:175], v[72:75], a[108:111], v[172:175]
    buffer_load_dwordx4 a[4:7], v240, s[16:19], s55 offen offset:0 sc1
    v_mfma_f32_16x16x32_bf16 v[176:179], v[72:75], a[252:255], v[176:179]
    s_waitcnt lgkmcnt(6)
    s_barrier
    ds_read_b64_tr_b16 v[68:69], v233 offset:61440
    ds_read_b64_tr_b16 v[70:71], v233 offset:64000
    v_mfma_f32_16x16x32_bf16 v[180:183], v[76:79], a[108:111], v[180:183]
    v_mfma_f32_16x16x32_bf16 v[184:187], v[76:79], a[252:255], v[184:187]
    s_waitcnt lgkmcnt(6)
    ds_read_b64_tr_b16 v[72:73], v236 offset:61472
    ds_read_b64_tr_b16 v[74:75], v236 offset:64032
    v_mfma_f32_16x16x32_bf16 v[188:191], v[80:83], a[108:111], v[188:191]
    buffer_load_dwordx4 v231, s[24:27], s54 offen offset:3072 lds
    v_mfma_f32_16x16x32_bf16 v[192:195], v[80:83], a[252:255], v[192:195]
    s_waitcnt lgkmcnt(6)
    ds_read_b64_tr_b16 v[76:77], v233 offset:61504
    ds_read_b64_tr_b16 v[78:79], v233 offset:64064
    v_mfma_f32_16x16x32_bf16 v[196:199], v[60:63], a[108:111], v[196:199]
    v_mfma_f32_16x16x32_bf16 v[200:203], v[60:63], a[252:255], v[200:203]
    s_waitcnt lgkmcnt(6)
    ds_read_b64_tr_b16 v[80:81], v236 offset:61536
    ds_read_b64_tr_b16 v[82:83], v236 offset:64096
    v_mfma_f32_16x16x32_bf16 v[204:207], v[64:67], a[108:111], v[204:207]
    buffer_load_dwordx4 a[148:151], v240, s[16:19], s55 offen offset:1024 sc1
    v_mfma_f32_16x16x32_bf16 v[208:211], v[64:67], a[252:255], v[208:211]
    s_waitcnt lgkmcnt(6)
    ds_read_b64_tr_b16 v[60:61], v233 offset:61568
    ds_read_b64_tr_b16 v[62:63], v233 offset:64128
    v_mfma_f32_16x16x32_bf16 v[148:151], v[68:71], a[112:115], v[148:151]
    s_add_u32 s55, s82, 65536
    buffer_load_dwordx4 a[8:11], v239, s[16:19], s55 offen offset:0 sc1
    v_mfma_f32_16x16x32_bf16 v[152:155], v[68:71], a[116:119], v[152:155]
    s_waitcnt lgkmcnt(6)
    ds_read_b64_tr_b16 v[64:65], v236 offset:61600
    ds_read_b64_tr_b16 v[66:67], v236 offset:64160
    v_mfma_f32_16x16x32_bf16 v[156:159], v[72:75], a[112:115], v[156:159]
    buffer_load_dwordx4 a[152:155], v239, s[16:19], s55 offen offset:1024 sc1
    v_mfma_f32_16x16x32_bf16 v[160:163], v[72:75], a[116:119], v[160:163]
    s_waitcnt lgkmcnt(6)
    ds_read_b64_tr_b16 v[68:69], v233 offset:61632
    ds_read_b64_tr_b16 v[70:71], v233 offset:64192
    v_mfma_f32_16x16x32_bf16 v[164:167], v[76:79], a[112:115], v[164:167]
    buffer_load_dwordx4 a[12:15], v240, s[16:19], s55 offen offset:0 sc1
    v_mfma_f32_16x16x32_bf16 v[168:171], v[76:79], a[116:119], v[168:171]
    s_waitcnt lgkmcnt(6)
    ds_read_b64_tr_b16 v[72:73], v236 offset:61664
    ds_read_b64_tr_b16 v[74:75], v236 offset:64224
    v_mfma_f32_16x16x32_bf16 v[172:175], v[80:83], a[112:115], v[172:175]
    buffer_load_dwordx4 a[156:159], v240, s[16:19], s55 offen offset:1024 sc1
    v_mfma_f32_16x16x32_bf16 v[176:179], v[80:83], a[116:119], v[176:179]
    s_waitcnt lgkmcnt(6)
    ds_read_b64_tr_b16 v[76:77], v234 offset:6144
    ds_read_b64_tr_b16 v[78:79], v234 offset:8704
    v_mfma_f32_16x16x32_bf16 v[180:183], v[60:63], a[112:115], v[180:183]
    s_add_u32 m0, s88, 4096
    v_mfma_f32_16x16x32_bf16 v[184:187], v[60:63], a[116:119], v[184:187]
    s_waitcnt lgkmcnt(6)
    ds_read_b64_tr_b16 v[80:81], v237 offset:6176
    ds_read_b64_tr_b16 v[82:83], v237 offset:8736
    v_mfma_f32_16x16x32_bf16 v[188:191], v[64:67], a[112:115], v[188:191]
    buffer_load_dwordx4 v232, s[24:27], s54 offen offset:0 lds
    v_mfma_f32_16x16x32_bf16 v[192:195], v[64:67], a[116:119], v[192:195]
    s_waitcnt lgkmcnt(6)
    ds_read_b64_tr_b16 v[60:61], v234 offset:6208
    ds_read_b64_tr_b16 v[62:63], v234 offset:8768
    v_mfma_f32_16x16x32_bf16 v[196:199], v[68:71], a[112:115], v[196:199]
    s_add_u32 s54, s53, 294912
    v_mfma_f32_16x16x32_bf16 v[200:203], v[68:71], a[116:119], v[200:203]
    s_waitcnt lgkmcnt(6)
    ds_read_b64_tr_b16 v[64:65], v237 offset:6240
    ds_read_b64_tr_b16 v[66:67], v237 offset:8800
    v_mfma_f32_16x16x32_bf16 v[204:207], v[72:75], a[112:115], v[204:207]
    s_add_u32 m0, s88, 20480
    v_mfma_f32_16x16x32_bf16 v[208:211], v[72:75], a[116:119], v[208:211]
    s_waitcnt lgkmcnt(6)
    ds_read_b64_tr_b16 v[68:69], v234 offset:6272
    ds_read_b64_tr_b16 v[70:71], v234 offset:8832
    v_mfma_f32_16x16x32_bf16 v[148:151], v[76:79], a[120:123], v[148:151]
    buffer_load_dwordx4 v228, s[24:27], s54 offen offset:0 lds
    v_mfma_f32_16x16x32_bf16 v[152:155], v[76:79], a[124:127], v[152:155]
    s_waitcnt lgkmcnt(6)
    ds_read_b64_tr_b16 v[72:73], v237 offset:6304
    ds_read_b64_tr_b16 v[74:75], v237 offset:8864
    v_mfma_f32_16x16x32_bf16 v[156:159], v[80:83], a[120:123], v[156:159]
    buffer_load_dwordx4 v229, s[24:27], s54 offen offset:1024 lds
    v_mfma_f32_16x16x32_bf16 v[160:163], v[80:83], a[124:127], v[160:163]
    s_waitcnt lgkmcnt(6)
    ds_read_b64_tr_b16 v[76:77], v234 offset:6336
    ds_read_b64_tr_b16 v[78:79], v234 offset:8896
    v_mfma_f32_16x16x32_bf16 v[164:167], v[60:63], a[120:123], v[164:167]
    buffer_load_dwordx4 v230, s[24:27], s54 offen offset:2048 lds
    v_mfma_f32_16x16x32_bf16 v[168:171], v[60:63], a[124:127], v[168:171]
    s_waitcnt lgkmcnt(6)
    ds_read_b64_tr_b16 v[80:81], v237 offset:6368
    ds_read_b64_tr_b16 v[82:83], v237 offset:8928
    v_mfma_f32_16x16x32_bf16 v[172:175], v[64:67], a[120:123], v[172:175]
    buffer_load_dwordx4 v231, s[24:27], s54 offen offset:3072 lds
    v_mfma_f32_16x16x32_bf16 v[176:179], v[64:67], a[124:127], v[176:179]
    s_waitcnt lgkmcnt(6)
    s_waitcnt vmcnt(17)
    s_barrier
    ds_read_b64_tr_b16 v[60:61], v234 offset:16384
    ds_read_b64_tr_b16 v[62:63], v234 offset:18944
    v_mfma_f32_16x16x32_bf16 v[180:183], v[68:71], a[120:123], v[180:183]
    s_add_u32 m0, s88, 24576
    v_mfma_f32_16x16x32_bf16 v[184:187], v[68:71], a[124:127], v[184:187]
    s_waitcnt lgkmcnt(6)
    ds_read_b64_tr_b16 v[64:65], v237 offset:16416
    ds_read_b64_tr_b16 v[66:67], v237 offset:18976
    v_mfma_f32_16x16x32_bf16 v[188:191], v[72:75], a[120:123], v[188:191]
    buffer_load_dwordx4 v232, s[24:27], s54 offen offset:0 lds
    v_mfma_f32_16x16x32_bf16 v[192:195], v[72:75], a[124:127], v[192:195]
    s_waitcnt lgkmcnt(6)
    ds_read_b64_tr_b16 v[68:69], v234 offset:16448
    ds_read_b64_tr_b16 v[70:71], v234 offset:19008
    v_mfma_f32_16x16x32_bf16 v[196:199], v[76:79], a[120:123], v[196:199]
    v_mfma_f32_16x16x32_bf16 v[200:203], v[76:79], a[124:127], v[200:203]
    s_waitcnt lgkmcnt(6)
    ds_read_b64_tr_b16 v[72:73], v237 offset:16480
    ds_read_b64_tr_b16 v[74:75], v237 offset:19040
    v_mfma_f32_16x16x32_bf16 v[204:207], v[80:83], a[120:123], v[204:207]
    v_mfma_f32_16x16x32_bf16 v[208:211], v[80:83], a[124:127], v[208:211]
    s_waitcnt lgkmcnt(6)
    ds_read_b64_tr_b16 v[76:77], v234 offset:16512
    ds_read_b64_tr_b16 v[78:79], v234 offset:19072
    v_mfma_f32_16x16x32_bf16 v[148:151], v[60:63], a[128:131], v[148:151]
    v_mfma_f32_16x16x32_bf16 v[152:155], v[60:63], a[132:135], v[152:155]
    s_waitcnt lgkmcnt(6)
    ds_read_b64_tr_b16 v[80:81], v237 offset:16544
    ds_read_b64_tr_b16 v[82:83], v237 offset:19104
    v_mfma_f32_16x16x32_bf16 v[156:159], v[64:67], a[128:131], v[156:159]
    v_mfma_f32_16x16x32_bf16 v[160:163], v[64:67], a[132:135], v[160:163]
    s_waitcnt lgkmcnt(6)
    ds_read_b64_tr_b16 v[60:61], v234 offset:16576
    ds_read_b64_tr_b16 v[62:63], v234 offset:19136
    v_mfma_f32_16x16x32_bf16 v[164:167], v[68:71], a[128:131], v[164:167]
    v_mfma_f32_16x16x32_bf16 v[168:171], v[68:71], a[132:135], v[168:171]
    s_waitcnt lgkmcnt(6)
    ds_read_b64_tr_b16 v[64:65], v237 offset:16608
    ds_read_b64_tr_b16 v[66:67], v237 offset:19168
    v_mfma_f32_16x16x32_bf16 v[172:175], v[72:75], a[128:131], v[172:175]
    v_mfma_f32_16x16x32_bf16 v[176:179], v[72:75], a[132:135], v[176:179]
    s_waitcnt lgkmcnt(6)
    ds_read_b64_tr_b16 v[68:69], v234 offset:26624
    ds_read_b64_tr_b16 v[70:71], v234 offset:29184
    v_mfma_f32_16x16x32_bf16 v[180:183], v[76:79], a[128:131], v[180:183]
    v_mfma_f32_16x16x32_bf16 v[184:187], v[76:79], a[132:135], v[184:187]
    s_waitcnt lgkmcnt(6)
    ds_read_b64_tr_b16 v[72:73], v237 offset:26656
    ds_read_b64_tr_b16 v[74:75], v237 offset:29216
    v_mfma_f32_16x16x32_bf16 v[188:191], v[80:83], a[128:131], v[188:191]
    v_mfma_f32_16x16x32_bf16 v[192:195], v[80:83], a[132:135], v[192:195]
    s_waitcnt lgkmcnt(6)
    ds_read_b64_tr_b16 v[76:77], v234 offset:26688
    ds_read_b64_tr_b16 v[78:79], v234 offset:29248
    v_mfma_f32_16x16x32_bf16 v[196:199], v[60:63], a[128:131], v[196:199]
    v_mfma_f32_16x16x32_bf16 v[200:203], v[60:63], a[132:135], v[200:203]
    s_waitcnt lgkmcnt(6)
    ds_read_b64_tr_b16 v[80:81], v237 offset:26720
    ds_read_b64_tr_b16 v[82:83], v237 offset:29280
    v_mfma_f32_16x16x32_bf16 v[204:207], v[64:67], a[128:131], v[204:207]
    v_mfma_f32_16x16x32_bf16 v[208:211], v[64:67], a[132:135], v[208:211]
    s_waitcnt lgkmcnt(6)
    ds_read_b64_tr_b16 v[60:61], v234 offset:26752
    ds_read_b64_tr_b16 v[62:63], v234 offset:29312
    v_mfma_f32_16x16x32_bf16 v[148:151], v[68:71], a[136:139], v[148:151]
    v_mfma_f32_16x16x32_bf16 v[152:155], v[68:71], a[140:143], v[152:155]
    s_waitcnt lgkmcnt(6)
    ds_read_b64_tr_b16 v[64:65], v237 offset:26784
    ds_read_b64_tr_b16 v[66:67], v237 offset:29344
    v_mfma_f32_16x16x32_bf16 v[156:159], v[72:75], a[136:139], v[156:159]
    v_mfma_f32_16x16x32_bf16 v[160:163], v[72:75], a[140:143], v[160:163]
    s_waitcnt lgkmcnt(6)
    ds_read_b64_tr_b16 v[68:69], v234 offset:26816
    ds_read_b64_tr_b16 v[70:71], v234 offset:29376
    v_mfma_f32_16x16x32_bf16 v[164:167], v[76:79], a[136:139], v[164:167]
    v_mfma_f32_16x16x32_bf16 v[168:171], v[76:79], a[140:143], v[168:171]
    s_waitcnt lgkmcnt(6)
    ds_read_b64_tr_b16 v[72:73], v237 offset:26848
    ds_read_b64_tr_b16 v[74:75], v237 offset:29408
    v_mfma_f32_16x16x32_bf16 v[172:175], v[80:83], a[136:139], v[172:175]
    v_mfma_f32_16x16x32_bf16 v[176:179], v[80:83], a[140:143], v[176:179]
    s_waitcnt lgkmcnt(6)
    s_waitcnt vmcnt(0)
    s_barrier
    ds_read_b64_tr_b16 v[76:77], v233 offset:0
    ds_read_b64_tr_b16 v[78:79], v233 offset:2560
    v_mfma_f32_16x16x32_bf16 v[180:183], v[60:63], a[136:139], v[180:183]
    v_mfma_f32_16x16x32_bf16 v[184:187], v[60:63], a[140:143], v[184:187]
    s_waitcnt lgkmcnt(6)
    ds_read_b64_tr_b16 v[80:81], v233 offset:10240
    ds_read_b64_tr_b16 v[82:83], v233 offset:12800
    v_mfma_f32_16x16x32_bf16 v[188:191], v[64:67], a[136:139], v[188:191]
    v_mfma_f32_16x16x32_bf16 v[192:195], v[64:67], a[140:143], v[192:195]
    s_waitcnt lgkmcnt(6)
    ds_read_b64_tr_b16 v[60:61], v233 offset:20480
    ds_read_b64_tr_b16 v[62:63], v233 offset:23040
    v_mfma_f32_16x16x32_bf16 v[196:199], v[68:71], a[136:139], v[196:199]
    v_mfma_f32_16x16x32_bf16 v[200:203], v[68:71], a[140:143], v[200:203]
    s_waitcnt lgkmcnt(6)
    ds_read_b64_tr_b16 v[64:65], v233 offset:30720
    ds_read_b64_tr_b16 v[66:67], v233 offset:33280
    v_mfma_f32_16x16x32_bf16 v[204:207], v[72:75], a[136:139], v[204:207]
    v_mfma_f32_16x16x32_bf16 v[208:211], v[72:75], a[140:143], v[208:211]
    s_waitcnt lgkmcnt(6)
    ds_read_b64_tr_b16 v[68:69], v236 offset:32
    ds_read_b64_tr_b16 v[70:71], v236 offset:2592
    v_mfma_f32_16x16x32_bf16 v[148:151], v[76:79], a[0:3], v[148:151]
    v_mfma_f32_16x16x32_bf16 v[152:155], v[76:79], a[144:147], v[152:155]
    s_waitcnt lgkmcnt(6)
    ds_read_b64_tr_b16 v[72:73], v236 offset:10272
    ds_read_b64_tr_b16 v[74:75], v236 offset:12832
    v_mfma_f32_16x16x32_bf16 v[148:151], v[80:83], a[4:7], v[148:151]
    v_mfma_f32_16x16x32_bf16 v[152:155], v[80:83], a[148:151], v[152:155]
    s_waitcnt lgkmcnt(6)
    ds_read_b64_tr_b16 v[76:77], v236 offset:20512
    ds_read_b64_tr_b16 v[78:79], v236 offset:23072
    v_mfma_f32_16x16x32_bf16 v[148:151], v[60:63], a[8:11], v[148:151]
    v_mfma_f32_16x16x32_bf16 v[152:155], v[60:63], a[152:155], v[152:155]
    s_waitcnt lgkmcnt(6)
    ds_read_b64_tr_b16 v[80:81], v236 offset:30752
    ds_read_b64_tr_b16 v[82:83], v236 offset:33312
    v_mfma_f32_16x16x32_bf16 v[148:151], v[64:67], a[12:15], v[148:151]
    v_mfma_f32_16x16x32_bf16 v[152:155], v[64:67], a[156:159], v[152:155]
    s_waitcnt lgkmcnt(6)
    ds_read_b64_tr_b16 v[60:61], v233 offset:64
    ds_read_b64_tr_b16 v[62:63], v233 offset:2624
    v_mfma_f32_16x16x32_bf16 v[156:159], v[68:71], a[0:3], v[156:159]
    v_mfma_f32_16x16x32_bf16 v[160:163], v[68:71], a[144:147], v[160:163]
    s_waitcnt lgkmcnt(6)
    ds_read_b64_tr_b16 v[64:65], v233 offset:10304
    ds_read_b64_tr_b16 v[66:67], v233 offset:12864
    v_mfma_f32_16x16x32_bf16 v[156:159], v[72:75], a[4:7], v[156:159]
    v_mfma_f32_16x16x32_bf16 v[160:163], v[72:75], a[148:151], v[160:163]
    s_waitcnt lgkmcnt(6)
    ds_read_b64_tr_b16 v[68:69], v233 offset:20544
    ds_read_b64_tr_b16 v[70:71], v233 offset:23104
    v_mfma_f32_16x16x32_bf16 v[156:159], v[76:79], a[8:11], v[156:159]
    v_cvt_pk_bf16_f32 v44, v148, v149
    v_cvt_pk_bf16_f32 v45, v150, v151
    v_mfma_f32_16x16x32_bf16 v[160:163], v[76:79], a[152:155], v[160:163]
    s_waitcnt lgkmcnt(6)
    ds_read_b64_tr_b16 v[72:73], v233 offset:30784
    ds_read_b64_tr_b16 v[74:75], v233 offset:33344
    v_mfma_f32_16x16x32_bf16 v[156:159], v[80:83], a[12:15], v[156:159]
    v_cvt_pk_bf16_f32 v46, v152, v153
    v_cvt_pk_bf16_f32 v47, v154, v155
    v_mfma_f32_16x16x32_bf16 v[160:163], v[80:83], a[156:159], v[160:163]
    s_waitcnt lgkmcnt(6)
    ds_read_b64_tr_b16 v[76:77], v236 offset:96
    ds_read_b64_tr_b16 v[78:79], v236 offset:2656
    v_mfma_f32_16x16x32_bf16 v[164:167], v[60:63], a[0:3], v[164:167]
    buffer_store_dwordx4 v[44:47], v8, s[16:19], s61 offen sc1
    v_mfma_f32_16x16x32_bf16 v[168:171], v[60:63], a[144:147], v[168:171]
    s_waitcnt lgkmcnt(6)
    ds_read_b64_tr_b16 v[80:81], v236 offset:10336
    ds_read_b64_tr_b16 v[82:83], v236 offset:12896
    v_mfma_f32_16x16x32_bf16 v[164:167], v[64:67], a[4:7], v[164:167]
    v_mfma_f32_16x16x32_bf16 v[168:171], v[64:67], a[148:151], v[168:171]
    s_waitcnt lgkmcnt(6)
    ds_read_b64_tr_b16 v[60:61], v236 offset:20576
    ds_read_b64_tr_b16 v[62:63], v236 offset:23136
    v_mfma_f32_16x16x32_bf16 v[164:167], v[68:71], a[8:11], v[164:167]
    v_cvt_pk_bf16_f32 v48, v156, v157
    v_cvt_pk_bf16_f32 v49, v158, v159
    v_mfma_f32_16x16x32_bf16 v[168:171], v[68:71], a[152:155], v[168:171]
    s_waitcnt lgkmcnt(6)
    ds_read_b64_tr_b16 v[64:65], v236 offset:30816
    ds_read_b64_tr_b16 v[66:67], v236 offset:33376
    v_mfma_f32_16x16x32_bf16 v[164:167], v[72:75], a[12:15], v[164:167]
    v_cvt_pk_bf16_f32 v50, v160, v161
    v_cvt_pk_bf16_f32 v51, v162, v163
    v_mfma_f32_16x16x32_bf16 v[168:171], v[72:75], a[156:159], v[168:171]
    s_waitcnt lgkmcnt(6)
    ds_read_b64_tr_b16 v[68:69], v233 offset:128
    ds_read_b64_tr_b16 v[70:71], v233 offset:2688
    v_mfma_f32_16x16x32_bf16 v[172:175], v[76:79], a[0:3], v[172:175]
    buffer_store_dwordx4 v[48:51], v8, s[16:19], s62 offen sc1
    v_mfma_f32_16x16x32_bf16 v[176:179], v[76:79], a[144:147], v[176:179]
    s_waitcnt lgkmcnt(6)
    ds_read_b64_tr_b16 v[72:73], v233 offset:10368
    ds_read_b64_tr_b16 v[74:75], v233 offset:12928
    v_mfma_f32_16x16x32_bf16 v[172:175], v[80:83], a[4:7], v[172:175]
    v_mfma_f32_16x16x32_bf16 v[176:179], v[80:83], a[148:151], v[176:179]
    s_waitcnt lgkmcnt(6)
    ds_read_b64_tr_b16 v[76:77], v233 offset:20608
    ds_read_b64_tr_b16 v[78:79], v233 offset:23168
    v_mfma_f32_16x16x32_bf16 v[172:175], v[60:63], a[8:11], v[172:175]
    v_cvt_pk_bf16_f32 v52, v164, v165
    v_cvt_pk_bf16_f32 v53, v166, v167
    v_mfma_f32_16x16x32_bf16 v[176:179], v[60:63], a[152:155], v[176:179]
    s_waitcnt lgkmcnt(6)
    ds_read_b64_tr_b16 v[80:81], v233 offset:30848
    ds_read_b64_tr_b16 v[82:83], v233 offset:33408
    v_mfma_f32_16x16x32_bf16 v[172:175], v[64:67], a[12:15], v[172:175]
    v_cvt_pk_bf16_f32 v54, v168, v169
    v_cvt_pk_bf16_f32 v55, v170, v171
    v_mfma_f32_16x16x32_bf16 v[176:179], v[64:67], a[156:159], v[176:179]
    s_waitcnt lgkmcnt(6)
    ds_read_b64_tr_b16 v[60:61], v236 offset:160
    ds_read_b64_tr_b16 v[62:63], v236 offset:2720
    v_mfma_f32_16x16x32_bf16 v[180:183], v[68:71], a[0:3], v[180:183]
    buffer_store_dwordx4 v[52:55], v8, s[16:19], s63 offen sc1
    v_mfma_f32_16x16x32_bf16 v[184:187], v[68:71], a[144:147], v[184:187]
    s_waitcnt lgkmcnt(6)
    ds_read_b64_tr_b16 v[64:65], v236 offset:10400
    ds_read_b64_tr_b16 v[66:67], v236 offset:12960
    v_mfma_f32_16x16x32_bf16 v[180:183], v[72:75], a[4:7], v[180:183]
    v_mfma_f32_16x16x32_bf16 v[184:187], v[72:75], a[148:151], v[184:187]
    s_waitcnt lgkmcnt(6)
    ds_read_b64_tr_b16 v[68:69], v236 offset:20640
    ds_read_b64_tr_b16 v[70:71], v236 offset:23200
    v_mfma_f32_16x16x32_bf16 v[180:183], v[76:79], a[8:11], v[180:183]
    v_cvt_pk_bf16_f32 v56, v172, v173
    v_cvt_pk_bf16_f32 v57, v174, v175
    v_mfma_f32_16x16x32_bf16 v[184:187], v[76:79], a[152:155], v[184:187]
    s_waitcnt lgkmcnt(6)
    ds_read_b64_tr_b16 v[72:73], v236 offset:30880
    ds_read_b64_tr_b16 v[74:75], v236 offset:33440
    v_mfma_f32_16x16x32_bf16 v[180:183], v[80:83], a[12:15], v[180:183]
    v_cvt_pk_bf16_f32 v58, v176, v177
    v_cvt_pk_bf16_f32 v59, v178, v179
    v_mfma_f32_16x16x32_bf16 v[184:187], v[80:83], a[156:159], v[184:187]
    s_waitcnt lgkmcnt(6)
    ds_read_b64_tr_b16 v[76:77], v233 offset:192
    ds_read_b64_tr_b16 v[78:79], v233 offset:2752
    v_mfma_f32_16x16x32_bf16 v[188:191], v[60:63], a[0:3], v[188:191]
    buffer_store_dwordx4 v[56:59], v8, s[16:19], s64 offen sc1
    v_mfma_f32_16x16x32_bf16 v[192:195], v[60:63], a[144:147], v[192:195]
    s_waitcnt lgkmcnt(6)
    ds_read_b64_tr_b16 v[80:81], v233 offset:10432
    ds_read_b64_tr_b16 v[82:83], v233 offset:12992
    v_mfma_f32_16x16x32_bf16 v[188:191], v[64:67], a[4:7], v[188:191]
    v_mfma_f32_16x16x32_bf16 v[192:195], v[64:67], a[148:151], v[192:195]
    s_waitcnt lgkmcnt(6)
    ds_read_b64_tr_b16 v[60:61], v233 offset:20672
    ds_read_b64_tr_b16 v[62:63], v233 offset:23232
    v_mfma_f32_16x16x32_bf16 v[188:191], v[68:71], a[8:11], v[188:191]
    v_cvt_pk_bf16_f32 v44, v180, v181
    v_cvt_pk_bf16_f32 v45, v182, v183
    v_mfma_f32_16x16x32_bf16 v[192:195], v[68:71], a[152:155], v[192:195]
    s_waitcnt lgkmcnt(6)
    ds_read_b64_tr_b16 v[64:65], v233 offset:30912
    ds_read_b64_tr_b16 v[66:67], v233 offset:33472
    v_mfma_f32_16x16x32_bf16 v[188:191], v[72:75], a[12:15], v[188:191]
    v_cvt_pk_bf16_f32 v46, v184, v185
    v_cvt_pk_bf16_f32 v47, v186, v187
    v_mfma_f32_16x16x32_bf16 v[192:195], v[72:75], a[156:159], v[192:195]
    s_waitcnt lgkmcnt(6)
    ds_read_b64_tr_b16 v[68:69], v236 offset:224
    ds_read_b64_tr_b16 v[70:71], v236 offset:2784
    v_mfma_f32_16x16x32_bf16 v[196:199], v[76:79], a[0:3], v[196:199]
    buffer_store_dwordx4 v[44:47], v8, s[16:19], s65 offen sc1
    v_mfma_f32_16x16x32_bf16 v[200:203], v[76:79], a[144:147], v[200:203]
    s_waitcnt lgkmcnt(6)
    ds_read_b64_tr_b16 v[72:73], v236 offset:10464
    ds_read_b64_tr_b16 v[74:75], v236 offset:13024
    v_mfma_f32_16x16x32_bf16 v[196:199], v[80:83], a[4:7], v[196:199]
    v_mfma_f32_16x16x32_bf16 v[200:203], v[80:83], a[148:151], v[200:203]
    s_waitcnt lgkmcnt(6)
    ds_read_b64_tr_b16 v[76:77], v236 offset:20704
    ds_read_b64_tr_b16 v[78:79], v236 offset:23264
    v_mfma_f32_16x16x32_bf16 v[196:199], v[60:63], a[8:11], v[196:199]
    v_cvt_pk_bf16_f32 v48, v188, v189
    v_cvt_pk_bf16_f32 v49, v190, v191
    v_mfma_f32_16x16x32_bf16 v[200:203], v[60:63], a[152:155], v[200:203]
    s_waitcnt lgkmcnt(6)
    ds_read_b64_tr_b16 v[80:81], v236 offset:30944
    ds_read_b64_tr_b16 v[82:83], v236 offset:33504
    v_mfma_f32_16x16x32_bf16 v[196:199], v[64:67], a[12:15], v[196:199]
    v_cvt_pk_bf16_f32 v50, v192, v193
    v_cvt_pk_bf16_f32 v51, v194, v195
    v_mfma_f32_16x16x32_bf16 v[200:203], v[64:67], a[156:159], v[200:203]
    s_waitcnt lgkmcnt(6)
    ds_read_b64_tr_b16 v[60:61], v233 offset:41216
    ds_read_b64_tr_b16 v[62:63], v233 offset:43776
    v_mfma_f32_16x16x32_bf16 v[204:207], v[68:71], a[0:3], v[204:207]
    buffer_store_dwordx4 v[48:51], v8, s[16:19], s66 offen sc1
    v_mfma_f32_16x16x32_bf16 v[208:211], v[68:71], a[144:147], v[208:211]
    s_waitcnt lgkmcnt(6)
    ds_read_b64_tr_b16 v[64:65], v236 offset:41248
    ds_read_b64_tr_b16 v[66:67], v236 offset:43808
    v_mfma_f32_16x16x32_bf16 v[204:207], v[72:75], a[4:7], v[204:207]
    v_mfma_f32_16x16x32_bf16 v[208:211], v[72:75], a[148:151], v[208:211]
    s_waitcnt lgkmcnt(6)
    ds_read_b64_tr_b16 v[68:69], v233 offset:51456
    ds_read_b64_tr_b16 v[70:71], v233 offset:54016
    v_mfma_f32_16x16x32_bf16 v[204:207], v[76:79], a[8:11], v[204:207]
    v_cvt_pk_bf16_f32 v52, v196, v197
    v_cvt_pk_bf16_f32 v53, v198, v199
    v_mfma_f32_16x16x32_bf16 v[208:211], v[76:79], a[152:155], v[208:211]
    s_waitcnt lgkmcnt(6)
    ds_read_b64_tr_b16 v[72:73], v236 offset:51488
    ds_read_b64_tr_b16 v[74:75], v236 offset:54048
    v_mfma_f32_16x16x32_bf16 v[204:207], v[80:83], a[12:15], v[204:207]
    v_cvt_pk_bf16_f32 v54, v200, v201
    v_cvt_pk_bf16_f32 v55, v202, v203
    v_mfma_f32_16x16x32_bf16 v[208:211], v[80:83], a[156:159], v[208:211]
    s_waitcnt lgkmcnt(6)
    ds_read_b64_tr_b16 v[76:77], v235 offset:11264
    ds_read_b64_tr_b16 v[78:79], v235 offset:13824
    v_mfma_f32_16x16x32_bf16 v[212:215], v[60:63], a[96:99], v[212:215]
    buffer_store_dwordx4 v[52:55], v8, s[16:19], s67 offen sc1
    v_mfma_f32_16x16x32_bf16 v[216:219], v[60:63], a[240:243], v[216:219]
    s_waitcnt lgkmcnt(6)
    ds_read_b64_tr_b16 v[80:81], v238 offset:11296
    ds_read_b64_tr_b16 v[82:83], v238 offset:13856
    v_mfma_f32_16x16x32_bf16 v[220:223], v[64:67], a[96:99], v[220:223]
    v_mfma_f32_16x16x32_bf16 v[224:227], v[64:67], a[240:243], v[224:227]
    s_waitcnt lgkmcnt(6)
    ds_read_b64_tr_b16 v[60:61], v235 offset:21504
    ds_read_b64_tr_b16 v[62:63], v235 offset:24064
    v_mfma_f32_16x16x32_bf16 v[212:215], v[68:71], a[100:103], v[212:215]
    v_cvt_pk_bf16_f32 v56, v204, v205
    v_cvt_pk_bf16_f32 v57, v206, v207
    v_mfma_f32_16x16x32_bf16 v[216:219], v[68:71], a[244:247], v[216:219]
    s_waitcnt lgkmcnt(6)
    ds_read_b64_tr_b16 v[64:65], v238 offset:21536
    ds_read_b64_tr_b16 v[66:67], v238 offset:24096
    v_mfma_f32_16x16x32_bf16 v[220:223], v[72:75], a[100:103], v[220:223]
    v_cvt_pk_bf16_f32 v58, v208, v209
    v_cvt_pk_bf16_f32 v59, v210, v211
    v_mfma_f32_16x16x32_bf16 v[224:227], v[72:75], a[244:247], v[224:227]
    s_waitcnt lgkmcnt(6)
    ds_read_b64_tr_b16 v[68:69], v233 offset:61696
    ds_read_b64_tr_b16 v[70:71], v233 offset:64256
    v_mfma_f32_16x16x32_bf16 v[212:215], v[76:79], a[104:107], v[212:215]
    buffer_store_dwordx4 v[56:59], v8, s[16:19], s68 offen sc1
    v_mfma_f32_16x16x32_bf16 v[216:219], v[76:79], a[248:251], v[216:219]
    s_waitcnt lgkmcnt(6)
    ds_read_b64_tr_b16 v[72:73], v236 offset:61728
    ds_read_b64_tr_b16 v[74:75], v236 offset:64288
    v_mfma_f32_16x16x32_bf16 v[220:223], v[80:83], a[104:107], v[220:223]
    v_mfma_f32_16x16x32_bf16 v[224:227], v[80:83], a[248:251], v[224:227]
    s_waitcnt lgkmcnt(6)
    ds_read_b64_tr_b16 v[76:77], v234 offset:6400
    ds_read_b64_tr_b16 v[78:79], v234 offset:8960
    v_mfma_f32_16x16x32_bf16 v[212:215], v[60:63], a[108:111], v[212:215]
    v_mfma_f32_16x16x32_bf16 v[216:219], v[60:63], a[252:255], v[216:219]
    s_waitcnt lgkmcnt(6)
    ds_read_b64_tr_b16 v[80:81], v237 offset:6432
    ds_read_b64_tr_b16 v[82:83], v237 offset:8992
    v_mfma_f32_16x16x32_bf16 v[220:223], v[64:67], a[108:111], v[220:223]
    v_mfma_f32_16x16x32_bf16 v[224:227], v[64:67], a[252:255], v[224:227]
    s_waitcnt lgkmcnt(6)
    ds_read_b64_tr_b16 v[60:61], v234 offset:16640
    ds_read_b64_tr_b16 v[62:63], v234 offset:19200
    v_mfma_f32_16x16x32_bf16 v[212:215], v[68:71], a[112:115], v[212:215]
    v_mfma_f32_16x16x32_bf16 v[216:219], v[68:71], a[116:119], v[216:219]
    s_waitcnt lgkmcnt(6)
    ds_read_b64_tr_b16 v[64:65], v237 offset:16672
    ds_read_b64_tr_b16 v[66:67], v237 offset:19232
    v_mfma_f32_16x16x32_bf16 v[220:223], v[72:75], a[112:115], v[220:223]
    v_mfma_f32_16x16x32_bf16 v[224:227], v[72:75], a[116:119], v[224:227]
    s_waitcnt lgkmcnt(6)
    ds_read_b64_tr_b16 v[68:69], v234 offset:26880
    ds_read_b64_tr_b16 v[70:71], v234 offset:29440
    v_mfma_f32_16x16x32_bf16 v[212:215], v[76:79], a[120:123], v[212:215]
    v_mfma_f32_16x16x32_bf16 v[216:219], v[76:79], a[124:127], v[216:219]
    s_waitcnt lgkmcnt(6)
    ds_read_b64_tr_b16 v[72:73], v237 offset:26912
    ds_read_b64_tr_b16 v[74:75], v237 offset:29472
    v_mfma_f32_16x16x32_bf16 v[220:223], v[80:83], a[120:123], v[220:223]
    v_mfma_f32_16x16x32_bf16 v[224:227], v[80:83], a[124:127], v[224:227]
    s_waitcnt lgkmcnt(6)
    ds_read_b64_tr_b16 v[76:77], v233 offset:256
    ds_read_b64_tr_b16 v[78:79], v233 offset:2816
    v_mfma_f32_16x16x32_bf16 v[212:215], v[60:63], a[128:131], v[212:215]
    v_mfma_f32_16x16x32_bf16 v[216:219], v[60:63], a[132:135], v[216:219]
    s_waitcnt lgkmcnt(6)
    ds_read_b64_tr_b16 v[80:81], v236 offset:288
    ds_read_b64_tr_b16 v[82:83], v236 offset:2848
    v_mfma_f32_16x16x32_bf16 v[220:223], v[64:67], a[128:131], v[220:223]
    v_mfma_f32_16x16x32_bf16 v[224:227], v[64:67], a[132:135], v[224:227]
    s_waitcnt lgkmcnt(6)
    ds_read_b64_tr_b16 v[60:61], v233 offset:10496
    ds_read_b64_tr_b16 v[62:63], v233 offset:13056
    v_mfma_f32_16x16x32_bf16 v[212:215], v[68:71], a[136:139], v[212:215]
    v_mfma_f32_16x16x32_bf16 v[216:219], v[68:71], a[140:143], v[216:219]
    s_waitcnt lgkmcnt(6)
    ds_read_b64_tr_b16 v[64:65], v236 offset:10528
    ds_read_b64_tr_b16 v[66:67], v236 offset:13088
    v_mfma_f32_16x16x32_bf16 v[220:223], v[72:75], a[136:139], v[220:223]
    v_mfma_f32_16x16x32_bf16 v[224:227], v[72:75], a[140:143], v[224:227]
    s_waitcnt lgkmcnt(6)
    ds_read_b64_tr_b16 v[68:69], v233 offset:20736
    ds_read_b64_tr_b16 v[70:71], v233 offset:23296
    s_or_b32 s3, s60, 6
    v_mov_b32 v243, s3
    s_waitcnt vmcnt(0)
    s_barrier
    buffer_store_dword v243, v241, s[16:19], 0 offen sc1
    v_mfma_f32_16x16x32_bf16 v[212:215], v[76:79], a[0:3], v[212:215]
    v_mfma_f32_16x16x32_bf16 v[216:219], v[76:79], a[144:147], v[216:219]
    s_waitcnt lgkmcnt(6)
    ds_read_b64_tr_b16 v[72:73], v236 offset:20768
    ds_read_b64_tr_b16 v[74:75], v236 offset:23328
    v_mfma_f32_16x16x32_bf16 v[220:223], v[80:83], a[0:3], v[220:223]
    v_mfma_f32_16x16x32_bf16 v[224:227], v[80:83], a[144:147], v[224:227]
    s_waitcnt lgkmcnt(6)
    ds_read_b64_tr_b16 v[76:77], v233 offset:30976
    ds_read_b64_tr_b16 v[78:79], v233 offset:33536
    v_mfma_f32_16x16x32_bf16 v[212:215], v[60:63], a[4:7], v[212:215]
    v_mfma_f32_16x16x32_bf16 v[216:219], v[60:63], a[148:151], v[216:219]
    s_waitcnt lgkmcnt(6)
    ds_read_b64_tr_b16 v[80:81], v236 offset:31008
    ds_read_b64_tr_b16 v[82:83], v236 offset:33568
    v_mfma_f32_16x16x32_bf16 v[220:223], v[64:67], a[4:7], v[220:223]
    v_mfma_f32_16x16x32_bf16 v[224:227], v[64:67], a[148:151], v[224:227]
    s_waitcnt lgkmcnt(6)
    v_mfma_f32_16x16x32_bf16 v[212:215], v[68:71], a[8:11], v[212:215]
    v_mfma_f32_16x16x32_bf16 v[216:219], v[68:71], a[152:155], v[216:219]
    s_waitcnt lgkmcnt(4)
    v_mfma_f32_16x16x32_bf16 v[220:223], v[72:75], a[8:11], v[220:223]
    v_mfma_f32_16x16x32_bf16 v[224:227], v[72:75], a[152:155], v[224:227]
    s_waitcnt lgkmcnt(2)
    v_mfma_f32_16x16x32_bf16 v[212:215], v[76:79], a[12:15], v[212:215]
    v_mfma_f32_16x16x32_bf16 v[216:219], v[76:79], a[156:159], v[216:219]
    s_waitcnt lgkmcnt(0)
    v_mfma_f32_16x16x32_bf16 v[220:223], v[80:83], a[12:15], v[220:223]
    v_mfma_f32_16x16x32_bf16 v[224:227], v[80:83], a[156:159], v[224:227]
    s_nop 3
    buffer_load_dword v29, v242, s[16:19], 0 offen sc1
    v_and_b32 v30, 15, v1
    v_mul_u32_u24 v30, 1152, v30
    v_bfe_u32 v32, v1, 4, 1
    v_lshl_add_u32 v30, v32, 5, v30
    v_lshrrev_b32 v32, 5, v1
    v_lshl_add_u32 v30, v32, 4, v30
    v_add_u32 v31, 18432, v30
    v_lshlrev_b32 v34, 16, v246
    v_and_b32 v35, 0xffff0000, v246
    v_lshlrev_b32 v32, 16, v247
    v_and_b32 v33, 0xffff0000, v247
    v_add_f32 v212, v212, v34
    v_add_f32 v213, v213, v35
    v_add_f32 v214, v214, v32
    v_add_f32 v215, v215, v33
    v_add_f32 v216, v216, v34
    v_add_f32 v217, v217, v35
    v_add_f32 v218, v218, v32
    v_add_f32 v219, v219, v33
    v_lshlrev_b32 v34, 16, v248
    v_and_b32 v35, 0xffff0000, v248
    v_lshlrev_b32 v32, 16, v249
    v_and_b32 v33, 0xffff0000, v249
    v_add_f32 v220, v220, v34
    v_add_f32 v221, v221, v35
    v_add_f32 v222, v222, v32
    v_add_f32 v223, v223, v33
    v_add_f32 v224, v224, v34
    v_add_f32 v225, v225, v35
    v_add_f32 v226, v226, v32
    v_add_f32 v227, v227, v33
    v_lshlrev_b32 v34, 16, v250
    v_and_b32 v35, 0xffff0000, v250
    v_lshlrev_b32 v32, 16, v251
    v_and_b32 v33, 0xffff0000, v251
    v_add_f32 v196, v196, v34
    v_add_f32 v197, v197, v35
    v_add_f32 v198, v198, v32
    v_add_f32 v199, v199, v33
    v_add_f32 v200, v200, v34
    v_add_f32 v201, v201, v35
    v_add_f32 v202, v202, v32
    v_add_f32 v203, v203, v33
    v_lshlrev_b32 v34, 16, v252
    v_and_b32 v35, 0xffff0000, v252
    v_lshlrev_b32 v32, 16, v253
    v_and_b32 v33, 0xffff0000, v253
    v_add_f32 v204, v204, v34
    v_add_f32 v205, v205, v35
    v_add_f32 v206, v206, v32
    v_add_f32 v207, v207, v33
    v_add_f32 v208, v208, v34
    v_add_f32 v209, v209, v35
    v_add_f32 v210, v210, v32
    v_add_f32 v211, v211, v33
    v_add_u32 v36, 16384, v8
    s_add_u32 s3, s58, 1
    s_and_b32 s3, s3, 3
    s_lshl_b32 s61, s3, 12
    s_add_u32 s3, s58, 2
    s_and_b32 s3, s3, 3
    s_lshl_b32 s62, s3, 12
    s_add_u32 s3, s58, 3
    s_and_b32 s3, s3, 3
    s_lshl_b32 s63, s3, 12
    s_waitcnt vmcnt(0)
    s_add_u32 s3, s60, 6
    v_subrev_u32 v23, s3, v29
    v_cmp_ge_u32 vcc, 1, v23
    s_and_b64 vcc, vcc, s[92:93]
    s_cmp_eq_u64 vcc, s[92:93]
    s_cbranch_scc0 L_spinoF
L_backoF:
    s_cmp_lg_u32 s58, s56
    s_cbranch_scc1 L_twoo
    s_add_u32 s3, s61, s69
    buffer_load_dwordx4 v[84:87], v8, s[16:19], s3 offen sc1
    s_add_u32 s3, s62, s69
    buffer_load_dwordx4 v[88:91], v8, s[16:19], s3 offen sc1
    s_add_u32 s3, s63, s69
    buffer_load_dwordx4 v[92:95], v8, s[16:19], s3 offen sc1
    s_add_u32 s3, s61, s69
    buffer_load_dwordx4 v[96:99], v36, s[16:19], s3 offen sc1
    s_add_u32 s3, s62, s69
    buffer_load_dwordx4 v[100:103], v36, s[16:19], s3 offen sc1
    s_add_u32 s3, s63, s69
    buffer_load_dwordx4 v[104:107], v36, s[16:19], s3 offen sc1
    s_add_u32 s3, s61, s70
    buffer_load_dwordx4 v[108:111], v8, s[16:19], s3 offen sc1
    s_add_u32 s3, s62, s70
    buffer_load_dwordx4 v[112:115], v8, s[16:19], s3 offen sc1
    s_add_u32 s3, s63, s70
    buffer_load_dwordx4 v[116:119], v8, s[16:19], s3 offen sc1
    s_add_u32 s3, s61, s70
    buffer_load_dwordx4 v[120:123], v36, s[16:19], s3 offen sc1
    s_add_u32 s3, s62, s70
    buffer_load_dwordx4 v[124:127], v36, s[16:19], s3 offen sc1
    s_add_u32 s3, s63, s70
    buffer_load_dwordx4 v[128:131], v36, s[16:19], s3 offen sc1
    s_waitcnt vmcnt(11)
    v_lshlrev_b32 v38, 16, v84
    v_and_b32 v39, 0xffff0000, v84
    v_add_f32 v212, v212, v38
    v_add_f32 v213, v213, v39
    v_lshlrev_b32 v38, 16, v85
    v_and_b32 v39, 0xffff0000, v85
    v_add_f32 v214, v214, v38
    v_add_f32 v215, v215, v39
    v_lshlrev_b32 v38, 16, v86
    v_and_b32 v39, 0xffff0000, v86
    v_add_f32 v216, v216, v38
    v_add_f32 v217, v217, v39
    v_lshlrev_b32 v38, 16, v87
    v_and_b32 v39, 0xffff0000, v87
    v_add_f32 v218, v218, v38
    v_add_f32 v219, v219, v39
    s_waitcnt vmcnt(10)
    v_lshlrev_b32 v38, 16, v88
    v_and_b32 v39, 0xffff0000, v88
    v_add_f32 v212, v212, v38
    v_add_f32 v213, v213, v39
    v_lshlrev_b32 v38, 16, v89
    v_and_b32 v39, 0xffff0000, v89
    v_add_f32 v214, v214, v38
    v_add_f32 v215, v215, v39
    v_lshlrev_b32 v38, 16, v90
    v_and_b32 v39, 0xffff0000, v90
    v_add_f32 v216, v216, v38
    v_add_f32 v217, v217, v39
    v_lshlrev_b32 v38, 16, v91
    v_and_b32 v39, 0xffff0000, v91
    v_add_f32 v218, v218, v38
    v_add_f32 v219, v219, v39
    s_waitcnt vmcnt(9)
    v_lshlrev_b32 v38, 16, v92
    v_and_b32 v39, 0xffff0000, v92
    v_add_f32 v212, v212, v38
    v_add_f32 v213, v213, v39
    v_lshlrev_b32 v38, 16, v93
    v_and_b32 v39, 0xffff0000, v93
    v_add_f32 v214, v214, v38
    v_add_f32 v215, v215, v39
    v_lshlrev_b32 v38, 16, v94
    v_and_b32 v39, 0xffff0000, v94
    v_add_f32 v216, v216, v38
    v_add_f32 v217, v217, v39
    v_lshlrev_b32 v38, 16, v95
    v_and_b32 v39, 0xffff0000, v95
    v_add_f32 v218, v218, v38
    v_add_f32 v219, v219, v39
    v_cvt_pk_bf16_f32 v44, v212, v213
    v_cvt_pk_bf16_f32 v45, v214, v215
    v_cvt_pk_bf16_f32 v48, v216, v217
    v_cvt_pk_bf16_f32 v49, v218, v219
    s_waitcnt vmcnt(8)
    v_lshlrev_b32 v38, 16, v96
    v_and_b32 v39, 0xffff0000, v96
    v_add_f32 v220, v220, v38
    v_add_f32 v221, v221, v39
    v_lshlrev_b32 v38, 16, v97
    v_and_b32 v39, 0xffff0000, v97
    v_add_f32 v222, v222, v38
    v_add_f32 v223, v223, v39
    v_lshlrev_b32 v38, 16, v98
    v_and_b32 v39, 0xffff0000, v98
    v_add_f32 v224, v224, v38
    v_add_f32 v225, v225, v39
    v_lshlrev_b32 v38, 16, v99
    v_and_b32 v39, 0xffff0000, v99
    v_add_f32 v226, v226, v38
    v_add_f32 v227, v227, v39
    s_waitcnt vmcnt(7)
    v_lshlrev_b32 v38, 16, v100
    v_and_b32 v39, 0xffff0000, v100
    v_add_f32 v220, v220, v38
    v_add_f32 v221, v221, v39
    v_lshlrev_b32 v38, 16, v101
    v_and_b32 v39, 0xffff0000, v101
    v_add_f32 v222, v222, v38
    v_add_f32 v223, v223, v39
    v_lshlrev_b32 v38, 16, v102
    v_and_b32 v39, 0xffff0000, v102
    v_add_f32 v224, v224, v38
    v_add_f32 v225, v225, v39
    v_lshlrev_b32 v38, 16, v103
    v_and_b32 v39, 0xffff0000, v103
    v_add_f32 v226, v226, v38
    v_add_f32 v227, v227, v39
    s_waitcnt vmcnt(6)
    v_lshlrev_b32 v38, 16, v104
    v_and_b32 v39, 0xffff0000, v104
    v_add_f32 v220, v220, v38
    v_add_f32 v221, v221, v39
    v_lshlrev_b32 v38, 16, v105
    v_and_b32 v39, 0xffff0000, v105
    v_add_f32 v222, v222, v38
    v_add_f32 v223, v223, v39
    v_lshlrev_b32 v38, 16, v106
    v_and_b32 v39, 0xffff0000, v106
    v_add_f32 v224, v224, v38
    v_add_f32 v225, v225, v39
    v_lshlrev_b32 v38, 16, v107
    v_and_b32 v39, 0xffff0000, v107
    v_add_f32 v226, v226, v38
    v_add_f32 v227, v227, v39
    v_cvt_pk_bf16_f32 v46, v220, v221
    v_cvt_pk_bf16_f32 v47, v222, v223
    v_cvt_pk_bf16_f32 v50, v224, v225
    v_cvt_pk_bf16_f32 v51, v226, v227
    v_permlane16_swap_b32 v44, v46
    v_permlane16_swap_b32 v45, v47
    buffer_store_dwordx4 v[44:47], v30, s[28:31], s72 offen sc1
    v_permlane16_swap_b32 v48, v50
    v_permlane16_swap_b32 v49, v51
    buffer_store_dwordx4 v[48:51], v31, s[28:31], s72 offen sc1
    s_waitcnt vmcnt(7)
    v_lshlrev_b32 v38, 16, v108
    v_and_b32 v39, 0xffff0000, v108
    v_add_f32 v196, v196, v38
    v_add_f32 v197, v197, v39
    v_lshlrev_b32 v38, 16, v109
    v_and_b32 v39, 0xffff0000, v109
    v_add_f32 v198, v198, v38
    v_add_f32 v199, v199, v39
    v_lshlrev_b32 v38, 16, v110
    v_and_b32 v39, 0xffff0000, v110
    v_add_f32 v200, v200, v38
    v_add_f32 v201, v201, v39
    v_lshlrev_b32 v38, 16, v111
    v_and_b32 v39, 0xffff0000, v111
    v_add_f32 v202, v202, v38
    v_add_f32 v203, v203, v39
    s_waitcnt vmcnt(6)
    v_lshlrev_b32 v38, 16, v112
    v_and_b32 v39, 0xffff0000, v112
    v_add_f32 v196, v196, v38
    v_add_f32 v197, v197, v39
    v_lshlrev_b32 v38, 16, v113
    v_and_b32 v39, 0xffff0000, v113
    v_add_f32 v198, v198, v38
    v_add_f32 v199, v199, v39
    v_lshlrev_b32 v38, 16, v114
    v_and_b32 v39, 0xffff0000, v114
    v_add_f32 v200, v200, v38
    v_add_f32 v201, v201, v39
    v_lshlrev_b32 v38, 16, v115
    v_and_b32 v39, 0xffff0000, v115
    v_add_f32 v202, v202, v38
    v_add_f32 v203, v203, v39
    s_waitcnt vmcnt(5)
    v_lshlrev_b32 v38, 16, v116
    v_and_b32 v39, 0xffff0000, v116
    v_add_f32 v196, v196, v38
    v_add_f32 v197, v197, v39
    v_lshlrev_b32 v38, 16, v117
    v_and_b32 v39, 0xffff0000, v117
    v_add_f32 v198, v198, v38
    v_add_f32 v199, v199, v39
    v_lshlrev_b32 v38, 16, v118
    v_and_b32 v39, 0xffff0000, v118
    v_add_f32 v200, v200, v38
    v_add_f32 v201, v201, v39
    v_lshlrev_b32 v38, 16, v119
    v_and_b32 v39, 0xffff0000, v119
    v_add_f32 v202, v202, v38
    v_add_f32 v203, v203, v39
    v_cvt_pk_bf16_f32 v52, v196, v197
    v_cvt_pk_bf16_f32 v53, v198, v199
    v_cvt_pk_bf16_f32 v56, v200, v201
    v_cvt_pk_bf16_f32 v57, v202, v203
    s_waitcnt vmcnt(4)
    v_lshlrev_b32 v38, 16, v120
    v_and_b32 v39, 0xffff0000, v120
    v_add_f32 v204, v204, v38
    v_add_f32 v205, v205, v39
    v_lshlrev_b32 v38, 16, v121
    v_and_b32 v39, 0xffff0000, v121
    v_add_f32 v206, v206, v38
    v_add_f32 v207, v207, v39
    v_lshlrev_b32 v38, 16, v122
    v_and_b32 v39, 0xffff0000, v122
    v_add_f32 v208, v208, v38
    v_add_f32 v209, v209, v39
    v_lshlrev_b32 v38, 16, v123
    v_and_b32 v39, 0xffff0000, v123
    v_add_f32 v210, v210, v38
    v_add_f32 v211, v211, v39
    s_waitcnt vmcnt(3)
    v_lshlrev_b32 v38, 16, v124
    v_and_b32 v39, 0xffff0000, v124
    v_add_f32 v204, v204, v38
    v_add_f32 v205, v205, v39
    v_lshlrev_b32 v38, 16, v125
    v_and_b32 v39, 0xffff0000, v125
    v_add_f32 v206, v206, v38
    v_add_f32 v207, v207, v39
    v_lshlrev_b32 v38, 16, v126
    v_and_b32 v39, 0xffff0000, v126
    v_add_f32 v208, v208, v38
    v_add_f32 v209, v209, v39
    v_lshlrev_b32 v38, 16, v127
    v_and_b32 v39, 0xffff0000, v127
    v_add_f32 v210, v210, v38
    v_add_f32 v211, v211, v39
    s_waitcnt vmcnt(2)
    v_lshlrev_b32 v38, 16, v128
    v_and_b32 v39, 0xffff0000, v128
    v_add_f32 v204, v204, v38
    v_add_f32 v205, v205, v39
    v_lshlrev_b32 v38, 16, v129
    v_and_b32 v39, 0xffff0000, v129
    v_add_f32 v206, v206, v38
    v_add_f32 v207, v207, v39
    v_lshlrev_b32 v38, 16, v130
    v_and_b32 v39, 0xffff0000, v130
    v_add_f32 v208, v208, v38
    v_add_f32 v209, v209, v39
    v_lshlrev_b32 v38, 16, v131
    v_and_b32 v39, 0xffff0000, v131
    v_add_f32 v210, v210, v38
    v_add_f32 v211, v211, v39
    v_cvt_pk_bf16_f32 v54, v204, v205
    v_cvt_pk_bf16_f32 v55, v206, v207
    v_cvt_pk_bf16_f32 v58, v208, v209
    v_cvt_pk_bf16_f32 v59, v210, v211
    v_permlane16_swap_b32 v52, v54
    v_permlane16_swap_b32 v53, v55
    buffer_store_dwordx4 v[52:55], v30, s[28:31], s73 offen sc1
    v_permlane16_swap_b32 v56, v58
    v_permlane16_swap_b32 v57, v59
    buffer_store_dwordx4 v[56:59], v31, s[28:31], s73 offen sc1
    s_branch L_fino
L_twoo:
    s_add_u32 s3, s61, s69
    buffer_load_dwordx4 v[84:87], v8, s[16:19], s3 offen sc1
    s_add_u32 s3, s62, s69
    buffer_load_dwordx4 v[88:91], v8, s[16:19], s3 offen sc1
    s_add_u32 s3, s63, s69
    buffer_load_dwordx4 v[92:95], v8, s[16:19], s3 offen sc1
    s_add_u32 s3, s61, s69
    buffer_load_dwordx4 v[96:99], v36, s[16:19], s3 offen sc1
    s_add_u32 s3, s62, s69
    buffer_load_dwordx4 v[100:103], v36, s[16:19], s3 offen sc1
    s_add_u32 s3, s63, s69
    buffer_load_dwordx4 v[104:107], v36, s[16:19], s3 offen sc1
    s_waitcnt vmcnt(5)
    v_lshlrev_b32 v38, 16, v84
    v_and_b32 v39, 0xffff0000, v84
    v_add_f32 v212, v212, v38
    v_add_f32 v213, v213, v39
    v_lshlrev_b32 v38, 16, v85
    v_and_b32 v39, 0xffff0000, v85
    v_add_f32 v214, v214, v38
    v_add_f32 v215, v215, v39
    v_lshlrev_b32 v38, 16, v86
    v_and_b32 v39, 0xffff0000, v86
    v_add_f32 v216, v216, v38
    v_add_f32 v217, v217, v39
    v_lshlrev_b32 v38, 16, v87
    v_and_b32 v39, 0xffff0000, v87
    v_add_f32 v218, v218, v38
    v_add_f32 v219, v219, v39
    s_waitcnt vmcnt(4)
    v_lshlrev_b32 v38, 16, v88
    v_and_b32 v39, 0xffff0000, v88
    v_add_f32 v212, v212, v38
    v_add_f32 v213, v213, v39
    v_lshlrev_b32 v38, 16, v89
    v_and_b32 v39, 0xffff0000, v89
    v_add_f32 v214, v214, v38
    v_add_f32 v215, v215, v39
    v_lshlrev_b32 v38, 16, v90
    v_and_b32 v39, 0xffff0000, v90
    v_add_f32 v216, v216, v38
    v_add_f32 v217, v217, v39
    v_lshlrev_b32 v38, 16, v91
    v_and_b32 v39, 0xffff0000, v91
    v_add_f32 v218, v218, v38
    v_add_f32 v219, v219, v39
    s_waitcnt vmcnt(3)
    v_lshlrev_b32 v38, 16, v92
    v_and_b32 v39, 0xffff0000, v92
    v_add_f32 v212, v212, v38
    v_add_f32 v213, v213, v39
    v_lshlrev_b32 v38, 16, v93
    v_and_b32 v39, 0xffff0000, v93
    v_add_f32 v214, v214, v38
    v_add_f32 v215, v215, v39
    v_lshlrev_b32 v38, 16, v94
    v_and_b32 v39, 0xffff0000, v94
    v_add_f32 v216, v216, v38
    v_add_f32 v217, v217, v39
    v_lshlrev_b32 v38, 16, v95
    v_and_b32 v39, 0xffff0000, v95
    v_add_f32 v218, v218, v38
    v_add_f32 v219, v219, v39
    v_cvt_pk_bf16_f32 v44, v212, v213
    v_cvt_pk_bf16_f32 v45, v214, v215
    v_cvt_pk_bf16_f32 v48, v216, v217
    v_cvt_pk_bf16_f32 v49, v218, v219
    s_waitcnt vmcnt(2)
    v_lshlrev_b32 v38, 16, v96
    v_and_b32 v39, 0xffff0000, v96
    v_add_f32 v220, v220, v38
    v_add_f32 v221, v221, v39
    v_lshlrev_b32 v38, 16, v97
    v_and_b32 v39, 0xffff0000, v97
    v_add_f32 v222, v222, v38
    v_add_f32 v223, v223, v39
    v_lshlrev_b32 v38, 16, v98
    v_and_b32 v39, 0xffff0000, v98
    v_add_f32 v224, v224, v38
    v_add_f32 v225, v225, v39
    v_lshlrev_b32 v38, 16, v99
    v_and_b32 v39, 0xffff0000, v99
    v_add_f32 v226, v226, v38
    v_add_f32 v227, v227, v39
    s_waitcnt vmcnt(1)
    v_lshlrev_b32 v38, 16, v100
    v_and_b32 v39, 0xffff0000, v100
    v_add_f32 v220, v220, v38
    v_add_f32 v221, v221, v39
    v_lshlrev_b32 v38, 16, v101
    v_and_b32 v39, 0xffff0000, v101
    v_add_f32 v222, v222, v38
    v_add_f32 v223, v223, v39
    v_lshlrev_b32 v38, 16, v102
    v_and_b32 v39, 0xffff0000, v102
    v_add_f32 v224, v224, v38
    v_add_f32 v225, v225, v39
    v_lshlrev_b32 v38, 16, v103
    v_and_b32 v39, 0xffff0000, v103
    v_add_f32 v226, v226, v38
    v_add_f32 v227, v227, v39
    s_waitcnt vmcnt(0)
    v_lshlrev_b32 v38, 16, v104
    v_and_b32 v39, 0xffff0000, v104
    v_add_f32 v220, v220, v38
    v_add_f32 v221, v221, v39
    v_lshlrev_b32 v38, 16, v105
    v_and_b32 v39, 0xffff0000, v105
    v_add_f32 v222, v222, v38
    v_add_f32 v223, v223, v39
    v_lshlrev_b32 v38, 16, v106
    v_and_b32 v39, 0xffff0000, v106
    v_add_f32 v224, v224, v38
    v_add_f32 v225, v225, v39
    v_lshlrev_b32 v38, 16, v107
    v_and_b32 v39, 0xffff0000, v107
    v_add_f32 v226, v226, v38
    v_add_f32 v227, v227, v39
    v_cvt_pk_bf16_f32 v46, v220, v221
    v_cvt_pk_bf16_f32 v47, v222, v223
    v_cvt_pk_bf16_f32 v50, v224, v225
    v_cvt_pk_bf16_f32 v51, v226, v227
    v_permlane16_swap_b32 v44, v46
    v_permlane16_swap_b32 v45, v47
    buffer_store_dwordx4 v[44:47], v30, s[28:31], s72 offen sc1
    v_permlane16_swap_b32 v48, v50
    v_permlane16_swap_b32 v49, v51
    buffer_store_dwordx4 v[48:51], v31, s[28:31], s72 offen sc1
L_fino:
    s_endpgm
L_spinoN:
    s_mov_b32 s96, 0x20000
L_spinoN_l:
    buffer_load_dword v29, v244, s[36:39], 0 offen sc1
    s_waitcnt vmcnt(0)
    v_readfirstlane_b32 s60, v29
    s_nop 0
    s_cmp_lg_u32 s60, 0
    s_cbranch_scc1 L_backoN
    s_sub_u32 s96, s96, 1
    s_cmp_lg_u32 s96, 0
    s_cbranch_scc1 L_spinoN_l
    s_branch L_backoN
L_spino1:
    s_mov_b32 s96, 0x20000
L_spino1_l:
    buffer_load_dword v29, v242, s[16:19], 0 offen sc1
    s_waitcnt vmcnt(0)
    s_add_u32 s3, s60, 1
    v_subrev_u32 v23, s3, v29
    v_cmp_ge_u32 vcc, 6, v23
    s_and_b64 vcc, vcc, s[90:91]
    s_cmp_eq_u64 vcc, s[90:91]
    s_cbranch_scc1 L_backo1
    s_sub_u32 s96, s96, 1
    s_cmp_lg_u32 s96, 0
    s_cbranch_scc1 L_spino1_l
    s_branch L_backo1
L_spino2:
    s_mov_b32 s96, 0x20000
L_spino2_l:
    buffer_load_dword v29, v242, s[16:19], 0 offen sc1
    s_waitcnt vmcnt(0)
    s_add_u32 s3, s60, 2
    v_subrev_u32 v23, s3, v29
    v_cmp_ge_u32 vcc, 5, v23
    s_and_b64 vcc, vcc, s[90:91]
    s_cmp_eq_u64 vcc, s[90:91]
    s_cbranch_scc1 L_backo2
    s_sub_u32 s96, s96, 1
    s_cmp_lg_u32 s96, 0
    s_cbranch_scc1 L_spino2_l
    s_branch L_backo2
L_spino3:
    s_mov_b32 s96, 0x20000
L_spino3_l:
    buffer_load_dword v29, v242, s[16:19], 0 offen sc1
    s_waitcnt vmcnt(0)
    s_add_u32 s3, s60, 3
    v_subrev_u32 v23, s3, v29
    v_cmp_ge_u32 vcc, 4, v23
    s_and_b64 vcc, vcc, s[90:91]
    s_cmp_eq_u64 vcc, s[90:91]
    s_cbranch_scc1 L_backo3
    s_sub_u32 s96, s96, 1
    s_cmp_lg_u32 s96, 0
    s_cbranch_scc1 L_spino3_l
    s_branch L_backo3
L_spinoF:
    s_mov_b32 s96, 0x20000
L_spinoF_l:
    buffer_load_dword v29, v242, s[16:19], 0 offen sc1
    s_waitcnt vmcnt(0)
    s_add_u32 s3, s60, 6
    v_subrev_u32 v23, s3, v29
    v_cmp_ge_u32 vcc, 1, v23
    s_and_b64 vcc, vcc, s[92:93]
    s_cmp_eq_u64 vcc, s[92:93]
    s_cbranch_scc1 L_backoF
    s_sub_u32 s96, s96, 1
    s_cmp_lg_u32 s96, 0
    s_cbranch_scc1 L_spinoF_l
    s_branch L_backoF
L_end:
    s_endpgm
.section .rodata,"a"
.p2align 6
.amdhsa_kernel standalone__dense_activation_gelu__prompt_kernel
  .amdhsa_next_free_vgpr 512
  .amdhsa_next_free_sgpr 102
  .amdhsa_accum_offset 256
  .amdhsa_group_segment_fixed_size 0
  .amdhsa_kernarg_size 64
  .amdhsa_user_sgpr_count 2
  .amdhsa_user_sgpr_kernarg_segment_ptr 1
  .amdhsa_system_sgpr_workgroup_id_x 1
  .amdhsa_float_denorm_mode_32 3
.end_amdhsa_kernel
```
